```python
import torch

def _softmax(x, axis=-1):
    return torch.softmax(x, dim=axis)
def _gelu(x):
    return torch.nn.functional.gelu(x, approximate="tanh")
def _silu(x):
    return torch.nn.functional.silu(x)
def _sigmoid(x):
    return torch.sigmoid(x)
def _layernorm(x, axis=-1, eps=1e-5):
    m = x.mean(dim=axis, keepdim=True)
    v = x.var(dim=axis, keepdim=True, unbiased=False)
    return (x - m) / torch.sqrt(v + eps)
def _scatter_add(tgt, idx, src, axis=0):
    return tgt.clone().index_add_(axis, idx, src)
def _segment_sum(src, seg, n):
    out = torch.zeros((n,) + src.shape[1:], dtype=src.dtype)
    return out.index_add_(0, seg, src)
def _pad(x, pw):
    flat = tuple(v for pair in reversed(pw) for v in pair)
    return torch.nn.functional.pad(x, flat)

kernel_name = 'sequential_preLN__ssm_conv_s4d__geglu_ffn__prompt'

def setup_inputs():

    _w = (lambda a: (lambda t: t.to(torch.bfloat16) if t.is_floating_point() else t)(torch.as_tensor(a)))
    def _A_setup():
        Bsz, L, D, N = 1, 2048, 448, 256
        return {
            "u": _w((lambda *s: torch.randn(*s, dtype=torch.bfloat16) * 0.05)(Bsz, L, D)),
            "log_A_real": _w((lambda *s: torch.randn(*s, dtype=torch.bfloat16) * 6.4)(D, N) * 0.5),
            "A_imag": _w((lambda *s: torch.randn(*s, dtype=torch.bfloat16) * 0.05)(D, N) * 3.14),
            "C_real": _w((lambda *s: torch.randn(*s, dtype=torch.bfloat16) * 0.05)(D, N) / N ** 0.5),
            "C_imag": _w((lambda *s: torch.randn(*s, dtype=torch.bfloat16) * 0.05)(D, N) / N ** 0.5),
            "log_dt": _w((lambda *s: torch.randn(*s, dtype=torch.bfloat16) * 0.05)(D) * 0.5 - 4.0),
            "D_skip": _w((lambda *s: torch.randn(*s, dtype=torch.bfloat16) * 0.05)(D)),
        }
    _A_in = _A_setup()

    def _B_setup():
        B, S, D, F = 1, 2048, 448, 1792
        return {
            "x": _w((lambda *s: torch.randn(*s, dtype=torch.bfloat16) * 0.05)(B, S, D)),
            "w_gate": _w((lambda *s: torch.randn(*s, dtype=torch.bfloat16) * 0.05)(D, F)),
            "w_up": _w((lambda *s: torch.randn(*s, dtype=torch.bfloat16) * 0.05)(D, F)),
            "w_down": _w((lambda *s: torch.randn(*s, dtype=torch.bfloat16) * 0.05)(F, D)),
        }
    _B_in = _B_setup()

    return {
        "A_u": _A_in["u"],
        "A_log_A_real": _A_in["log_A_real"],
        "A_A_imag": _A_in["A_imag"],
        "A_C_real": _A_in["C_real"],
        "A_C_imag": _A_in["C_imag"],
        "A_log_dt": _A_in["log_dt"],
        "A_D_skip": _A_in["D_skip"],
        "B_x": _B_in["x"],
        "B_w_gate": _B_in["w_gate"],
        "B_w_up": _B_in["w_up"],
        "B_w_down": _B_in["w_down"],
    }

def reference(A_u, A_log_A_real, A_A_imag, A_C_real, A_C_imag, A_log_dt, A_D_skip, B_x, B_w_gate, B_w_up, B_w_down):
    def _A_ref(u, log_A_real, A_imag, C_real, C_imag, log_dt, D_skip):
        L = u.shape[1]
        dt = torch.exp(log_dt)
        A = -torch.exp(log_A_real) + 1j * A_imag
        C = (C_real + 1j * C_imag) * dt[:, None]
        pos = (lambda x, dt: x.to(dt))(torch.arange(L), log_dt.dtype)
        P = torch.exp((A * dt[:, None])[:, :, None] * pos[None, None, :])
        K = 2.0 * torch.einsum("dn,dnl->dl", C, P).real
        L2 = 2 * L
        u_t = (lambda x, *d: x.permute(*d))(u, 0, 2, 1)
        Kf = (lambda x, *a, **k: torch.fft.rfft(x.float(), *a, **k))(K, L2)
        Uf = (lambda x, *a, **k: torch.fft.rfft(x.float(), *a, **k))(u_t, L2)
        y = (lambda x, *a, **k: torch.fft.irfft(x, *a, **k).to(torch.bfloat16))(Uf * Kf[None, :, :], L2)[:, :, :L]
        y = (lambda x, *d: x.permute(*d))(y, 0, 2, 1)
        return y + u * D_skip[None, None, :]

    def _B_ref(x, w_gate, w_up, w_down):
        return (_gelu(x @ w_gate) * (x @ w_up)) @ w_down

    x = A_u
    h = x + _A_ref(_layernorm(x, axis=-1), A_log_A_real, A_A_imag, A_C_real, A_C_imag, A_log_dt, A_D_skip)
    h2 = h + _B_ref(_layernorm(h, axis=-1), B_w_gate, B_w_up, B_w_down)
    return h2
```

```asm
; @launch grid=(256,1,1) block=(768,1,1) lds=163840
.amdgcn_target "amdgcn-amd-amdhsa--gfx950"
.text
.globl sequential_preLN__ssm_conv_s4d__geglu_ffn__prompt_kernel
.p2align 8
.type sequential_preLN__ssm_conv_s4d__geglu_ffn__prompt_kernel,@function
sequential_preLN__ssm_conv_s4d__geglu_ffn__prompt_kernel:
    s_cmp_ge_u32 s2, 256
    s_cbranch_scc1 end_1
    s_load_dwordx16 s[4:19], s[0:1], 0
    s_load_dwordx8 s[20:27], s[0:1], 64
    s_load_dwordx4 s[28:31], s[0:1], 96
    s_getpc_b64 s[60:61]
Lpc:
    s_lshr_b32 s62, s2, 3
    s_mul_i32 s62, s62, 1536
    v_lshl_add_u32 v2, v0, 7, s62
    v_min_u32 v2, Lcode_end-Lpc-4, v2
    v_cmp_gt_u32_e64 vcc, 12, v0
    s_nop 0
    s_and_saveexec_b64 s[62:63], vcc
    s_cbranch_execz Lcpx
    global_load_dword v167, v2, s[60:61]
Lcpx:
    s_mov_b64 exec, -1
    v_lshrrev_b32 v4, 6, v0
    v_and_b32 v1, 63, v0
    s_and_b32 s37, s2, 7
    v_readfirstlane_b32 s36, v4
    s_mul_i32 s37, s37, 28
    s_lshr_b32 s38, s2, 3
    s_add_u32 s37, s37, s38
    s_mov_b32 s43, 0xffff0000
    s_cmp_ge_u32 s36, 8
    s_cbranch_scc1 Laux
    s_cmp_ge_u32 s2, 224
    s_cbranch_scc1 hlp_2
    v_mov_b32 v8, 0
    v_mov_b32 v9, 0
    v_mov_b32 v10, 0
    v_mov_b32 v11, 0
    s_lshl_b32 s48, s37, 10
    v_lshl_add_u32 v4, v0, 1, s48
    s_lshl_b32 s48, s37, 2
    s_lshl_b32 s56, s36, 14
    s_mov_b32 m0, s56
    s_lshr_b32 s38, s36, 2
    s_add_u32 s62, s60, tab_5-Lpc+2048
    s_addc_u32 s63, s61, 0
    s_waitcnt lgkmcnt(0)
    s_load_dword s52, s[14:15], s48
    global_load_short_d16_hi v8, v4, s[6:7]
    global_load_short_d16_hi v9, v4, s[8:9]
    global_load_short_d16_hi v10, v4, s[10:11]
    global_load_short_d16_hi v11, v4, s[12:13]
    s_branch kw_3
Laux:
    s_setprio 3
    v_lshrrev_b32 v5, 3, v1
    v_and_b32 v6, 7, v1
    v_mul_u32_u24 v7, 896, v5
    s_cmp_lt_u32 s36, 10
    s_cbranch_scc1 til_8
    s_and_b32 s36, s36, 1
    s_and_b32 s47, s2, 7
    s_lshl_b32 s47, s47, 5
    s_add_u32 s47, s47, s38
    s_xor_b32 s47, s47, 31
    s_mul_i32 s48, s47, 7168
    v_lshl_add_u32 v8, v6, 4, v7
    v_add_u32_e64 v8, s48, v8
    s_waitcnt lgkmcnt(0)
    s_cmp_eq_u32 s36, 1
    s_cbranch_scc1 hold_9t
    s_load_dword s56, s[30:31], 16384
    global_load_dwordx4 v[16:19], v8, s[4:5] offset:0
    global_load_dwordx4 v[20:23], v8, s[4:5] offset:128
    global_load_dwordx4 v[24:27], v8, s[4:5] offset:256
    global_load_dwordx4 v[28:31], v8, s[4:5] offset:384
    global_load_dwordx4 v[32:35], v8, s[4:5] offset:512
    global_load_dwordx4 v[36:39], v8, s[4:5] offset:640
    global_load_dwordx4 v[40:43], v8, s[4:5] offset:768
    s_branch auxs_7
til_8:
    s_cmp_ge_u32 s2, 224
    s_cbranch_scc1 hlp_2
    s_and_b32 s36, s36, 1
    s_mul_i32 s46, s37, 9363
    s_lshr_b32 s46, s46, 16
    s_mul_i32 s47, s46, 7
    s_sub_u32 s47, s37, s47
    s_lshl_b32 s46, s46, 1
    s_add_u32 s46, s46, s36
    s_mul_i32 s49, s46, 28672
    s_lshl_b32 s48, s47, 7
    s_add_u32 s49, s49, s48
    s_lshl_b32 s47, s47, 19
    s_lshl_b32 s46, s46, 8
    s_add_u32 s51, s47, s46
    s_lshl_b32 s46, s36, 12
    s_add_u32 s46, s46, 140288
    s_mov_b32 m0, s46
    v_lshrrev_b32 v4, 1, v5
    v_xor_b32_e64 v4, v4, v6
    v_lshl_add_u32 v12, v4, 4, v7
    v_xor_b32_e64 v4, 4, v4
    v_lshl_add_u32 v13, v4, 4, v7
    v_add_u32 v13, 6144, v13
    v_add_u32 v14, 12288, v12
    v_add_u32 v15, 12288, v13
    s_mov_b32 s34, 1835008
    s_mov_b32 s35, 0x20000
    s_waitcnt lgkmcnt(0)
    s_mov_b32 s32, s4
    s_mov_b32 s33, s5
    buffer_load_dwordx4 v12, s[32:35], s49 offen offset:0 lds
    buffer_load_dwordx4 v13, s[32:35], s49 offen offset:1024 lds
    buffer_load_dwordx4 v14, s[32:35], s49 offen offset:2048 lds
    buffer_load_dwordx4 v15, s[32:35], s49 offen offset:3072 lds
    s_load_dword s57, s[30:31], 16384
    s_branch auxt_6
kw_3:
    v_bfe_u32 v2, v0, 5, 1
    v_and_b32 v3, 31, v0
    s_lshl_b32 s46, s36, 15
    v_mul_u32_u24 v4, 272, v3
    v_lshl_add_u32 v4, v2, 4, v4
    v_add_u32_e64 v96, s46, v4
    s_bfe_u32 s39, s36, 0x10001
    s_and_b32 s40, s36, 1
    s_lshl_b32 s48, s39, 15
    s_lshl_b32 s47, s40, 8
    s_add_u32 s48, s48, s47
    s_add_u32 s48, s48, 8744
    v_and_b32 v4, 3, v0
    v_sub_u32 v4, 3, v4
    v_mul_u32_u24 v4, 4160, v4
    v_bfe_u32 v5, v0, 2, 2
    v_lshl_add_u32 v4, v5, 3, v4
    v_bfe_u32 v5, v0, 4, 2
    v_lshl_add_u32 v4, v5, 4, v4
    v_add_u32_e64 v94, s48, v4
    s_mul_i32 s48, s39, 4608
    s_sub_u32 s48, s48, s47
    s_add_u32 s48, s48, 74576
    v_and_b32 v4, 15, v0
    v_lshlrev_b32 v4, 5, v4
    v_lshlrev_b32 v5, 4, v5
    v_sub_u32 v4, v4, v5
    v_add_u32 v95, s48, v4
    s_add_u32 s64, s30, 10489856
    s_addc_u32 s65, s31, 0
    s_mov_b32 s66, 3670016
    s_mov_b32 s67, 0x20000
    s_and_b32 s47, s36, 3
    s_lshl_b32 s47, s47, 12
    v_lshl_add_u32 v97, v1, 4, s47
    s_lshl_b32 s44, s37, 14
    s_mov_b32 s54, 0x41000000
    s_mov_b32 s55, 0x43800000
    s_lshl_b32 s46, s38, 4
    v_mov_b32 v12, 0x3fb8aa3b
    s_cmp_lt_u32 s36, 4
    s_cbranch_scc1 Lnoprio
    s_setprio 1
Lnoprio:
    s_waitcnt lgkmcnt(0)
    s_lshr_b32 s52, s52, s46
    s_lshl_b32 s52, s52, 16
    v_mul_f32 v12, s52, v12
    v_exp_f32 v12, v12
    s_nop 0
    v_cvt_pk_bf16_f32 v12, v12, v12
    v_and_b32 v12, s43, v12
    v_add_f32_e64 v6, v12, v12
    s_waitcnt vmcnt(2)
    v_mul_f32 v4, 0x3fb8aa3b, v8
    v_exp_f32 v4, v4
    v_mul_f32 v15, v9, v12
    v_cvt_pk_bf16_f32 v4, v4, v4
    v_and_b32 v4, s43, v4
    v_mul_f32 v14, v4, v12
    v_mul_f32_e64 v15, 0.15915494, v15
    v_mul_f32 v14, 0xbfb8aa3b, v14
    v_mul_f32 v24, s54, v14
    v_mul_f32 v25, s54, v15
    v_exp_f32 v24, v24
    v_fract_f32 v25, v25
    v_cos_f32 v62, v25
    v_sin_f32_e64 v63, v25
    s_nop 0
    v_pk_mul_f32 v[62:63], v[62:63], v[24:25] op_sel_hi:[1,0]
    v_mov_b32 v86, 0x3f80
    ds_write_addtid_b32 v86
    v_pk_mul_f32 v[64:65], v[62:63], v[62:63] op_sel_hi:[1,0]
    v_pk_fma_f32 v[64:65], v[62:63], v[62:63], v[64:65] op_sel:[1,1,0] op_sel_hi:[0,1,1] neg_lo:[0,1,0]
    v_pk_mul_f32 v[66:67], v[64:65], v[62:63] op_sel_hi:[1,0]
    v_pk_fma_f32 v[66:67], v[64:65], v[62:63], v[66:67] op_sel:[1,1,0] op_sel_hi:[0,1,1] neg_lo:[0,1,0]
    v_pk_mul_f32 v[68:69], v[64:65], v[64:65] op_sel_hi:[1,0]
    v_pk_fma_f32 v[68:69], v[64:65], v[64:65], v[68:69] op_sel:[1,1,0] op_sel_hi:[0,1,1] neg_lo:[0,1,0]
    v_cvt_pk_bf16_f32 v78, v62, v63
    v_pk_mul_f32 v[70:71], v[62:63], v[68:69] op_sel_hi:[1,0]
    v_pk_fma_f32 v[70:71], v[62:63], v[68:69], v[70:71] op_sel:[1,1,0] op_sel_hi:[0,1,1] neg_lo:[0,1,0]
    v_mul_f32_e64 v28, s55, v14
    ds_write_addtid_b32 v78 offset:272
    v_cvt_pk_bf16_f32 v79, v64, v65
    v_pk_mul_f32 v[72:73], v[64:65], v[68:69] op_sel_hi:[1,0]
    v_pk_fma_f32 v[72:73], v[64:65], v[68:69], v[72:73] op_sel:[1,1,0] op_sel_hi:[0,1,1] neg_lo:[0,1,0]
    v_exp_f32_e64 v26, v14
    ds_write_addtid_b32 v79 offset:544
    v_cvt_pk_bf16_f32 v80, v66, v67
    v_pk_mul_f32 v[74:75], v[66:67], v[68:69] op_sel_hi:[1,0]
    v_pk_fma_f32 v[74:75], v[66:67], v[68:69], v[74:75] op_sel:[1,1,0] op_sel_hi:[0,1,1] neg_lo:[0,1,0]
    v_mul_f32_e64 v29, s55, v15
    ds_write_addtid_b32 v80 offset:816
    v_cvt_pk_bf16_f32 v81, v68, v69
    v_pk_mul_f32 v[76:77], v[68:69], v[68:69] op_sel_hi:[1,0]
    v_pk_fma_f32 v[76:77], v[68:69], v[68:69], v[76:77] op_sel:[1,1,0] op_sel_hi:[0,1,1] neg_lo:[0,1,0]
    v_fract_f32_e64 v27, v15
    ds_write_addtid_b32 v81 offset:1088
    v_cvt_pk_bf16_f32 v82, v70, v71
    v_pk_mul_f32 v[46:47], v[70:71], v[68:69] op_sel_hi:[1,0]
    v_pk_fma_f32 v[46:47], v[70:71], v[68:69], v[46:47] op_sel:[1,1,0] op_sel_hi:[0,1,1] neg_lo:[0,1,0]
    v_exp_f32_e64 v28, v28
    ds_write_addtid_b32 v82 offset:1360
    v_cvt_pk_bf16_f32 v83, v72, v73
    v_pk_mul_f32 v[48:49], v[72:73], v[68:69] op_sel_hi:[1,0]
    v_pk_fma_f32 v[48:49], v[72:73], v[68:69], v[48:49] op_sel:[1,1,0] op_sel_hi:[0,1,1] neg_lo:[0,1,0]
    v_cos_f32_e64 v16, v27
    ds_write_addtid_b32 v83 offset:1632
    v_cvt_pk_bf16_f32 v84, v74, v75
    v_pk_mul_f32 v[50:51], v[74:75], v[68:69] op_sel_hi:[1,0]
    v_pk_fma_f32 v[50:51], v[74:75], v[68:69], v[50:51] op_sel:[1,1,0] op_sel_hi:[0,1,1] neg_lo:[0,1,0]
    v_fract_f32_e64 v29, v29
    ds_write_addtid_b32 v84 offset:1904
    v_cvt_pk_bf16_f32 v85, v76, v77
    v_pk_mul_f32 v[52:53], v[76:77], v[68:69] op_sel_hi:[1,0]
    v_pk_fma_f32 v[52:53], v[76:77], v[68:69], v[52:53] op_sel:[1,1,0] op_sel_hi:[0,1,1] neg_lo:[0,1,0]
    v_cos_f32_e64 v18, v29
    ds_write_addtid_b32 v85 offset:2176
    v_cvt_pk_bf16_f32 v78, v46, v47
    v_pk_mul_f32 v[70:71], v[46:47], v[68:69] op_sel_hi:[1,0]
    v_pk_fma_f32 v[70:71], v[46:47], v[68:69], v[70:71] op_sel:[1,1,0] op_sel_hi:[0,1,1] neg_lo:[0,1,0]
    v_sin_f32_e64 v17, v27
    ds_write_addtid_b32 v78 offset:2448
    v_cvt_pk_bf16_f32 v79, v48, v49
    v_pk_mul_f32 v[72:73], v[48:49], v[68:69] op_sel_hi:[1,0]
    v_pk_fma_f32 v[72:73], v[48:49], v[68:69], v[72:73] op_sel:[1,1,0] op_sel_hi:[0,1,1] neg_lo:[0,1,0]
    v_sin_f32_e64 v19, v29
    ds_write_addtid_b32 v79 offset:2720
    v_cvt_pk_bf16_f32 v80, v50, v51
    v_pk_mul_f32 v[74:75], v[50:51], v[68:69] op_sel_hi:[1,0]
    v_pk_fma_f32 v[74:75], v[50:51], v[68:69], v[74:75] op_sel:[1,1,0] op_sel_hi:[0,1,1] neg_lo:[0,1,0]
    v_pk_mul_f32 v[16:17], v[16:17], v[26:27] op_sel_hi:[1,0]
    ds_write_addtid_b32 v80 offset:2992
    v_cvt_pk_bf16_f32 v81, v52, v53
    v_pk_mul_f32 v[76:77], v[52:53], v[68:69] op_sel_hi:[1,0]
    v_pk_fma_f32 v[76:77], v[52:53], v[68:69], v[76:77] op_sel:[1,1,0] op_sel_hi:[0,1,1] neg_lo:[0,1,0]
    v_pk_mul_f32 v[18:19], v[18:19], v[28:29] op_sel_hi:[1,0]
    ds_write_addtid_b32 v81 offset:3264
    v_cvt_pk_bf16_f32 v82, v70, v71
    v_pk_mul_f32 v[46:47], v[70:71], v[68:69] op_sel_hi:[1,0]
    v_pk_fma_f32 v[46:47], v[70:71], v[68:69], v[46:47] op_sel:[1,1,0] op_sel_hi:[0,1,1] neg_lo:[0,1,0]
    s_waitcnt vmcnt(0)
    ds_write_addtid_b32 v82 offset:3536
    v_cvt_pk_bf16_f32 v83, v72, v73
    v_pk_mul_f32 v[48:49], v[72:73], v[68:69] op_sel_hi:[1,0]
    v_pk_fma_f32 v[48:49], v[72:73], v[68:69], v[48:49] op_sel:[1,1,0] op_sel_hi:[0,1,1] neg_lo:[0,1,0]
    v_mul_f32 v30, v10, v6
    ds_write_addtid_b32 v83 offset:3808
    v_cvt_pk_bf16_f32 v84, v74, v75
    v_pk_mul_f32 v[50:51], v[74:75], v[68:69] op_sel_hi:[1,0]
    v_pk_fma_f32 v[50:51], v[74:75], v[68:69], v[50:51] op_sel:[1,1,0] op_sel_hi:[0,1,1] neg_lo:[0,1,0]
    v_mul_f32_e64 v31, v11, v6
    ds_write_addtid_b32 v84 offset:4080
    v_cvt_pk_bf16_f32 v85, v76, v77
    v_pk_mul_f32 v[52:53], v[76:77], v[68:69] op_sel_hi:[1,0]
    v_pk_fma_f32 v[52:53], v[76:77], v[68:69], v[52:53] op_sel:[1,1,0] op_sel_hi:[0,1,1] neg_lo:[0,1,0]
    v_min_u32 v5, 255, v0
    v_lshlrev_b32_e64 v6, 4, v5
    ds_write_addtid_b32 v85 offset:4352
    v_cvt_pk_bf16_f32 v78, v46, v47
    v_pk_mul_f32 v[70:71], v[46:47], v[68:69] op_sel_hi:[1,0]
    v_pk_fma_f32 v[70:71], v[46:47], v[68:69], v[70:71] op_sel:[1,1,0] op_sel_hi:[0,1,1] neg_lo:[0,1,0]
    v_lshlrev_b32_e64 v5, 3, v5
    ds_write_addtid_b32 v78 offset:4624
    v_cvt_pk_bf16_f32 v79, v48, v49
    v_pk_mul_f32 v[72:73], v[48:49], v[68:69] op_sel_hi:[1,0]
    v_pk_fma_f32 v[72:73], v[48:49], v[68:69], v[72:73] op_sel:[1,1,0] op_sel_hi:[0,1,1] neg_lo:[0,1,0]
    global_load_dwordx4 v[88:91], v6, s[62:63] offset:-2048
    ds_write_addtid_b32 v79 offset:4896
    v_cvt_pk_bf16_f32 v80, v50, v51
    v_pk_mul_f32 v[74:75], v[50:51], v[68:69] op_sel_hi:[1,0]
    v_pk_fma_f32 v[74:75], v[50:51], v[68:69], v[74:75] op_sel:[1,1,0] op_sel_hi:[0,1,1] neg_lo:[0,1,0]
    global_load_dwordx2 v[92:93], v5, s[62:63] offset:2048
    ds_write_addtid_b32 v80 offset:5168
    v_cvt_pk_bf16_f32 v81, v52, v53
    v_pk_mul_f32 v[76:77], v[52:53], v[68:69] op_sel_hi:[1,0]
    v_pk_fma_f32 v[76:77], v[52:53], v[68:69], v[76:77] op_sel:[1,1,0] op_sel_hi:[0,1,1] neg_lo:[0,1,0]
    v_pk_mul_f32 v[20:21], v[16:17], v[16:17] op_sel_hi:[1,0]
    ds_write_addtid_b32 v81 offset:5440
    v_cvt_pk_bf16_f32 v82, v70, v71
    v_pk_mul_f32 v[46:47], v[70:71], v[68:69] op_sel_hi:[1,0]
    v_pk_fma_f32 v[46:47], v[70:71], v[68:69], v[46:47] op_sel:[1,1,0] op_sel_hi:[0,1,1] neg_lo:[0,1,0]
    v_pk_fma_f32 v[20:21], v[16:17], v[16:17], v[20:21] op_sel:[1,1,0] op_sel_hi:[0,1,1] neg_lo:[0,1,0]
    ds_write_addtid_b32 v82 offset:5712
    v_cvt_pk_bf16_f32 v83, v72, v73
    v_pk_mul_f32 v[48:49], v[72:73], v[68:69] op_sel_hi:[1,0]
    v_pk_fma_f32 v[48:49], v[72:73], v[68:69], v[48:49] op_sel:[1,1,0] op_sel_hi:[0,1,1] neg_lo:[0,1,0]
    v_pk_mul_f32 v[32:33], v[30:31], v[16:17] op_sel_hi:[1,0]
    ds_write_addtid_b32 v83 offset:5984
    v_cvt_pk_bf16_f32 v84, v74, v75
    v_pk_mul_f32 v[50:51], v[74:75], v[68:69] op_sel_hi:[1,0]
    v_pk_fma_f32 v[50:51], v[74:75], v[68:69], v[50:51] op_sel:[1,1,0] op_sel_hi:[0,1,1] neg_lo:[0,1,0]
    v_pk_fma_f32 v[32:33], v[30:31], v[16:17], v[32:33] op_sel:[1,1,0] op_sel_hi:[0,1,1] neg_lo:[0,1,0]
    ds_write_addtid_b32 v84 offset:6256
    v_cvt_pk_bf16_f32 v85, v76, v77
    v_pk_mul_f32 v[52:53], v[76:77], v[68:69] op_sel_hi:[1,0]
    v_pk_fma_f32 v[52:53], v[76:77], v[68:69], v[52:53] op_sel:[1,1,0] op_sel_hi:[0,1,1] neg_lo:[0,1,0]
    v_pk_mul_f32 v[22:23], v[18:19], v[18:19] op_sel_hi:[1,0]
    ds_write_addtid_b32 v85 offset:6528
    v_cvt_pk_bf16_f32 v78, v46, v47
    v_pk_mul_f32 v[70:71], v[46:47], v[68:69] op_sel_hi:[1,0]
    v_pk_fma_f32 v[70:71], v[46:47], v[68:69], v[70:71] op_sel:[1,1,0] op_sel_hi:[0,1,1] neg_lo:[0,1,0]
    v_pk_fma_f32 v[22:23], v[18:19], v[18:19], v[22:23] op_sel:[1,1,0] op_sel_hi:[0,1,1] neg_lo:[0,1,0]
    ds_write_addtid_b32 v78 offset:6800
    v_cvt_pk_bf16_f32 v79, v48, v49
    v_pk_mul_f32 v[72:73], v[48:49], v[68:69] op_sel_hi:[1,0]
    v_pk_fma_f32 v[72:73], v[48:49], v[68:69], v[72:73] op_sel:[1,1,0] op_sel_hi:[0,1,1] neg_lo:[0,1,0]
    ds_write_addtid_b32 v79 offset:7072
    s_setprio 0
    s_nop 0
    v_cvt_pk_bf16_f32 v80, v50, v51
    v_pk_mul_f32 v[74:75], v[50:51], v[68:69] op_sel_hi:[1,0]
    v_pk_fma_f32 v[74:75], v[50:51], v[68:69], v[74:75] op_sel:[1,1,0] op_sel_hi:[0,1,1] neg_lo:[0,1,0]
    ds_write_addtid_b32 v80 offset:7344
    v_cvt_pk_bf16_f32 v81, v52, v53
    ds_write_addtid_b32 v81 offset:7616
    v_cvt_pk_bf16_f32 v82, v70, v71
    v_pk_mul_f32 v[34:35], v[30:31], v[20:21] op_sel_hi:[1,0]
    v_pk_fma_f32 v[34:35], v[30:31], v[20:21], v[34:35] op_sel:[1,1,0] op_sel_hi:[0,1,1] neg_lo:[0,1,0]
    ds_write_addtid_b32 v82 offset:7888
    v_cvt_pk_bf16_f32 v83, v72, v73
    v_pk_mul_f32 v[36:37], v[32:33], v[20:21] op_sel_hi:[1,0]
    v_pk_fma_f32 v[36:37], v[32:33], v[20:21], v[36:37] op_sel:[1,1,0] op_sel_hi:[0,1,1] neg_lo:[0,1,0]
    ds_write_addtid_b32 v83 offset:8160
    v_cvt_pk_bf16_f32 v84, v74, v75
    v_pk_mul_f32 v[38:39], v[34:35], v[20:21] op_sel_hi:[1,0]
    v_pk_fma_f32 v[38:39], v[34:35], v[20:21], v[38:39] op_sel:[1,1,0] op_sel_hi:[0,1,1] neg_lo:[0,1,0]
    ds_write_addtid_b32 v84 offset:8432
    v_cvt_pk_bf16_f32 v85, v30, -v31
    v_pk_mul_f32 v[40:41], v[36:37], v[20:21] op_sel_hi:[1,0]
    v_pk_fma_f32 v[40:41], v[36:37], v[20:21], v[40:41] op_sel:[1,1,0] op_sel_hi:[0,1,1] neg_lo:[0,1,0]
    ds_write_addtid_b32 v85 offset:8704
    v_cvt_pk_bf16_f32 v78, v32, -v33
    v_pk_mul_f32 v[42:43], v[38:39], v[20:21] op_sel_hi:[1,0]
    v_pk_fma_f32 v[42:43], v[38:39], v[20:21], v[42:43] op_sel:[1,1,0] op_sel_hi:[0,1,1] neg_lo:[0,1,0]
    ds_write_addtid_b32 v78 offset:8976
    v_cvt_pk_bf16_f32 v79, v34, -v35
    v_pk_mul_f32 v[44:45], v[40:41], v[20:21] op_sel_hi:[1,0]
    v_pk_fma_f32 v[44:45], v[40:41], v[20:21], v[44:45] op_sel:[1,1,0] op_sel_hi:[0,1,1] neg_lo:[0,1,0]
    ds_write_addtid_b32 v79 offset:9248
    v_cvt_pk_bf16_f32 v80, v36, -v37
    v_pk_mul_f32 v[46:47], v[30:31], v[18:19] op_sel_hi:[1,0]
    v_pk_fma_f32 v[46:47], v[30:31], v[18:19], v[46:47] op_sel:[1,1,0] op_sel_hi:[0,1,1] neg_lo:[0,1,0]
    ds_write_addtid_b32 v80 offset:9520
    v_cvt_pk_bf16_f32 v81, v38, -v39
    v_pk_mul_f32 v[48:49], v[34:35], v[18:19] op_sel_hi:[1,0]
    v_pk_fma_f32 v[48:49], v[34:35], v[18:19], v[48:49] op_sel:[1,1,0] op_sel_hi:[0,1,1] neg_lo:[0,1,0]
    ds_write_addtid_b32 v81 offset:9792
    v_cvt_pk_bf16_f32 v82, v40, -v41
    v_pk_mul_f32 v[50:51], v[38:39], v[18:19] op_sel_hi:[1,0]
    v_pk_fma_f32 v[50:51], v[38:39], v[18:19], v[50:51] op_sel:[1,1,0] op_sel_hi:[0,1,1] neg_lo:[0,1,0]
    ds_write_addtid_b32 v82 offset:10064
    v_cvt_pk_bf16_f32 v83, v42, -v43
    v_pk_mul_f32 v[52:53], v[42:43], v[18:19] op_sel_hi:[1,0]
    v_pk_fma_f32 v[52:53], v[42:43], v[18:19], v[52:53] op_sel:[1,1,0] op_sel_hi:[0,1,1] neg_lo:[0,1,0]
    ds_write_addtid_b32 v83 offset:10336
    v_cvt_pk_bf16_f32 v84, v44, -v45
    v_pk_mul_f32 v[54:55], v[30:31], v[22:23] op_sel_hi:[1,0]
    v_pk_fma_f32 v[54:55], v[30:31], v[22:23], v[54:55] op_sel:[1,1,0] op_sel_hi:[0,1,1] neg_lo:[0,1,0]
    ds_write_addtid_b32 v84 offset:10608
    v_cvt_pk_bf16_f32 v85, v46, -v47
    v_pk_mul_f32 v[56:57], v[38:39], v[22:23] op_sel_hi:[1,0]
    v_pk_fma_f32 v[56:57], v[38:39], v[22:23], v[56:57] op_sel:[1,1,0] op_sel_hi:[0,1,1] neg_lo:[0,1,0]
    ds_write_addtid_b32 v85 offset:10880
    v_cvt_pk_bf16_f32 v78, v48, -v49
    v_pk_mul_f32 v[58:59], v[46:47], v[22:23] op_sel_hi:[1,0]
    v_pk_fma_f32 v[58:59], v[46:47], v[22:23], v[58:59] op_sel:[1,1,0] op_sel_hi:[0,1,1] neg_lo:[0,1,0]
    ds_write_addtid_b32 v78 offset:11152
    v_cvt_pk_bf16_f32 v79, v50, -v51
    v_pk_mul_f32 v[60:61], v[50:51], v[22:23] op_sel_hi:[1,0]
    v_pk_fma_f32 v[60:61], v[50:51], v[22:23], v[60:61] op_sel:[1,1,0] op_sel_hi:[0,1,1] neg_lo:[0,1,0]
    ds_write_addtid_b32 v79 offset:11424
    v_cvt_pk_bf16_f32 v80, v52, -v53
    v_pk_mul_f32 v[30:31], v[54:55], v[22:23] op_sel_hi:[1,0]
    v_pk_fma_f32 v[30:31], v[54:55], v[22:23], v[30:31] op_sel:[1,1,0] op_sel_hi:[0,1,1] neg_lo:[0,1,0]
    ds_write_addtid_b32 v80 offset:11696
    v_cvt_pk_bf16_f32 v81, v54, -v55
    v_pk_mul_f32 v[32:33], v[58:59], v[22:23] op_sel_hi:[1,0]
    v_pk_fma_f32 v[32:33], v[58:59], v[22:23], v[32:33] op_sel:[1,1,0] op_sel_hi:[0,1,1] neg_lo:[0,1,0]
    ds_write_addtid_b32 v81 offset:11968
    v_cvt_pk_bf16_f32 v82, v56, -v57
    v_pk_mul_f32 v[34:35], v[30:31], v[22:23] op_sel_hi:[1,0]
    v_pk_fma_f32 v[34:35], v[30:31], v[22:23], v[34:35] op_sel:[1,1,0] op_sel_hi:[0,1,1] neg_lo:[0,1,0]
    ds_write_addtid_b32 v82 offset:12240
    v_cvt_pk_bf16_f32 v83, v58, -v59
    v_pk_mul_f32 v[36:37], v[32:33], v[22:23] op_sel_hi:[1,0]
    v_pk_fma_f32 v[36:37], v[32:33], v[22:23], v[36:37] op_sel:[1,1,0] op_sel_hi:[0,1,1] neg_lo:[0,1,0]
    ds_write_addtid_b32 v83 offset:12512
    v_cvt_pk_bf16_f32 v84, v60, -v61
    v_pk_mul_f32 v[38:39], v[34:35], v[22:23] op_sel_hi:[1,0]
    v_pk_fma_f32 v[38:39], v[34:35], v[22:23], v[38:39] op_sel:[1,1,0] op_sel_hi:[0,1,1] neg_lo:[0,1,0]
    ds_write_addtid_b32 v84 offset:12784
    v_cvt_pk_bf16_f32 v85, v30, -v31
    ds_write_addtid_b32 v85 offset:13056
    v_cvt_pk_bf16_f32 v78, v32, -v33
    ds_write_addtid_b32 v78 offset:13328
    v_cvt_pk_bf16_f32 v79, v34, -v35
    ds_write_addtid_b32 v79 offset:13600
    v_cvt_pk_bf16_f32 v80, v36, -v37
    ds_write_addtid_b32 v80 offset:13872
    v_cvt_pk_bf16_f32 v81, v38, -v39
    ds_write_addtid_b32 v81 offset:14144
    s_cmp_ge_u32 s36, 4
    s_cbranch_scc1 nw_4
    s_branch Lmw
.p2align 12
.p2align 6
Lmww:
    s_setpc_b64 s[96:97]
    s_nop 0
Lmw:
    s_waitcnt lgkmcnt(0)
    s_barrier
    ds_read_b128 v[100:103], v96 offset:8704
    ds_read_b128 v[104:107], v96 offset:0
    ds_read_b128 v[108:111], v96 offset:8736
    ds_read_b128 v[112:115], v96 offset:32
    ds_read_b128 v[116:119], v96 offset:8768
    ds_read_b128 v[120:123], v96 offset:64
    ds_read_b128 v[124:127], v96 offset:8800
    ds_read_b128 v[128:131], v96 offset:96
    ds_read_b128 v[132:135], v96 offset:8832
    ds_read_b128 v[136:139], v96 offset:128
    ds_read_b128 v[140:143], v96 offset:8864
    ds_read_b128 v[144:147], v96 offset:160
    s_waitcnt lgkmcnt(10)
    v_mfma_f32_32x32x16_bf16 v[8:23], v[100:103], v[104:107], 0
    ds_read_b128 v[148:151], v96 offset:8896
    ds_read_b128 v[152:155], v96 offset:192
    s_lshl_b32 s46, s36, 15
    v_lshl_add_u32 v4, v3, 2, s46
    s_waitcnt lgkmcnt(10)
    v_mfma_f32_32x32x16_bf16 v[8:23], v[108:111], v[112:115], v[8:23]
    ds_read_b128 v[156:159], v96 offset:8928
    ds_read_b128 v[160:163], v96 offset:224
    v_mul_u32_u24 v5, 4224, v2
    v_add_u32_e64 v5, v5, v4
    s_waitcnt lgkmcnt(10)
    v_mfma_f32_32x32x16_bf16 v[8:23], v[116:119], v[120:123], v[8:23]
    ds_read_b128 v[100:103], v96 offset:25088
    ds_read_b128 v[104:107], v96 offset:16384
    v_xor_b32_e64 v7, 1, v2
    v_mul_u32_u24 v44, 128, v2
    s_waitcnt lgkmcnt(10)
    v_mfma_f32_32x32x16_bf16 v[8:23], v[124:127], v[128:131], v[8:23]
    ds_read_b128 v[108:111], v96 offset:25120
    ds_read_b128 v[112:115], v96 offset:16416
    v_add_u32 v44, v44, v4
    v_mul_u32_u24 v45, 2240, v2
    s_waitcnt lgkmcnt(10)
    v_mfma_f32_32x32x16_bf16 v[8:23], v[132:135], v[136:139], v[8:23]
    ds_read_b128 v[116:119], v96 offset:25152
    ds_read_b128 v[120:123], v96 offset:16448
    v_add_u32 v45, v45, v4
    v_mul_u32_u24 v46, 3968, v7
    s_waitcnt lgkmcnt(10)
    v_mfma_f32_32x32x16_bf16 v[8:23], v[140:143], v[144:147], v[8:23]
    ds_read_b128 v[124:127], v96 offset:25184
    ds_read_b128 v[128:131], v96 offset:16480
    v_add_u32 v46, v46, v4
    v_mul_u32_u24 v47, 1856, v7
    s_waitcnt lgkmcnt(10)
    v_mfma_f32_32x32x16_bf16 v[8:23], v[148:151], v[152:155], v[8:23]
    ds_read_b128 v[132:135], v96 offset:25216
    ds_read_b128 v[136:139], v96 offset:16512
    v_add_u32 v47, v47, v4
    v_lshl_add_u32 v48, v2, 9, v4
    s_waitcnt lgkmcnt(10)
    v_mfma_f32_32x32x16_bf16 v[8:23], v[156:159], v[160:163], v[8:23]
    ds_read_b128 v[140:143], v96 offset:25248
    ds_read_b128 v[144:147], v96 offset:16544
    s_waitcnt vmcnt(0)
    v_and_b32 v30, 0xffff, v88
    s_waitcnt lgkmcnt(10)
    v_mfma_f32_32x32x16_bf16 v[8:23], v[100:103], v[104:107], v[8:23]
    ds_read_b128 v[148:151], v96 offset:25280
    ds_read_b128 v[152:155], v96 offset:16576
    v_lshrrev_b32 v31, 16, v88
    v_and_b32 v32, 0xffff, v89
    s_waitcnt lgkmcnt(10)
    v_mfma_f32_32x32x16_bf16 v[8:23], v[108:111], v[112:115], v[8:23]
    ds_read_b128 v[156:159], v96 offset:25312
    ds_read_b128 v[160:163], v96 offset:16608
    v_lshrrev_b32 v33, 16, v89
    v_and_b32 v34, 0xffff, v90
    s_waitcnt lgkmcnt(10)
    v_mfma_f32_32x32x16_bf16 v[8:23], v[116:119], v[120:123], v[8:23]
    v_lshrrev_b32 v35, 16, v90
    v_and_b32 v36, 0xffff, v91
    s_waitcnt lgkmcnt(8)
    v_mfma_f32_32x32x16_bf16 v[8:23], v[124:127], v[128:131], v[8:23]
    v_lshrrev_b32 v37, 16, v91
    v_and_b32 v38, 0xffff, v92
    s_waitcnt lgkmcnt(6)
    v_mfma_f32_32x32x16_bf16 v[8:23], v[132:135], v[136:139], v[8:23]
    v_lshrrev_b32 v39, 16, v92
    v_and_b32 v40, 0xffff, v93
    s_waitcnt lgkmcnt(4)
    v_mfma_f32_32x32x16_bf16 v[8:23], v[140:143], v[144:147], v[8:23]
    v_cmp_ne_u32 s[44:45], 0, v0
    v_lshlrev_b32_e64 v6, 4, v0
    s_waitcnt lgkmcnt(2)
    v_mfma_f32_32x32x16_bf16 v[8:23], v[148:151], v[152:155], v[8:23]
    s_waitcnt lgkmcnt(0)
    v_mfma_f32_32x32x16_bf16 v[8:23], v[156:159], v[160:163], v[8:23]
    s_lshl_b32 s46, s36, 12
    s_add_u32 s46, s46, 98304
    v_lshl_add_u32 v97, v1, 4, s46
    v_xor_b32 v98, 0x1000, v97
    s_lshl_b32 s46, s40, 10
    s_lshl_b32 s47, s39, 15
    s_add_u32 s47, s47, s46
    v_lshl_add_u32 v3, v1, 4, s47
    s_nop 3
    ds_write_b32 v5, v8 offset:0
    ds_write_b32 v5, v9 offset:1056
    ds_write_b32 v5, v10 offset:2112
    ds_write_b32 v5, v11 offset:3168
    ds_write_b32 v44, v12 offset:128
    ds_write_b32 v45, v13 offset:2240
    ds_write_b32 v46, v14 offset:384
    ds_write_b32 v47, v15 offset:4608
    s_mov_b32 exec_hi, 1
    ds_write_b32 v48, v16 offset:512
    s_mov_b32 exec_hi, 0
    ds_write_b32 v48, v17 offset:640
    ds_write_b32 v48, v18 offset:768
    ds_write_b32 v48, v19 offset:896
    s_mov_b32 exec_hi, -1
    s_waitcnt lgkmcnt(0)
    s_barrier
    s_nop 0
    ds_read2st64_b32 v[100:101], v30 offset0:0 offset1:128
    v_add_u32 v30, 0x10000, v30
    ds_read2st64_b32 v[102:103], v31 offset0:0 offset1:128
    v_add_u32 v31, 0x10000, v31
    ds_read2st64_b32 v[104:105], v32 offset0:0 offset1:128
    v_add_u32 v32, 0x10000, v32
    ds_read2st64_b32 v[106:107], v33 offset0:0 offset1:128
    v_add_u32 v33, 0x10000, v33
    ds_read2st64_b32 v[108:109], v34 offset0:0 offset1:128
    v_add_u32 v34, 0x10000, v34
    ds_read2st64_b32 v[110:111], v35 offset0:0 offset1:128
    v_add_u32 v35, 0x10000, v35
    ds_read2st64_b32 v[112:113], v36 offset0:0 offset1:128
    v_add_u32 v36, 0x10000, v36
    ds_read2st64_b32 v[114:115], v37 offset0:0 offset1:128
    v_add_u32 v37, 0x10000, v37
    ds_read2st64_b32 v[116:117], v38 offset0:0 offset1:128
    v_add_u32 v38, 0x10000, v38
    ds_read2st64_b32 v[118:119], v39 offset0:0 offset1:128
    v_add_u32 v39, 0x10000, v39
    ds_read2st64_b32 v[120:121], v40 offset0:0 offset1:128
    v_add_u32 v40, 0x10000, v40
    ds_read2st64_b32 v[122:123], v30 offset0:0 offset1:128
    ds_read2st64_b32 v[124:125], v31 offset0:0 offset1:128
    ds_read2st64_b32 v[126:127], v32 offset0:0 offset1:128
    ds_read2st64_b32 v[128:129], v33 offset0:0 offset1:128
    ds_read2st64_b32 v[130:131], v34 offset0:0 offset1:128
    ds_read2st64_b32 v[132:133], v35 offset0:0 offset1:128
    ds_read2st64_b32 v[134:135], v36 offset0:0 offset1:128
    ds_read2st64_b32 v[136:137], v37 offset0:0 offset1:128
    ds_read2st64_b32 v[138:139], v38 offset0:0 offset1:128
    ds_read2st64_b32 v[140:141], v39 offset0:0 offset1:128
    ds_read2st64_b32 v[142:143], v40 offset0:0 offset1:128
    s_waitcnt lgkmcnt(11)
    v_add_f32 v100, v100, v101
    v_add_f32 v102, v102, v103
    v_add_f32 v104, v104, v105
    v_add_f32 v106, v106, v107
    v_add_f32 v108, v108, v109
    v_add_f32 v110, v110, v111
    v_add_f32 v112, v112, v113
    v_add_f32 v114, v114, v115
    v_add_f32 v116, v116, v117
    v_add_f32 v118, v118, v119
    v_add_f32 v120, v120, v121
    v_cndmask_b32 v100, 0, v100, s[44:45]
    v_cndmask_b32 v102, 0, v102, s[44:45]
    v_cndmask_b32 v104, 0, v104, s[44:45]
    v_cvt_pk_bf16_f32 v44, v106, v108
    v_cvt_pk_bf16_f32 v45, v110, v112
    v_cvt_pk_bf16_f32 v46, v114, v116
    v_cvt_pk_bf16_f32 v47, v118, v120
    ds_write_b128 v6, v[44:47] offset:8768
    v_cvt_pk_bf16_f32 v48, v104, v106
    v_cvt_pk_bf16_f32 v49, v108, v110
    v_cvt_pk_bf16_f32 v50, v112, v114
    v_cvt_pk_bf16_f32 v51, v116, v118
    ds_write_b128 v6, v[48:51] offset:12928
    v_cvt_pk_bf16_f32 v52, v102, v104
    v_cvt_pk_bf16_f32 v53, v106, v108
    v_cvt_pk_bf16_f32 v54, v110, v112
    v_cvt_pk_bf16_f32 v55, v114, v116
    ds_write_b128 v6, v[52:55] offset:17088
    v_cvt_pk_bf16_f32 v56, v100, v102
    v_cvt_pk_bf16_f32 v57, v104, v106
    v_cvt_pk_bf16_f32 v58, v108, v110
    v_cvt_pk_bf16_f32 v59, v112, v114
    ds_write_b128 v6, v[56:59] offset:21248
    s_waitcnt lgkmcnt(4)
    v_add_f32 v122, v122, v123
    v_add_f32 v124, v124, v125
    v_add_f32 v126, v126, v127
    v_add_f32 v128, v128, v129
    v_add_f32 v130, v130, v131
    v_add_f32 v132, v132, v133
    v_add_f32 v134, v134, v135
    v_add_f32 v136, v136, v137
    v_add_f32 v138, v138, v139
    v_add_f32 v140, v140, v141
    v_add_f32 v142, v142, v143
    v_cndmask_b32 v122, 0, v122, s[44:45]
    v_cndmask_b32 v124, 0, v124, s[44:45]
    v_cndmask_b32 v126, 0, v126, s[44:45]
    v_cvt_pk_bf16_f32 v60, v128, v130
    v_cvt_pk_bf16_f32 v61, v132, v134
    v_cvt_pk_bf16_f32 v62, v136, v138
    v_cvt_pk_bf16_f32 v63, v140, v142
    ds_write_b128 v6, v[60:63] offset:41536
    v_cvt_pk_bf16_f32 v64, v126, v128
    v_cvt_pk_bf16_f32 v65, v130, v132
    v_cvt_pk_bf16_f32 v66, v134, v136
    v_cvt_pk_bf16_f32 v67, v138, v140
    ds_write_b128 v6, v[64:67] offset:45696
    v_cvt_pk_bf16_f32 v68, v124, v126
    v_cvt_pk_bf16_f32 v69, v128, v130
    v_cvt_pk_bf16_f32 v70, v132, v134
    v_cvt_pk_bf16_f32 v71, v136, v138
    ds_write_b128 v6, v[68:71] offset:49856
    v_cvt_pk_bf16_f32 v72, v122, v124
    v_cvt_pk_bf16_f32 v73, v126, v128
    v_cvt_pk_bf16_f32 v74, v130, v132
    v_cvt_pk_bf16_f32 v75, v134, v136
    ds_write_b128 v6, v[72:75] offset:54016
    s_waitcnt lgkmcnt(0)
    s_barrier
    s_setprio 3
    s_nop 0
    ds_read_b64 v[40:41], v94 offset:0
    ds_read_b64 v[42:43], v94 offset:8
    ds_read_b128 v[44:47], v95 offset:192
    ds_read_b64 v[48:49], v94 offset:512
    ds_read_b64 v[50:51], v94 offset:520
    ds_read_b128 v[52:55], v95 offset:704
    ds_read_b64 v[56:57], v94 offset:1024
    ds_read_b64 v[58:59], v94 offset:1032
    ds_read_b128 v[60:63], v95 offset:1216
    ds_read_b64 v[64:65], v94 offset:1536
    ds_read_b64 v[66:67], v94 offset:1544
    ds_read_b128 v[68:71], v95 offset:1728
    s_lshl_b32 s46, s37, 2
    s_add_u32 s46, s46, s39
    s_lshl_b32 s46, s46, 12
    s_lshl_b32 s47, s40, 9
    s_add_u32 s46, s46, s47
    s_add_u32 s46, s46, 10489856
    v_and_b32 v4, 15, v0
    v_bfe_u32 v5, v0, 4, 2
    v_lshlrev_b32 v4, 5, v4
    v_lshrrev_b32 v6, 1, v5
    v_lshl_add_u32 v4, v6, 4, v4
    v_and_b32_e64 v5, 1, v5
    v_lshl_add_u32 v4, v5, 10, v4
    v_add_u32 v99, s46, v4
    s_waitcnt lgkmcnt(9)
    v_mfma_f32_16x16x32_bf16 v[8:11], v[40:43], v[44:47], 0
    ds_read_b64 v[72:73], v94 offset:2048
    s_waitcnt lgkmcnt(7)
    s_nop 0
    v_mfma_f32_16x16x32_bf16 v[12:15], v[40:43], v[52:55], 0
    ds_read_b64 v[74:75], v94 offset:2056
    v_mfma_f32_16x16x32_bf16 v[12:15], v[48:51], v[44:47], v[12:15]
    ds_read_b128 v[76:79], v95 offset:2240
    v_mfma_f32_16x16x32_bf16 v[16:19], v[48:51], v[52:55], 0
    ds_read_b64 v[80:81], v94 offset:2560
    s_waitcnt lgkmcnt(7)
    s_nop 0
    v_mfma_f32_16x16x32_bf16 v[16:19], v[40:43], v[60:63], v[16:19]
    ds_read_b64 v[82:83], v94 offset:2568
    v_mfma_f32_16x16x32_bf16 v[20:23], v[48:51], v[60:63], 0
    ds_read_b128 v[84:87], v95 offset:2752
    v_mfma_f32_16x16x32_bf16 v[16:19], v[56:59], v[44:47], v[16:19]
    ds_read_b64 v[100:101], v94 offset:3072
    v_mfma_f32_16x16x32_bf16 v[20:23], v[56:59], v[52:55], v[20:23]
    ds_read_b64 v[102:103], v94 offset:3080
    v_mfma_f32_16x16x32_bf16 v[24:27], v[56:59], v[60:63], 0
    ds_read_b128 v[104:107], v95 offset:3264
    s_waitcnt lgkmcnt(9)
    s_nop 0
    v_mfma_f32_16x16x32_bf16 v[20:23], v[40:43], v[68:71], v[20:23]
    ds_read_b64 v[108:109], v94 offset:3584
    v_mfma_f32_16x16x32_bf16 v[24:27], v[48:51], v[68:71], v[24:27]
    ds_read_b64 v[110:111], v94 offset:3592
    v_mfma_f32_16x16x32_bf16 v[28:31], v[56:59], v[68:71], 0
    ds_read_b128 v[112:115], v95 offset:3776
    v_mfma_f32_16x16x32_bf16 v[20:23], v[64:67], v[44:47], v[20:23]
    v_mfma_f32_16x16x32_bf16 v[24:27], v[64:67], v[52:55], v[24:27]
    v_mfma_f32_16x16x32_bf16 v[28:31], v[64:67], v[60:63], v[28:31]
    v_mfma_f32_16x16x32_bf16 v[32:35], v[64:67], v[68:71], 0
    s_waitcnt lgkmcnt(6)
    s_nop 0
    v_mfma_f32_16x16x32_bf16 v[24:27], v[40:43], v[76:79], v[24:27]
    ds_read_b64 v[116:117], v94 offset:64
    v_mfma_f32_16x16x32_bf16 v[28:31], v[48:51], v[76:79], v[28:31]
    ds_read_b64 v[118:119], v94 offset:72
    v_mfma_f32_16x16x32_bf16 v[32:35], v[56:59], v[76:79], v[32:35]
    ds_read_b128 v[120:123], v95 offset:128
    v_mfma_f32_16x16x32_bf16 v[36:39], v[64:67], v[76:79], 0
    v_mfma_f32_16x16x32_bf16 v[24:27], v[72:75], v[44:47], v[24:27]
    v_mfma_f32_16x16x32_bf16 v[28:31], v[72:75], v[52:55], v[28:31]
    v_mfma_f32_16x16x32_bf16 v[32:35], v[72:75], v[60:63], v[32:35]
    v_mfma_f32_16x16x32_bf16 v[36:39], v[72:75], v[68:71], v[36:39]
    v_mfma_f32_16x16x32_bf16 v[28:31], v[40:43], v[84:87], v[28:31]
    ds_read_b64 v[124:125], v94 offset:576
    v_mfma_f32_16x16x32_bf16 v[32:35], v[48:51], v[84:87], v[32:35]
    ds_read_b64 v[126:127], v94 offset:584
    v_mfma_f32_16x16x32_bf16 v[36:39], v[56:59], v[84:87], v[36:39]
    ds_read_b128 v[128:131], v95 offset:640
    v_mfma_f32_16x16x32_bf16 v[28:31], v[80:83], v[44:47], v[28:31]
    v_mfma_f32_16x16x32_bf16 v[32:35], v[80:83], v[52:55], v[32:35]
    v_mfma_f32_16x16x32_bf16 v[36:39], v[80:83], v[60:63], v[36:39]
    s_waitcnt lgkmcnt(6)
    s_nop 0
    v_mfma_f32_16x16x32_bf16 v[32:35], v[40:43], v[104:107], v[32:35]
    ds_read_b64 v[132:133], v94 offset:1088
    v_mfma_f32_16x16x32_bf16 v[36:39], v[48:51], v[104:107], v[36:39]
    ds_read_b64 v[134:135], v94 offset:1096
    v_mfma_f32_16x16x32_bf16 v[32:35], v[100:103], v[44:47], v[32:35]
    ds_read_b128 v[136:139], v95 offset:1152
    v_mfma_f32_16x16x32_bf16 v[36:39], v[100:103], v[52:55], v[36:39]
    v_mfma_f32_16x16x32_bf16 v[36:39], v[40:43], v[112:115], v[36:39]
    ds_read_b64 v[140:141], v94 offset:1600
    v_mfma_f32_16x16x32_bf16 v[36:39], v[108:111], v[44:47], v[36:39]
    ds_read_b64 v[142:143], v94 offset:1608
    s_waitcnt lgkmcnt(5)
    s_nop 0
    v_mfma_f32_16x16x32_bf16 v[8:11], v[116:119], v[120:123], v[8:11]
    ds_read_b128 v[144:147], v95 offset:1664
    v_mfma_f32_16x16x32_bf16 v[12:15], v[116:119], v[128:131], v[12:15]
    ds_read_b64 v[40:41], v94 offset:2112
    v_mfma_f32_16x16x32_bf16 v[12:15], v[124:127], v[120:123], v[12:15]
    ds_read_b64 v[42:43], v94 offset:2120
    v_mfma_f32_16x16x32_bf16 v[16:19], v[124:127], v[128:131], v[16:19]
    ds_read_b128 v[44:47], v95 offset:2176
    s_waitcnt lgkmcnt(3)
    s_nop 0
    v_mfma_f32_16x16x32_bf16 v[16:19], v[116:119], v[136:139], v[16:19]
    ds_read_b64 v[48:49], v94 offset:2624
    v_mfma_f32_16x16x32_bf16 v[20:23], v[124:127], v[136:139], v[20:23]
    ds_read_b64 v[50:51], v94 offset:2632
    v_mfma_f32_16x16x32_bf16 v[16:19], v[132:135], v[120:123], v[16:19]
    ds_read_b128 v[52:55], v95 offset:2688
    v_mfma_f32_16x16x32_bf16 v[20:23], v[132:135], v[128:131], v[20:23]
    ds_read_b64 v[56:57], v94 offset:3136
    v_mfma_f32_16x16x32_bf16 v[24:27], v[132:135], v[136:139], v[24:27]
    ds_read_b64 v[58:59], v94 offset:3144
    v_mfma_f32_16x16x32_bf16 v[20:23], v[116:119], v[144:147], v[20:23]
    ds_read_b128 v[60:63], v95 offset:3200
    v_mfma_f32_16x16x32_bf16 v[24:27], v[124:127], v[144:147], v[24:27]
    ds_read_b64 v[64:65], v94 offset:3648
    v_mfma_f32_16x16x32_bf16 v[28:31], v[132:135], v[144:147], v[28:31]
    ds_read_b64 v[66:67], v94 offset:3656
    v_mfma_f32_16x16x32_bf16 v[20:23], v[140:143], v[120:123], v[20:23]
    ds_read_b128 v[68:71], v95 offset:3712
    v_mfma_f32_16x16x32_bf16 v[24:27], v[140:143], v[128:131], v[24:27]
    v_mfma_f32_16x16x32_bf16 v[28:31], v[140:143], v[136:139], v[28:31]
    v_mfma_f32_16x16x32_bf16 v[32:35], v[140:143], v[144:147], v[32:35]
    s_waitcnt lgkmcnt(6)
    s_nop 0
    v_mfma_f32_16x16x32_bf16 v[24:27], v[116:119], v[44:47], v[24:27]
    ds_read_b64 v[72:73], v94 offset:128
    v_mfma_f32_16x16x32_bf16 v[28:31], v[124:127], v[44:47], v[28:31]
    ds_read_b64 v[74:75], v94 offset:136
    v_mfma_f32_16x16x32_bf16 v[32:35], v[132:135], v[44:47], v[32:35]
    ds_read_b128 v[76:79], v95 offset:64
    v_mfma_f32_16x16x32_bf16 v[36:39], v[140:143], v[44:47], v[36:39]
    v_mfma_f32_16x16x32_bf16 v[24:27], v[40:43], v[120:123], v[24:27]
    v_mfma_f32_16x16x32_bf16 v[28:31], v[40:43], v[128:131], v[28:31]
    v_mfma_f32_16x16x32_bf16 v[32:35], v[40:43], v[136:139], v[32:35]
    v_mfma_f32_16x16x32_bf16 v[36:39], v[40:43], v[144:147], v[36:39]
    v_mfma_f32_16x16x32_bf16 v[28:31], v[116:119], v[52:55], v[28:31]
    ds_read_b64 v[80:81], v94 offset:640
    v_mfma_f32_16x16x32_bf16 v[32:35], v[124:127], v[52:55], v[32:35]
    ds_read_b64 v[82:83], v94 offset:648
    v_mfma_f32_16x16x32_bf16 v[36:39], v[132:135], v[52:55], v[36:39]
    ds_read_b128 v[84:87], v95 offset:576
    v_mfma_f32_16x16x32_bf16 v[28:31], v[48:51], v[120:123], v[28:31]
    v_mfma_f32_16x16x32_bf16 v[32:35], v[48:51], v[128:131], v[32:35]
    v_mfma_f32_16x16x32_bf16 v[36:39], v[48:51], v[136:139], v[36:39]
    s_waitcnt lgkmcnt(6)
    s_nop 0
    v_mfma_f32_16x16x32_bf16 v[32:35], v[116:119], v[60:63], v[32:35]
    ds_read_b64 v[100:101], v94 offset:1152
    v_mfma_f32_16x16x32_bf16 v[36:39], v[124:127], v[60:63], v[36:39]
    ds_read_b64 v[102:103], v94 offset:1160
    v_mfma_f32_16x16x32_bf16 v[32:35], v[56:59], v[120:123], v[32:35]
    ds_read_b128 v[104:107], v95 offset:1088
    v_mfma_f32_16x16x32_bf16 v[36:39], v[56:59], v[128:131], v[36:39]
    v_mfma_f32_16x16x32_bf16 v[36:39], v[116:119], v[68:71], v[36:39]
    ds_read_b64 v[108:109], v94 offset:1664
    v_mfma_f32_16x16x32_bf16 v[36:39], v[64:67], v[120:123], v[36:39]
    ds_read_b64 v[110:111], v94 offset:1672
    s_waitcnt lgkmcnt(5)
    s_nop 0
    v_mfma_f32_16x16x32_bf16 v[8:11], v[72:75], v[76:79], v[8:11]
    ds_read_b128 v[112:115], v95 offset:1600
    v_mfma_f32_16x16x32_bf16 v[12:15], v[72:75], v[84:87], v[12:15]
    ds_read_b64 v[116:117], v94 offset:2176
    v_mfma_f32_16x16x32_bf16 v[12:15], v[80:83], v[76:79], v[12:15]
    ds_read_b64 v[118:119], v94 offset:2184
    v_mfma_f32_16x16x32_bf16 v[16:19], v[80:83], v[84:87], v[16:19]
    ds_read_b128 v[120:123], v95 offset:2112
    s_waitcnt lgkmcnt(3)
    s_nop 0
    v_mfma_f32_16x16x32_bf16 v[16:19], v[72:75], v[104:107], v[16:19]
    ds_read_b64 v[124:125], v94 offset:2688
    v_mfma_f32_16x16x32_bf16 v[20:23], v[80:83], v[104:107], v[20:23]
    ds_read_b64 v[126:127], v94 offset:2696
    v_mfma_f32_16x16x32_bf16 v[16:19], v[100:103], v[76:79], v[16:19]
    ds_read_b128 v[128:131], v95 offset:2624
    v_mfma_f32_16x16x32_bf16 v[20:23], v[100:103], v[84:87], v[20:23]
    ds_read_b64 v[132:133], v94 offset:3200
    v_mfma_f32_16x16x32_bf16 v[24:27], v[100:103], v[104:107], v[24:27]
    ds_read_b64 v[134:135], v94 offset:3208
    v_mfma_f32_16x16x32_bf16 v[20:23], v[72:75], v[112:115], v[20:23]
    ds_read_b128 v[136:139], v95 offset:3136
    v_mfma_f32_16x16x32_bf16 v[24:27], v[80:83], v[112:115], v[24:27]
    ds_read_b64 v[140:141], v94 offset:3712
    v_mfma_f32_16x16x32_bf16 v[28:31], v[100:103], v[112:115], v[28:31]
    ds_read_b64 v[142:143], v94 offset:3720
    v_mfma_f32_16x16x32_bf16 v[20:23], v[108:111], v[76:79], v[20:23]
    ds_read_b128 v[144:147], v95 offset:3648
    v_mfma_f32_16x16x32_bf16 v[24:27], v[108:111], v[84:87], v[24:27]
    v_mfma_f32_16x16x32_bf16 v[28:31], v[108:111], v[104:107], v[28:31]
    v_mfma_f32_16x16x32_bf16 v[32:35], v[108:111], v[112:115], v[32:35]
    s_waitcnt lgkmcnt(6)
    s_nop 0
    v_mfma_f32_16x16x32_bf16 v[24:27], v[72:75], v[120:123], v[24:27]
    ds_read_b64 v[40:41], v94 offset:192
    v_mfma_f32_16x16x32_bf16 v[28:31], v[80:83], v[120:123], v[28:31]
    ds_read_b64 v[42:43], v94 offset:200
    v_mfma_f32_16x16x32_bf16 v[32:35], v[100:103], v[120:123], v[32:35]
    ds_read_b128 v[44:47], v95 offset:0
    v_mfma_f32_16x16x32_bf16 v[36:39], v[108:111], v[120:123], v[36:39]
    v_mfma_f32_16x16x32_bf16 v[24:27], v[116:119], v[76:79], v[24:27]
    v_mfma_f32_16x16x32_bf16 v[28:31], v[116:119], v[84:87], v[28:31]
    v_mfma_f32_16x16x32_bf16 v[32:35], v[116:119], v[104:107], v[32:35]
    v_mfma_f32_16x16x32_bf16 v[36:39], v[116:119], v[112:115], v[36:39]
    v_mfma_f32_16x16x32_bf16 v[28:31], v[72:75], v[128:131], v[28:31]
    ds_read_b64 v[48:49], v94 offset:704
    v_mfma_f32_16x16x32_bf16 v[32:35], v[80:83], v[128:131], v[32:35]
    ds_read_b64 v[50:51], v94 offset:712
    v_mfma_f32_16x16x32_bf16 v[36:39], v[100:103], v[128:131], v[36:39]
    ds_read_b128 v[52:55], v95 offset:512
    v_mfma_f32_16x16x32_bf16 v[28:31], v[124:127], v[76:79], v[28:31]
    v_mfma_f32_16x16x32_bf16 v[32:35], v[124:127], v[84:87], v[32:35]
    v_mfma_f32_16x16x32_bf16 v[36:39], v[124:127], v[104:107], v[36:39]
    s_waitcnt lgkmcnt(6)
    s_nop 0
    v_mfma_f32_16x16x32_bf16 v[32:35], v[72:75], v[136:139], v[32:35]
    ds_read_b64 v[56:57], v94 offset:1216
    v_mfma_f32_16x16x32_bf16 v[36:39], v[80:83], v[136:139], v[36:39]
    ds_read_b64 v[58:59], v94 offset:1224
    v_mfma_f32_16x16x32_bf16 v[32:35], v[132:135], v[76:79], v[32:35]
    ds_read_b128 v[60:63], v95 offset:1024
    v_mfma_f32_16x16x32_bf16 v[36:39], v[132:135], v[84:87], v[36:39]
    v_mfma_f32_16x16x32_bf16 v[36:39], v[72:75], v[144:147], v[36:39]
    ds_read_b64 v[64:65], v94 offset:1728
    v_mfma_f32_16x16x32_bf16 v[36:39], v[140:143], v[76:79], v[36:39]
    ds_read_b64 v[66:67], v94 offset:1736
    s_waitcnt lgkmcnt(5)
    s_nop 0
    v_mfma_f32_16x16x32_bf16 v[8:11], v[40:43], v[44:47], v[8:11]
    ds_read_b128 v[68:71], v95 offset:1536
    v_mfma_f32_16x16x32_bf16 v[12:15], v[40:43], v[52:55], v[12:15]
    ds_read_b64 v[72:73], v94 offset:2240
    v_mfma_f32_16x16x32_bf16 v[12:15], v[48:51], v[44:47], v[12:15]
    ds_read_b64 v[74:75], v94 offset:2248
    v_mfma_f32_16x16x32_bf16 v[16:19], v[48:51], v[52:55], v[16:19]
    ds_read_b128 v[76:79], v95 offset:2048
    s_waitcnt lgkmcnt(3)
    s_nop 0
    v_mfma_f32_16x16x32_bf16 v[16:19], v[40:43], v[60:63], v[16:19]
    ds_read_b64 v[80:81], v94 offset:2752
    v_mfma_f32_16x16x32_bf16 v[20:23], v[48:51], v[60:63], v[20:23]
    ds_read_b64 v[82:83], v94 offset:2760
    v_mfma_f32_16x16x32_bf16 v[16:19], v[56:59], v[44:47], v[16:19]
    ds_read_b128 v[84:87], v95 offset:2560
    v_mfma_f32_16x16x32_bf16 v[20:23], v[56:59], v[52:55], v[20:23]
    ds_read_b64 v[100:101], v94 offset:3264
    v_mfma_f32_16x16x32_bf16 v[24:27], v[56:59], v[60:63], v[24:27]
    ds_read_b64 v[102:103], v94 offset:3272
    v_mfma_f32_16x16x32_bf16 v[20:23], v[40:43], v[68:71], v[20:23]
    ds_read_b128 v[104:107], v95 offset:3072
    v_mfma_f32_16x16x32_bf16 v[24:27], v[48:51], v[68:71], v[24:27]
    ds_read_b64 v[108:109], v94 offset:3776
    v_mfma_f32_16x16x32_bf16 v[28:31], v[56:59], v[68:71], v[28:31]
    ds_read_b64 v[110:111], v94 offset:3784
    v_mfma_f32_16x16x32_bf16 v[20:23], v[64:67], v[44:47], v[20:23]
    ds_read_b128 v[112:115], v95 offset:3584
    v_mfma_f32_16x16x32_bf16 v[24:27], v[64:67], v[52:55], v[24:27]
    v_mfma_f32_16x16x32_bf16 v[28:31], v[64:67], v[60:63], v[28:31]
    v_mfma_f32_16x16x32_bf16 v[32:35], v[64:67], v[68:71], v[32:35]
    s_cmp_eq_u32 s40, 1
    s_cbranch_scc1 odd_10
    s_waitcnt lgkmcnt(9)
    s_nop 0
    v_mfma_f32_16x16x32_bf16 v[28:31], v[48:51], v[76:79], v[28:31]
    v_mfma_f32_16x16x32_bf16 v[36:39], v[64:67], v[76:79], v[36:39]
    ds_write_b128 v97, v[12:15] offset:0
    v_mfma_f32_16x16x32_bf16 v[28:31], v[72:75], v[52:55], v[28:31]
    v_mfma_f32_16x16x32_bf16 v[36:39], v[72:75], v[68:71], v[36:39]
    ds_write_b128 v97, v[20:23] offset:1024
    s_waitcnt lgkmcnt(2)
    s_nop 0
    v_mfma_f32_16x16x32_bf16 v[28:31], v[40:43], v[84:87], v[28:31]
    v_mfma_f32_16x16x32_bf16 v[36:39], v[56:59], v[84:87], v[36:39]
    v_mfma_f32_16x16x32_bf16 v[28:31], v[80:83], v[44:47], v[28:31]
    v_mfma_f32_16x16x32_bf16 v[36:39], v[80:83], v[60:63], v[36:39]
    v_mfma_f32_16x16x32_bf16 v[36:39], v[48:51], v[104:107], v[36:39]
    v_mfma_f32_16x16x32_bf16 v[36:39], v[100:103], v[52:55], v[36:39]
    v_mfma_f32_16x16x32_bf16 v[36:39], v[40:43], v[112:115], v[36:39]
    v_mfma_f32_16x16x32_bf16 v[36:39], v[108:111], v[44:47], v[36:39]
    v_mfma_f32_16x16x32_bf16 v[24:27], v[40:43], v[76:79], v[24:27]
    v_mfma_f32_16x16x32_bf16 v[32:35], v[56:59], v[76:79], v[32:35]
    v_mfma_f32_16x16x32_bf16 v[24:27], v[72:75], v[44:47], v[24:27]
    ds_write_b128 v97, v[28:31] offset:2048
    v_mfma_f32_16x16x32_bf16 v[32:35], v[72:75], v[60:63], v[32:35]
    v_mfma_f32_16x16x32_bf16 v[32:35], v[48:51], v[84:87], v[32:35]
    v_mfma_f32_16x16x32_bf16 v[32:35], v[80:83], v[52:55], v[32:35]
    v_mfma_f32_16x16x32_bf16 v[32:35], v[40:43], v[104:107], v[32:35]
    v_mfma_f32_16x16x32_bf16 v[32:35], v[100:103], v[44:47], v[32:35]
    ds_write_b128 v97, v[36:39] offset:3072
    s_waitcnt lgkmcnt(0)
    s_barrier
    ds_read_b128 v[148:151], v98 offset:0
    ds_read_b128 v[116:119], v3 offset:0
    ds_read_b128 v[152:155], v98 offset:1024
    ds_read_b128 v[120:123], v3 offset:2048
    ds_read_b128 v[156:159], v98 offset:2048
    ds_read_b128 v[124:127], v3 offset:4096
    ds_read_b128 v[160:163], v98 offset:3072
    ds_read_b128 v[128:131], v3 offset:6144
    s_waitcnt lgkmcnt(6)
    s_nop 0
    v_pk_add_f32 v[148:149], v[148:149], v[116:117]
    v_pk_add_f32 v[150:151], v[150:151], v[118:119]
    v_pk_add_f32 v[148:149], v[148:149], v[8:9]
    v_pk_add_f32 v[150:151], v[150:151], v[10:11]
    v_cvt_pk_bf16_f32 v132, v148, v149
    v_cvt_pk_bf16_f32 v133, v150, v151
    s_waitcnt lgkmcnt(4)
    s_nop 0
    v_pk_add_f32 v[152:153], v[152:153], v[120:121]
    v_pk_add_f32 v[154:155], v[154:155], v[122:123]
    v_pk_add_f32 v[152:153], v[152:153], v[16:17]
    v_pk_add_f32 v[154:155], v[154:155], v[18:19]
    v_cvt_pk_bf16_f32 v134, v152, v153
    v_cvt_pk_bf16_f32 v135, v154, v155
    s_nop 0
    v_permlane16_swap_b32 v132, v134
    v_permlane16_swap_b32 v133, v135
    global_store_dwordx4 v99, v[132:135], s[30:31] offset:0 sc0 sc1
    s_waitcnt lgkmcnt(2)
    v_pk_add_f32 v[156:157], v[156:157], v[124:125]
    v_pk_add_f32 v[158:159], v[158:159], v[126:127]
    v_pk_add_f32 v[156:157], v[156:157], v[24:25]
    v_pk_add_f32 v[158:159], v[158:159], v[26:27]
    v_cvt_pk_bf16_f32 v136, v156, v157
    v_cvt_pk_bf16_f32 v137, v158, v159
    s_waitcnt lgkmcnt(0)
    s_nop 0
    v_pk_add_f32 v[160:161], v[160:161], v[128:129]
    v_pk_add_f32 v[162:163], v[162:163], v[130:131]
    v_pk_add_f32 v[160:161], v[160:161], v[32:33]
    v_pk_add_f32 v[162:163], v[162:163], v[34:35]
    v_cvt_pk_bf16_f32 v138, v160, v161
    v_cvt_pk_bf16_f32 v139, v162, v163
    s_nop 0
    v_permlane16_swap_b32 v136, v138
    v_permlane16_swap_b32 v137, v139
    global_store_dwordx4 v99, v[136:139], s[30:31] offset:2048 sc0 sc1
    s_branch jn_11
.p2align 6
odd_10w:
    s_setpc_b64 s[96:97]
    s_nop 0
odd_10:
    s_waitcnt lgkmcnt(9)
    s_nop 0
    v_mfma_f32_16x16x32_bf16 v[24:27], v[40:43], v[76:79], v[24:27]
    v_mfma_f32_16x16x32_bf16 v[32:35], v[56:59], v[76:79], v[32:35]
    ds_write_b128 v97, v[8:11] offset:0
    v_mfma_f32_16x16x32_bf16 v[24:27], v[72:75], v[44:47], v[24:27]
    v_mfma_f32_16x16x32_bf16 v[32:35], v[72:75], v[60:63], v[32:35]
    ds_write_b128 v97, v[16:19] offset:1024
    s_waitcnt lgkmcnt(2)
    s_nop 0
    v_mfma_f32_16x16x32_bf16 v[32:35], v[48:51], v[84:87], v[32:35]
    v_mfma_f32_16x16x32_bf16 v[32:35], v[80:83], v[52:55], v[32:35]
    v_mfma_f32_16x16x32_bf16 v[32:35], v[40:43], v[104:107], v[32:35]
    v_mfma_f32_16x16x32_bf16 v[32:35], v[100:103], v[44:47], v[32:35]
    v_mfma_f32_16x16x32_bf16 v[28:31], v[48:51], v[76:79], v[28:31]
    v_mfma_f32_16x16x32_bf16 v[36:39], v[64:67], v[76:79], v[36:39]
    v_mfma_f32_16x16x32_bf16 v[28:31], v[72:75], v[52:55], v[28:31]
    ds_write_b128 v97, v[24:27] offset:2048
    v_mfma_f32_16x16x32_bf16 v[36:39], v[72:75], v[68:71], v[36:39]
    v_mfma_f32_16x16x32_bf16 v[28:31], v[40:43], v[84:87], v[28:31]
    v_mfma_f32_16x16x32_bf16 v[36:39], v[56:59], v[84:87], v[36:39]
    v_mfma_f32_16x16x32_bf16 v[28:31], v[80:83], v[44:47], v[28:31]
    v_mfma_f32_16x16x32_bf16 v[36:39], v[80:83], v[60:63], v[36:39]
    ds_write_b128 v97, v[32:35] offset:3072
    v_mfma_f32_16x16x32_bf16 v[36:39], v[48:51], v[104:107], v[36:39]
    v_mfma_f32_16x16x32_bf16 v[36:39], v[100:103], v[52:55], v[36:39]
    v_mfma_f32_16x16x32_bf16 v[36:39], v[40:43], v[112:115], v[36:39]
    v_mfma_f32_16x16x32_bf16 v[36:39], v[108:111], v[44:47], v[36:39]
    s_waitcnt lgkmcnt(0)
    s_barrier
    ds_read_b128 v[148:151], v98 offset:0
    ds_read_b128 v[116:119], v3 offset:0
    ds_read_b128 v[152:155], v98 offset:1024
    ds_read_b128 v[120:123], v3 offset:2048
    ds_read_b128 v[156:159], v98 offset:2048
    ds_read_b128 v[124:127], v3 offset:4096
    ds_read_b128 v[160:163], v98 offset:3072
    ds_read_b128 v[128:131], v3 offset:6144
    s_waitcnt lgkmcnt(6)
    s_nop 0
    v_pk_add_f32 v[148:149], v[148:149], v[116:117]
    v_pk_add_f32 v[150:151], v[150:151], v[118:119]
    v_pk_add_f32 v[148:149], v[148:149], v[12:13]
    v_pk_add_f32 v[150:151], v[150:151], v[14:15]
    v_cvt_pk_bf16_f32 v132, v148, v149
    v_cvt_pk_bf16_f32 v133, v150, v151
    s_waitcnt lgkmcnt(4)
    s_nop 0
    v_pk_add_f32 v[152:153], v[152:153], v[120:121]
    v_pk_add_f32 v[154:155], v[154:155], v[122:123]
    v_pk_add_f32 v[152:153], v[152:153], v[20:21]
    v_pk_add_f32 v[154:155], v[154:155], v[22:23]
    v_cvt_pk_bf16_f32 v134, v152, v153
    v_cvt_pk_bf16_f32 v135, v154, v155
    s_nop 0
    v_permlane16_swap_b32 v132, v134
    v_permlane16_swap_b32 v133, v135
    global_store_dwordx4 v99, v[132:135], s[30:31] offset:0 sc0 sc1
    s_waitcnt lgkmcnt(2)
    v_pk_add_f32 v[156:157], v[156:157], v[124:125]
    v_pk_add_f32 v[158:159], v[158:159], v[126:127]
    v_pk_add_f32 v[156:157], v[156:157], v[28:29]
    v_pk_add_f32 v[158:159], v[158:159], v[30:31]
    v_cvt_pk_bf16_f32 v136, v156, v157
    v_cvt_pk_bf16_f32 v137, v158, v159
    s_waitcnt lgkmcnt(0)
    s_nop 0
    v_pk_add_f32 v[160:161], v[160:161], v[128:129]
    v_pk_add_f32 v[162:163], v[162:163], v[130:131]
    v_pk_add_f32 v[160:161], v[160:161], v[36:37]
    v_pk_add_f32 v[162:163], v[162:163], v[38:39]
    v_cvt_pk_bf16_f32 v138, v160, v161
    v_cvt_pk_bf16_f32 v139, v162, v163
    s_nop 0
    v_permlane16_swap_b32 v136, v138
    v_permlane16_swap_b32 v137, v139
    global_store_dwordx4 v99, v[136:139], s[30:31] offset:2048 sc0 sc1
jn_11:
    s_and_b32 s37, s2, 7
    s_lshr_b32 s38, s2, 3
    s_and_b32 s40, s38, 3
    s_lshr_b32 s39, s37, 1
    s_lshl_b32 s39, s39, 2
    s_add_u32 s39, s39, s40
    s_and_b32 s34, s37, 1
    s_lshr_b32 s35, s38, 2
    s_mul_i32 s38, s34, 7
    s_add_u32 s38, s38, s35
    s_mul_i32 s33, s40, 3
    s_lshl_b32 s37, s35, 1
    s_add_u32 s33, s33, s37
    s_cmp_ge_u32 s33, 14
    s_cselect_b32 s37, 14, 0
    s_sub_u32 s33, s33, s37
    s_and_b32 s40, s36, 1
    s_bfe_u32 s41, s36, 0x10001
    s_lshr_b32 s49, s36, 2
    v_bfe_u32 v2, v1, 2, 2
    v_bfe_u32 v3, v1, 4, 1
    v_lshrrev_b32 v4, 5, v1
    v_and_b32_e64 v6, 3, v1
    v_lshl_add_u32 v5, v4, 3, v2
    v_lshlrev_b32_e64 v7, 8, v5
    v_lshl_add_u32 v7, v6, 3, v7
    v_lshl_add_u32 v7, v3, 5, v7
    s_lshl_b32 s42, s40, 1
    s_add_u32 s42, s42, s41
    v_xor_b32_e64 v8, s42, v2
    v_lshl_add_u32 v8, v8, 6, v7
    v_xor_b32_e64 v9, 64, v8
    v_add_u32 v17, 0x10000, v8
    v_add_u32 v46, 0x10000, v9
    s_lshl_b32 s42, s34, 1
    s_add_u32 s42, s42, s40
    v_xor_b32_e64 v18, s42, v2
    v_lshl_add_u32 v18, v18, 6, v7
    v_lshlrev_b32_e64 v7, 7, v5
    v_lshl_add_u32 v7, v6, 3, v7
    v_lshl_add_u32 v7, v3, 12, v7
    v_lshrrev_b32_e64 v5, 1, v2
    v_lshl_add_u32 v5, v3, 1, v5
    s_lshl_b32 s42, s41, 1
    v_xor_b32 v5, s42, v5
    v_lshl_add_u32 v7, v5, 5, v7
    v_add_u32 v10, 98304, v7
    v_xor_b32 v11, 32, v10
    s_lshl_b32 s42, s39, 2
    s_lshl_b32 s43, s40, 1
    s_add_u32 s42, s42, s43
    s_add_u32 s43, s42, s41
    s_xor_b32 s44, s43, 1
    s_lshl_b32 s45, s38, 3
    s_lshl_b32 s46, s41, 1
    s_add_u32 s45, s45, s46
    s_lshl_b32 s46, s49, 2
    s_add_u32 s45, s45, s46
    s_lshl_b32 s46, s45, 7
    s_add_u32 s45, s45, 2048
    s_mul_i32 s43, s43, 112
    s_mul_i32 s44, s44, 112
    s_add_u32 s43, s43, s45
    s_add_u32 s44, s44, s45
    s_lshl_b32 s43, s43, 10
    s_lshl_b32 s44, s44, 10
    v_lshl_add_u32 v12, v1, 4, s43
    v_lshl_add_u32 v13, v1, 4, s44
    v_and_b32_e64 v5, 15, v1
    v_mul_u32_u24 v7, 14336, v3
    v_lshl_add_u32 v5, v5, 3, v7
    s_add_u32 s46, s46, 32768
    v_add_u32 v16, s46, v5
    v_and_b32_e64 v5, 31, v1
    s_lshl_b32 s42, s40, 1
    s_add_u32 s42, s42, s41
    s_lshl_b32 s43, s42, 9
    s_add_u32 s43, s43, 155648
    v_lshl_add_u32 v14, v5, 4, s43
    v_xor_b32 v15, 512, v14
    s_lshl_b32 s43, s39, 11
    s_lshl_b32 s44, s41, 8
    s_add_u32 s43, s43, s44
    s_add_u32 s43, s43, 14680064
    s_lshl_b32 s44, s34, 10
    s_add_u32 s59, s43, s44
    s_lshl_b32 s44, s40, 10
    s_add_u32 s58, s43, s44
    s_lshl_b32 s44, s49, 9
    s_add_u32 s58, s58, s44
    v_mov_b32 v36, 0
    v_mov_b32 v37, 0
    v_mov_b32 v40, 0
    v_mov_b32 v41, 0
    v_mov_b32 v44, 0
    v_mov_b32_e64 v45, 0
    v_cmp_eq_u32 s[52:53], 0, v4
    s_mov_b32 s47, 0x3f803f80
    s_mov_b32 s48, 0xffff0000
    s_waitcnt vmcnt(0)
    s_barrier
    s_lshl_b32 s43, s35, 1
    s_add_u32 s43, s43, s41
    s_sub_u32 s43, s43, s38
    s_cselect_b32 s44, 14, 0
    s_add_u32 s43, s43, s44
    s_cmp_ge_u32 s43, 12
    s_cselect_b32 s44, 0, 0
    s_add_u32 s43, s43, s44
    s_lshl_b32 s43, s43, 13
    v_add_u32 v18, s43, v18
    v_lshlrev_b32 v7, 3, v4
    v_sub_u32 v7, v5, v7
    v_mov_b32 v19, 0x3f80
    v_mov_b32 v20, 1.0
    v_cmp_eq_u32 vcc, 0, v7
    v_cmp_eq_u32 s[50:51], 1, v7
    s_nop 0
    v_cndmask_b32 v160, 0, v19, vcc
    v_cndmask_b32 v160, v160, v20, s[50:51]
    v_cmp_eq_u32_e64 vcc, 2, v7
    v_cmp_eq_u32 s[50:51], 3, v7
    s_nop 0
    v_cndmask_b32 v161, 0, v19, vcc
    v_cndmask_b32 v161, v161, v20, s[50:51]
    v_cmp_eq_u32_e64 vcc, 4, v7
    v_cmp_eq_u32 s[50:51], 5, v7
    s_nop 0
    v_cndmask_b32 v162, 0, v19, vcc
    v_cndmask_b32 v162, v162, v20, s[50:51]
    v_cmp_eq_u32_e64 vcc, 6, v7
    v_cmp_eq_u32 s[50:51], 7, v7
    s_nop 0
    v_cndmask_b32 v163, 0, v19, vcc
    v_cndmask_b32 v163, v163, v20, s[50:51]
    v_cmp_eq_u32_e64 vcc, 16, v7
    v_cmp_eq_u32 s[50:51], 17, v7
    s_nop 0
    v_cndmask_b32 v164, 0, v19, vcc
    v_cndmask_b32 v164, v164, v20, s[50:51]
    v_cmp_eq_u32_e64 vcc, 18, v7
    v_cmp_eq_u32 s[50:51], 19, v7
    s_nop 0
    v_cndmask_b32 v165, 0, v19, vcc
    v_cndmask_b32 v165, v165, v20, s[50:51]
    v_cmp_eq_u32_e64 vcc, 20, v7
    v_cmp_eq_u32 s[50:51], 21, v7
    s_nop 0
    v_cndmask_b32 v166, 0, v19, vcc
    v_cndmask_b32 v166, v166, v20, s[50:51]
    v_cmp_eq_u32_e64 vcc, 22, v7
    v_cmp_eq_u32 s[50:51], 23, v7
    s_nop 0
    v_cndmask_b32 v167, 0, v19, vcc
    v_cndmask_b32 v167, v167, v20, s[50:51]
    s_setprio 2
    s_barrier
    ds_read_b64_tr_b16 v[56:57], v8 offset:0
    ds_read_b64_tr_b16 v[58:59], v8 offset:1024
    ds_read_b64_tr_b16 v[48:49], v10 offset:16384
    ds_read_b64_tr_b16 v[50:51], v10 offset:16896
    ds_read_b64_tr_b16 v[60:61], v9 offset:0
    ds_read_b64_tr_b16 v[62:63], v9 offset:1024
    ds_read_b64_tr_b16 v[52:53], v11 offset:16384
    ds_read_b64_tr_b16 v[54:55], v11 offset:16896
    ds_read_b64_tr_b16 v[72:73], v8 offset:4096
    ds_read_b64_tr_b16 v[74:75], v8 offset:5120
    ds_read_b64_tr_b16 v[64:65], v10 offset:18432
    ds_read_b64_tr_b16 v[66:67], v10 offset:18944
    ds_read_b64_tr_b16 v[76:77], v9 offset:4096
    ds_read_b64_tr_b16 v[78:79], v9 offset:5120
    ds_read_b64_tr_b16 v[68:69], v11 offset:18432
    ds_read_b64_tr_b16 v[70:71], v11 offset:18944
    s_barrier
    s_waitcnt lgkmcnt(8)
    v_mfma_f32_32x32x16_bf16 v[96:111], v[48:51], v[56:59], 0
    ds_read_b64_tr_b16 v[88:89], v8 offset:8192
    ds_read_b64_tr_b16 v[90:91], v8 offset:9216
    v_mfma_f32_32x32x16_bf16 v[112:127], v[48:51], v[60:63], 0
    ds_read_b64_tr_b16 v[80:81], v10 offset:24576
    ds_read_b64_tr_b16 v[82:83], v10 offset:25088
    v_mfma_f32_32x32x16_bf16 v[128:143], v[52:55], v[56:59], 0
    ds_read_b64_tr_b16 v[92:93], v9 offset:8192
    ds_read_b64_tr_b16 v[94:95], v9 offset:9216
    v_mfma_f32_32x32x16_bf16 v[144:159], v[52:55], v[60:63], 0
    ds_read_b64_tr_b16 v[84:85], v11 offset:24576
    ds_read_b64_tr_b16 v[86:87], v11 offset:25088
    s_waitcnt lgkmcnt(8)
    s_nop 0
    v_mfma_f32_32x32x16_bf16 v[96:111], v[64:67], v[72:75], v[96:111]
    ds_read_b64_tr_b16 v[56:57], v8 offset:12288
    ds_read_b64_tr_b16 v[58:59], v8 offset:13312
    v_mfma_f32_32x32x16_bf16 v[112:127], v[64:67], v[76:79], v[112:127]
    ds_read_b64_tr_b16 v[48:49], v10 offset:26624
    ds_read_b64_tr_b16 v[50:51], v10 offset:27136
    v_mfma_f32_32x32x16_bf16 v[128:143], v[68:71], v[72:75], v[128:143]
    ds_read_b64_tr_b16 v[60:61], v9 offset:12288
    ds_read_b64_tr_b16 v[62:63], v9 offset:13312
    v_mfma_f32_32x32x16_bf16 v[144:159], v[68:71], v[76:79], v[144:159]
    ds_read_b64_tr_b16 v[52:53], v11 offset:26624
    ds_read_b64_tr_b16 v[54:55], v11 offset:27136
    s_barrier
    s_waitcnt lgkmcnt(8)
    v_mfma_f32_32x32x16_bf16 v[96:111], v[80:83], v[88:91], v[96:111]
    ds_read_b64_tr_b16 v[72:73], v8 offset:16384
    ds_read_b64_tr_b16 v[74:75], v8 offset:17408
    v_mfma_f32_32x32x16_bf16 v[112:127], v[80:83], v[92:95], v[112:127]
    ds_read_b64_tr_b16 v[64:65], v10 offset:32768
    ds_read_b64_tr_b16 v[66:67], v10 offset:33280
    v_mfma_f32_32x32x16_bf16 v[128:143], v[84:87], v[88:91], v[128:143]
    ds_read_b64_tr_b16 v[76:77], v9 offset:16384
    ds_read_b64_tr_b16 v[78:79], v9 offset:17408
    v_mfma_f32_32x32x16_bf16 v[144:159], v[84:87], v[92:95], v[144:159]
    ds_read_b64_tr_b16 v[68:69], v11 offset:32768
    ds_read_b64_tr_b16 v[70:71], v11 offset:33280
    s_waitcnt lgkmcnt(8)
    s_nop 0
    v_mfma_f32_32x32x16_bf16 v[96:111], v[48:51], v[56:59], v[96:111]
    ds_read_b64_tr_b16 v[88:89], v8 offset:20480
    ds_read_b64_tr_b16 v[90:91], v8 offset:21504
    v_mfma_f32_32x32x16_bf16 v[112:127], v[48:51], v[60:63], v[112:127]
    ds_read_b64_tr_b16 v[80:81], v10 offset:34816
    ds_read_b64_tr_b16 v[82:83], v10 offset:35328
    v_mfma_f32_32x32x16_bf16 v[128:143], v[52:55], v[56:59], v[128:143]
    ds_read_b64_tr_b16 v[92:93], v9 offset:20480
    ds_read_b64_tr_b16 v[94:95], v9 offset:21504
    v_mfma_f32_32x32x16_bf16 v[144:159], v[52:55], v[60:63], v[144:159]
    ds_read_b64_tr_b16 v[84:85], v11 offset:34816
    ds_read_b64_tr_b16 v[86:87], v11 offset:35328
    s_barrier
    s_waitcnt lgkmcnt(8)
    v_mfma_f32_32x32x16_bf16 v[96:111], v[64:67], v[72:75], v[96:111]
    ds_read_b64_tr_b16 v[56:57], v8 offset:24576
    ds_read_b64_tr_b16 v[58:59], v8 offset:25600
    v_mfma_f32_32x32x16_bf16 v[112:127], v[64:67], v[76:79], v[112:127]
    ds_read_b64_tr_b16 v[48:49], v10 offset:40960
    ds_read_b64_tr_b16 v[50:51], v10 offset:41472
    v_mfma_f32_32x32x16_bf16 v[128:143], v[68:71], v[72:75], v[128:143]
    ds_read_b64_tr_b16 v[60:61], v9 offset:24576
    ds_read_b64_tr_b16 v[62:63], v9 offset:25600
    v_mfma_f32_32x32x16_bf16 v[144:159], v[68:71], v[76:79], v[144:159]
    ds_read_b64_tr_b16 v[52:53], v11 offset:40960
    ds_read_b64_tr_b16 v[54:55], v11 offset:41472
    s_waitcnt lgkmcnt(8)
    s_nop 0
    v_mfma_f32_32x32x16_bf16 v[96:111], v[80:83], v[88:91], v[96:111]
    ds_read_b64_tr_b16 v[72:73], v8 offset:28672
    ds_read_b64_tr_b16 v[74:75], v8 offset:29696
    v_mfma_f32_32x32x16_bf16 v[112:127], v[80:83], v[92:95], v[112:127]
    ds_read_b64_tr_b16 v[64:65], v10 offset:43008
    ds_read_b64_tr_b16 v[66:67], v10 offset:43520
    v_mfma_f32_32x32x16_bf16 v[128:143], v[84:87], v[88:91], v[128:143]
    ds_read_b64_tr_b16 v[76:77], v9 offset:28672
    ds_read_b64_tr_b16 v[78:79], v9 offset:29696
    v_mfma_f32_32x32x16_bf16 v[144:159], v[84:87], v[92:95], v[144:159]
    ds_read_b64_tr_b16 v[68:69], v11 offset:43008
    ds_read_b64_tr_b16 v[70:71], v11 offset:43520
    s_barrier
    s_waitcnt lgkmcnt(8)
    v_mfma_f32_32x32x16_bf16 v[96:111], v[48:51], v[56:59], v[96:111]
    ds_read_b64_tr_b16 v[88:89], v8 offset:32768
    ds_read_b64_tr_b16 v[90:91], v8 offset:33792
    v_mfma_f32_32x32x16_bf16 v[112:127], v[48:51], v[60:63], v[112:127]
    ds_read_b64_tr_b16 v[80:81], v10 offset:49152
    ds_read_b64_tr_b16 v[82:83], v10 offset:49664
    v_mfma_f32_32x32x16_bf16 v[128:143], v[52:55], v[56:59], v[128:143]
    ds_read_b64_tr_b16 v[92:93], v9 offset:32768
    ds_read_b64_tr_b16 v[94:95], v9 offset:33792
    v_mfma_f32_32x32x16_bf16 v[144:159], v[52:55], v[60:63], v[144:159]
    ds_read_b64_tr_b16 v[84:85], v11 offset:49152
    ds_read_b64_tr_b16 v[86:87], v11 offset:49664
    s_waitcnt lgkmcnt(8)
    s_nop 0
    v_mfma_f32_32x32x16_bf16 v[96:111], v[64:67], v[72:75], v[96:111]
    ds_read_b64_tr_b16 v[56:57], v8 offset:36864
    ds_read_b64_tr_b16 v[58:59], v8 offset:37888
    v_mfma_f32_32x32x16_bf16 v[112:127], v[64:67], v[76:79], v[112:127]
    ds_read_b64_tr_b16 v[48:49], v10 offset:51200
    ds_read_b64_tr_b16 v[50:51], v10 offset:51712
    v_mfma_f32_32x32x16_bf16 v[128:143], v[68:71], v[72:75], v[128:143]
    ds_read_b64_tr_b16 v[60:61], v9 offset:36864
    ds_read_b64_tr_b16 v[62:63], v9 offset:37888
    v_mfma_f32_32x32x16_bf16 v[144:159], v[68:71], v[76:79], v[144:159]
    ds_read_b64_tr_b16 v[52:53], v11 offset:51200
    ds_read_b64_tr_b16 v[54:55], v11 offset:51712
    s_barrier
    s_waitcnt lgkmcnt(8)
    v_mfma_f32_32x32x16_bf16 v[96:111], v[80:83], v[88:91], v[96:111]
    ds_read_b64_tr_b16 v[72:73], v8 offset:40960
    ds_read_b64_tr_b16 v[74:75], v8 offset:41984
    v_mfma_f32_32x32x16_bf16 v[112:127], v[80:83], v[92:95], v[112:127]
    ds_read_b64_tr_b16 v[64:65], v10 offset:57344
    ds_read_b64_tr_b16 v[66:67], v10 offset:57856
    v_mfma_f32_32x32x16_bf16 v[128:143], v[84:87], v[88:91], v[128:143]
    ds_read_b64_tr_b16 v[76:77], v9 offset:40960
    ds_read_b64_tr_b16 v[78:79], v9 offset:41984
    v_mfma_f32_32x32x16_bf16 v[144:159], v[84:87], v[92:95], v[144:159]
    ds_read_b64_tr_b16 v[68:69], v11 offset:57344
    ds_read_b64_tr_b16 v[70:71], v11 offset:57856
    s_waitcnt lgkmcnt(8)
    s_nop 0
    v_mfma_f32_32x32x16_bf16 v[96:111], v[48:51], v[56:59], v[96:111]
    ds_read_b64_tr_b16 v[88:89], v8 offset:45056
    ds_read_b64_tr_b16 v[90:91], v8 offset:46080
    v_mfma_f32_32x32x16_bf16 v[112:127], v[48:51], v[60:63], v[112:127]
    ds_read_b64_tr_b16 v[80:81], v10 offset:59392
    ds_read_b64_tr_b16 v[82:83], v10 offset:59904
    v_mfma_f32_32x32x16_bf16 v[128:143], v[52:55], v[56:59], v[128:143]
    ds_read_b64_tr_b16 v[92:93], v9 offset:45056
    ds_read_b64_tr_b16 v[94:95], v9 offset:46080
    v_mfma_f32_32x32x16_bf16 v[144:159], v[52:55], v[60:63], v[144:159]
    ds_read_b64_tr_b16 v[84:85], v11 offset:59392
    ds_read_b64_tr_b16 v[86:87], v11 offset:59904
    s_barrier
    s_waitcnt lgkmcnt(8)
    v_mfma_f32_32x32x16_bf16 v[96:111], v[64:67], v[72:75], v[96:111]
    ds_read_b64_tr_b16 v[56:57], v8 offset:49152
    ds_read_b64_tr_b16 v[58:59], v8 offset:50176
    v_mfma_f32_32x32x16_bf16 v[112:127], v[64:67], v[76:79], v[112:127]
    ds_read_b64_tr_b16 v[48:49], v10 offset:16384
    ds_read_b64_tr_b16 v[50:51], v10 offset:16896
    v_mfma_f32_32x32x16_bf16 v[128:143], v[68:71], v[72:75], v[128:143]
    ds_read_b64_tr_b16 v[60:61], v9 offset:49152
    ds_read_b64_tr_b16 v[62:63], v9 offset:50176
    v_mfma_f32_32x32x16_bf16 v[144:159], v[68:71], v[76:79], v[144:159]
    ds_read_b64_tr_b16 v[52:53], v11 offset:16384
    ds_read_b64_tr_b16 v[54:55], v11 offset:16896
    s_waitcnt lgkmcnt(8)
    s_nop 0
    v_mfma_f32_32x32x16_bf16 v[96:111], v[80:83], v[88:91], v[96:111]
    ds_read_b64_tr_b16 v[72:73], v8 offset:53248
    ds_read_b64_tr_b16 v[74:75], v8 offset:54272
    v_mfma_f32_32x32x16_bf16 v[112:127], v[80:83], v[92:95], v[112:127]
    ds_read_b64_tr_b16 v[64:65], v10 offset:18432
    ds_read_b64_tr_b16 v[66:67], v10 offset:18944
    v_mfma_f32_32x32x16_bf16 v[128:143], v[84:87], v[88:91], v[128:143]
    ds_read_b64_tr_b16 v[76:77], v9 offset:53248
    ds_read_b64_tr_b16 v[78:79], v9 offset:54272
    v_mfma_f32_32x32x16_bf16 v[144:159], v[84:87], v[92:95], v[144:159]
    ds_read_b64_tr_b16 v[68:69], v11 offset:18432
    ds_read_b64_tr_b16 v[70:71], v11 offset:18944
    s_barrier
    s_waitcnt lgkmcnt(8)
    v_mfma_f32_32x32x16_bf16 v[96:111], v[48:51], v[56:59], v[96:111]
    ds_read_b64_tr_b16 v[88:89], v8 offset:57344
    ds_read_b64_tr_b16 v[90:91], v8 offset:58368
    v_mfma_f32_32x32x16_bf16 v[112:127], v[48:51], v[60:63], v[112:127]
    ds_read_b64_tr_b16 v[80:81], v10 offset:24576
    ds_read_b64_tr_b16 v[82:83], v10 offset:25088
    v_mfma_f32_32x32x16_bf16 v[128:143], v[52:55], v[56:59], v[128:143]
    ds_read_b64_tr_b16 v[92:93], v9 offset:57344
    ds_read_b64_tr_b16 v[94:95], v9 offset:58368
    v_mfma_f32_32x32x16_bf16 v[144:159], v[52:55], v[60:63], v[144:159]
    ds_read_b64_tr_b16 v[84:85], v11 offset:24576
    ds_read_b64_tr_b16 v[86:87], v11 offset:25088
    s_waitcnt lgkmcnt(8)
    s_nop 0
    v_mfma_f32_32x32x16_bf16 v[96:111], v[64:67], v[72:75], v[96:111]
    ds_read_b64_tr_b16 v[56:57], v8 offset:61440
    ds_read_b64_tr_b16 v[58:59], v8 offset:62464
    v_mfma_f32_32x32x16_bf16 v[112:127], v[64:67], v[76:79], v[112:127]
    ds_read_b64_tr_b16 v[48:49], v10 offset:26624
    ds_read_b64_tr_b16 v[50:51], v10 offset:27136
    v_mfma_f32_32x32x16_bf16 v[128:143], v[68:71], v[72:75], v[128:143]
    ds_read_b64_tr_b16 v[60:61], v9 offset:61440
    ds_read_b64_tr_b16 v[62:63], v9 offset:62464
    v_mfma_f32_32x32x16_bf16 v[144:159], v[68:71], v[76:79], v[144:159]
    ds_read_b64_tr_b16 v[52:53], v11 offset:26624
    ds_read_b64_tr_b16 v[54:55], v11 offset:27136
    s_barrier
    s_waitcnt lgkmcnt(8)
    v_mfma_f32_32x32x16_bf16 v[96:111], v[80:83], v[88:91], v[96:111]
    ds_read_b64_tr_b16 v[72:73], v17 offset:0
    ds_read_b64_tr_b16 v[74:75], v17 offset:1024
    v_mfma_f32_32x32x16_bf16 v[112:127], v[80:83], v[92:95], v[112:127]
    ds_read_b64_tr_b16 v[64:65], v10 offset:32768
    ds_read_b64_tr_b16 v[66:67], v10 offset:33280
    v_mfma_f32_32x32x16_bf16 v[128:143], v[84:87], v[88:91], v[128:143]
    ds_read_b64_tr_b16 v[76:77], v46 offset:0
    ds_read_b64_tr_b16 v[78:79], v46 offset:1024
    v_mfma_f32_32x32x16_bf16 v[144:159], v[84:87], v[92:95], v[144:159]
    ds_read_b64_tr_b16 v[68:69], v11 offset:32768
    ds_read_b64_tr_b16 v[70:71], v11 offset:33280
    s_waitcnt lgkmcnt(8)
    s_nop 0
    v_mfma_f32_32x32x16_bf16 v[96:111], v[48:51], v[56:59], v[96:111]
    ds_read_b64_tr_b16 v[88:89], v17 offset:4096
    ds_read_b64_tr_b16 v[90:91], v17 offset:5120
    v_mfma_f32_32x32x16_bf16 v[112:127], v[48:51], v[60:63], v[112:127]
    ds_read_b64_tr_b16 v[80:81], v10 offset:34816
    ds_read_b64_tr_b16 v[82:83], v10 offset:35328
    v_mfma_f32_32x32x16_bf16 v[128:143], v[52:55], v[56:59], v[128:143]
    ds_read_b64_tr_b16 v[92:93], v46 offset:4096
    ds_read_b64_tr_b16 v[94:95], v46 offset:5120
    v_mfma_f32_32x32x16_bf16 v[144:159], v[52:55], v[60:63], v[144:159]
    ds_read_b64_tr_b16 v[84:85], v11 offset:34816
    ds_read_b64_tr_b16 v[86:87], v11 offset:35328
    s_barrier
    s_waitcnt lgkmcnt(8)
    v_mfma_f32_32x32x16_bf16 v[96:111], v[64:67], v[72:75], v[96:111]
    ds_read_b64_tr_b16 v[56:57], v17 offset:8192
    ds_read_b64_tr_b16 v[58:59], v17 offset:9216
    v_mfma_f32_32x32x16_bf16 v[112:127], v[64:67], v[76:79], v[112:127]
    ds_read_b64_tr_b16 v[48:49], v10 offset:40960
    ds_read_b64_tr_b16 v[50:51], v10 offset:41472
    v_mfma_f32_32x32x16_bf16 v[128:143], v[68:71], v[72:75], v[128:143]
    ds_read_b64_tr_b16 v[60:61], v46 offset:8192
    ds_read_b64_tr_b16 v[62:63], v46 offset:9216
    v_mfma_f32_32x32x16_bf16 v[144:159], v[68:71], v[76:79], v[144:159]
    ds_read_b64_tr_b16 v[52:53], v11 offset:40960
    ds_read_b64_tr_b16 v[54:55], v11 offset:41472
    s_waitcnt lgkmcnt(8)
    s_nop 0
    v_mfma_f32_32x32x16_bf16 v[96:111], v[80:83], v[88:91], v[96:111]
    ds_read_b64_tr_b16 v[72:73], v17 offset:12288
    ds_read_b64_tr_b16 v[74:75], v17 offset:13312
    v_mfma_f32_32x32x16_bf16 v[112:127], v[80:83], v[92:95], v[112:127]
    ds_read_b64_tr_b16 v[64:65], v10 offset:43008
    ds_read_b64_tr_b16 v[66:67], v10 offset:43520
    v_mfma_f32_32x32x16_bf16 v[128:143], v[84:87], v[88:91], v[128:143]
    ds_read_b64_tr_b16 v[76:77], v46 offset:12288
    ds_read_b64_tr_b16 v[78:79], v46 offset:13312
    v_mfma_f32_32x32x16_bf16 v[144:159], v[84:87], v[92:95], v[144:159]
    ds_read_b64_tr_b16 v[68:69], v11 offset:43008
    ds_read_b64_tr_b16 v[70:71], v11 offset:43520
    s_barrier
    s_waitcnt lgkmcnt(8)
    v_mfma_f32_32x32x16_bf16 v[96:111], v[48:51], v[56:59], v[96:111]
    ds_read_b64_tr_b16 v[88:89], v17 offset:16384
    ds_read_b64_tr_b16 v[90:91], v17 offset:17408
    v_mfma_f32_32x32x16_bf16 v[112:127], v[48:51], v[60:63], v[112:127]
    ds_read_b64_tr_b16 v[80:81], v10 offset:49152
    ds_read_b64_tr_b16 v[82:83], v10 offset:49664
    v_mfma_f32_32x32x16_bf16 v[128:143], v[52:55], v[56:59], v[128:143]
    ds_read_b64_tr_b16 v[92:93], v46 offset:16384
    ds_read_b64_tr_b16 v[94:95], v46 offset:17408
    v_mfma_f32_32x32x16_bf16 v[144:159], v[52:55], v[60:63], v[144:159]
    ds_read_b64_tr_b16 v[84:85], v11 offset:49152
    ds_read_b64_tr_b16 v[86:87], v11 offset:49664
    s_waitcnt lgkmcnt(8)
    s_nop 0
    v_mfma_f32_32x32x16_bf16 v[96:111], v[64:67], v[72:75], v[96:111]
    ds_read_b64_tr_b16 v[56:57], v17 offset:20480
    ds_read_b64_tr_b16 v[58:59], v17 offset:21504
    v_mfma_f32_32x32x16_bf16 v[112:127], v[64:67], v[76:79], v[112:127]
    ds_read_b64_tr_b16 v[48:49], v10 offset:51200
    ds_read_b64_tr_b16 v[50:51], v10 offset:51712
    v_mfma_f32_32x32x16_bf16 v[128:143], v[68:71], v[72:75], v[128:143]
    ds_read_b64_tr_b16 v[60:61], v46 offset:20480
    ds_read_b64_tr_b16 v[62:63], v46 offset:21504
    v_mfma_f32_32x32x16_bf16 v[144:159], v[68:71], v[76:79], v[144:159]
    ds_read_b64_tr_b16 v[52:53], v11 offset:51200
    ds_read_b64_tr_b16 v[54:55], v11 offset:51712
    s_barrier
    s_waitcnt lgkmcnt(8)
    v_mfma_f32_32x32x16_bf16 v[96:111], v[80:83], v[88:91], v[96:111]
    ds_read_b64_tr_b16 v[72:73], v17 offset:24576
    ds_read_b64_tr_b16 v[74:75], v17 offset:25600
    v_mfma_f32_32x32x16_bf16 v[112:127], v[80:83], v[92:95], v[112:127]
    ds_read_b64_tr_b16 v[64:65], v10 offset:16384
    ds_read_b64_tr_b16 v[66:67], v10 offset:16896
    v_mfma_f32_32x32x16_bf16 v[128:143], v[84:87], v[88:91], v[128:143]
    ds_read_b64_tr_b16 v[76:77], v46 offset:24576
    ds_read_b64_tr_b16 v[78:79], v46 offset:25600
    v_mfma_f32_32x32x16_bf16 v[144:159], v[84:87], v[92:95], v[144:159]
    ds_read_b64_tr_b16 v[68:69], v11 offset:16384
    ds_read_b64_tr_b16 v[70:71], v11 offset:16896
    s_waitcnt lgkmcnt(8)
    s_nop 0
    v_mfma_f32_32x32x16_bf16 v[96:111], v[48:51], v[56:59], v[96:111]
    ds_read_b64_tr_b16 v[88:89], v17 offset:28672
    ds_read_b64_tr_b16 v[90:91], v17 offset:29696
    v_mfma_f32_32x32x16_bf16 v[112:127], v[48:51], v[60:63], v[112:127]
    ds_read_b64_tr_b16 v[80:81], v10 offset:18432
    ds_read_b64_tr_b16 v[82:83], v10 offset:18944
    v_mfma_f32_32x32x16_bf16 v[128:143], v[52:55], v[56:59], v[128:143]
    ds_read_b64_tr_b16 v[92:93], v46 offset:28672
    ds_read_b64_tr_b16 v[94:95], v46 offset:29696
    v_mfma_f32_32x32x16_bf16 v[144:159], v[52:55], v[60:63], v[144:159]
    ds_read_b64_tr_b16 v[84:85], v11 offset:18432
    ds_read_b64_tr_b16 v[86:87], v11 offset:18944
    global_load_dwordx2 v[32:33], v16, s[30:31] sc1
    s_barrier
    s_waitcnt lgkmcnt(8)
    v_mfma_f32_32x32x16_bf16 v[96:111], v[64:67], v[72:75], v[96:111]
    ds_read_b64_tr_b16 v[56:57], v17 offset:32768
    ds_read_b64_tr_b16 v[58:59], v17 offset:33792
    v_mfma_f32_32x32x16_bf16 v[112:127], v[64:67], v[76:79], v[112:127]
    ds_read_b64_tr_b16 v[48:49], v10 offset:24576
    ds_read_b64_tr_b16 v[50:51], v10 offset:25088
    v_mfma_f32_32x32x16_bf16 v[128:143], v[68:71], v[72:75], v[128:143]
    ds_read_b64_tr_b16 v[60:61], v46 offset:32768
    ds_read_b64_tr_b16 v[62:63], v46 offset:33792
    v_mfma_f32_32x32x16_bf16 v[144:159], v[68:71], v[76:79], v[144:159]
    ds_read_b64_tr_b16 v[52:53], v11 offset:24576
    ds_read_b64_tr_b16 v[54:55], v11 offset:25088
    s_waitcnt lgkmcnt(8)
    s_nop 0
    v_mfma_f32_32x32x16_bf16 v[96:111], v[80:83], v[88:91], v[96:111]
    ds_read_b64_tr_b16 v[72:73], v17 offset:36864
    ds_read_b64_tr_b16 v[74:75], v17 offset:37888
    v_mfma_f32_32x32x16_bf16 v[112:127], v[80:83], v[92:95], v[112:127]
    ds_read_b64_tr_b16 v[64:65], v10 offset:26624
    ds_read_b64_tr_b16 v[66:67], v10 offset:27136
    v_mfma_f32_32x32x16_bf16 v[128:143], v[84:87], v[88:91], v[128:143]
    ds_read_b64_tr_b16 v[76:77], v46 offset:36864
    ds_read_b64_tr_b16 v[78:79], v46 offset:37888
    v_mfma_f32_32x32x16_bf16 v[144:159], v[84:87], v[92:95], v[144:159]
    ds_read_b64_tr_b16 v[68:69], v11 offset:26624
    ds_read_b64_tr_b16 v[70:71], v11 offset:27136
    global_load_dwordx2 v[34:35], v16, s[30:31] offset:128 sc1
    s_barrier
    s_waitcnt lgkmcnt(8)
    v_mfma_f32_32x32x16_bf16 v[96:111], v[48:51], v[56:59], v[96:111]
    s_branch Lpg1
.p2align 12
Lpw1:
    s_setpc_b64 s[96:97]
    s_nop 0
Lpg1:
    ds_read_b64_tr_b16 v[88:89], v17 offset:40960
    ds_read_b64_tr_b16 v[90:91], v17 offset:41984
    v_mfma_f32_32x32x16_bf16 v[112:127], v[48:51], v[60:63], v[112:127]
    ds_read_b64_tr_b16 v[80:81], v10 offset:32768
    ds_read_b64_tr_b16 v[82:83], v10 offset:33280
    v_mfma_f32_32x32x16_bf16 v[128:143], v[52:55], v[56:59], v[128:143]
    ds_read_b64_tr_b16 v[92:93], v46 offset:40960
    ds_read_b64_tr_b16 v[94:95], v46 offset:41984
    v_mfma_f32_32x32x16_bf16 v[144:159], v[52:55], v[60:63], v[144:159]
    ds_read_b64_tr_b16 v[84:85], v11 offset:32768
    ds_read_b64_tr_b16 v[86:87], v11 offset:33280
    s_waitcnt lgkmcnt(8)
    s_nop 0
    v_mfma_f32_32x32x16_bf16 v[96:111], v[64:67], v[72:75], v[96:111]
    ds_read_b64_tr_b16 v[56:57], v17 offset:45056
    ds_read_b64_tr_b16 v[58:59], v17 offset:46080
    v_mfma_f32_32x32x16_bf16 v[112:127], v[64:67], v[76:79], v[112:127]
    ds_read_b64_tr_b16 v[48:49], v10 offset:34816
    ds_read_b64_tr_b16 v[50:51], v10 offset:35328
    v_mfma_f32_32x32x16_bf16 v[128:143], v[68:71], v[72:75], v[128:143]
    ds_read_b64_tr_b16 v[60:61], v46 offset:45056
    ds_read_b64_tr_b16 v[62:63], v46 offset:46080
    v_mfma_f32_32x32x16_bf16 v[144:159], v[68:71], v[76:79], v[144:159]
    ds_read_b64_tr_b16 v[52:53], v11 offset:34816
    ds_read_b64_tr_b16 v[54:55], v11 offset:35328
    s_barrier
    s_waitcnt lgkmcnt(8)
    v_mfma_f32_32x32x16_bf16 v[96:111], v[80:83], v[88:91], v[96:111]
    ds_read_b128 v[24:27], v14
    ds_read_b128 v[28:31], v15
    v_mfma_f32_32x32x16_bf16 v[112:127], v[80:83], v[92:95], v[112:127]
    ds_read_b64_tr_b16 v[72:73], v18 offset:0
    ds_read_b64_tr_b16 v[74:75], v18 offset:1024
    v_mfma_f32_32x32x16_bf16 v[128:143], v[84:87], v[88:91], v[128:143]
    ds_read_b64_tr_b16 v[76:77], v18 offset:4096
    ds_read_b64_tr_b16 v[78:79], v18 offset:5120
    v_mfma_f32_32x32x16_bf16 v[144:159], v[84:87], v[92:95], v[144:159]
    s_waitcnt vmcnt(0) lgkmcnt(4)
    s_nop 0
    v_mfma_f32_32x32x16_bf16 v[96:111], v[48:51], v[56:59], v[96:111]
    v_cndmask_b32 v38, 0, v27, s[52:53]
    v_mfma_f32_32x32x16_bf16 v[112:127], v[48:51], v[60:63], v[112:127]
    v_cndmask_b32 v39, 0, v27, s[52:53]
    v_mfma_f32_32x32x16_bf16 v[128:143], v[52:55], v[56:59], v[128:143]
    v_cndmask_b32 v42, 0, v31, s[52:53]
    v_mfma_f32_32x32x16_bf16 v[144:159], v[52:55], v[60:63], v[144:159]
    v_cndmask_b32 v43, 0, v31, s[52:53]
    v_mfma_f32_32x32x16_bf16 v[96:111], v[32:35], v[38:41], v[96:111]
    s_nop 0
    v_mfma_f32_32x32x16_bf16 v[112:127], v[32:35], v[42:45], v[112:127]
    v_mfma_f32_32x32x16_bf16 v[128:143], v[34:37], v[38:41], v[128:143]
    v_mfma_f32_32x32x16_bf16 v[144:159], v[34:37], v[42:45], v[144:159]
    s_waitcnt lgkmcnt(0)
    s_setprio 0
    s_barrier
    s_nop 4
    v_mul_f32 v48, v96, v96
    v_mul_f32_e64 v49, v97, v97
    v_fma_f32 v48, v48, v25, v24
    v_fma_f32 v49, v49, v25, v24
    v_mul_f32 v48, v48, v96
    v_mul_f32 v49, v49, v97
    v_exp_f32 v48, v48
    v_exp_f32 v49, v49
    v_mul_f32 v56, v96, v104
    v_mul_f32 v57, v97, v105
    v_fma_f32 v48, v48, v26, v26
    v_fma_f32 v49, v49, v26, v26
    v_rcp_f32 v48, v48
    v_rcp_f32 v49, v49
    v_mul_f32 v56, v56, v48
    v_mul_f32 v57, v57, v49
    v_cvt_pk_bf16_f32 v64, v56, v57
    v_mul_f32 v50, v98, v98
    v_mul_f32 v51, v99, v99
    v_fma_f32 v50, v50, v25, v24
    v_fma_f32 v51, v51, v25, v24
    v_mul_f32 v50, v50, v98
    v_mul_f32 v51, v51, v99
    v_exp_f32 v50, v50
    v_exp_f32 v51, v51
    v_mul_f32 v58, v98, v106
    v_mul_f32 v59, v99, v107
    v_fma_f32 v50, v50, v26, v26
    v_fma_f32 v51, v51, v26, v26
    v_rcp_f32 v50, v50
    v_rcp_f32 v51, v51
    v_mul_f32 v58, v58, v50
    v_mul_f32 v59, v59, v51
    v_cvt_pk_bf16_f32 v65, v58, v59
    v_mul_f32 v52, v100, v100
    v_mul_f32 v53, v101, v101
    v_fma_f32 v52, v52, v25, v24
    v_fma_f32 v53, v53, v25, v24
    v_mul_f32 v52, v52, v100
    v_mul_f32 v53, v53, v101
    v_exp_f32 v52, v52
    v_exp_f32 v53, v53
    v_mul_f32 v60, v100, v108
    s_barrier
    v_mul_f32_e64 v61, v101, v109
    v_fma_f32 v52, v52, v26, v26
    v_fma_f32 v53, v53, v26, v26
    v_rcp_f32 v52, v52
    v_rcp_f32 v53, v53
    v_mul_f32 v60, v60, v52
    v_mul_f32 v61, v61, v53
    v_cvt_pk_bf16_f32 v66, v60, v61
    v_mul_f32 v54, v102, v102
    v_mul_f32 v55, v103, v103
    v_fma_f32 v54, v54, v25, v24
    v_fma_f32 v55, v55, v25, v24
    v_mul_f32 v54, v54, v102
    v_mul_f32 v55, v55, v103
    v_exp_f32 v54, v54
    v_exp_f32 v55, v55
    v_mul_f32 v62, v102, v110
    v_mul_f32 v63, v103, v111
    v_fma_f32 v54, v54, v26, v26
    v_fma_f32 v55, v55, v26, v26
    v_rcp_f32 v54, v54
    v_rcp_f32 v55, v55
    v_mul_f32 v62, v62, v54
    v_mul_f32 v63, v63, v55
    v_cvt_pk_bf16_f32 v67, v62, v63
    global_store_dwordx4 v12, v[64:67], s[30:31] offset:0 sc0 sc1
    v_mul_f32 v48, v112, v112
    v_mul_f32 v49, v113, v113
    v_fma_f32 v48, v48, v29, v28
    v_fma_f32 v49, v49, v29, v28
    v_mul_f32 v48, v48, v112
    v_mul_f32 v49, v49, v113
    v_exp_f32 v48, v48
    v_exp_f32 v49, v49
    v_mul_f32 v56, v112, v120
    v_mul_f32 v57, v113, v121
    v_fma_f32 v48, v48, v30, v30
    v_fma_f32 v49, v49, v30, v30
    s_barrier
    v_rcp_f32 v48, v48
    v_rcp_f32 v49, v49
    v_mul_f32 v56, v56, v48
    v_mul_f32_e64 v57, v57, v49
    v_cvt_pk_bf16_f32 v68, v56, v57
    v_mul_f32 v50, v114, v114
    v_mul_f32 v51, v115, v115
    v_fma_f32 v50, v50, v29, v28
    v_fma_f32 v51, v51, v29, v28
    v_mul_f32 v50, v50, v114
    v_mul_f32 v51, v51, v115
    v_exp_f32 v50, v50
    v_exp_f32 v51, v51
    v_mul_f32 v58, v114, v122
    v_mul_f32 v59, v115, v123
    v_fma_f32 v50, v50, v30, v30
    v_fma_f32 v51, v51, v30, v30
    v_rcp_f32 v50, v50
    v_rcp_f32 v51, v51
    v_mul_f32 v58, v58, v50
    v_mul_f32 v59, v59, v51
    v_cvt_pk_bf16_f32 v69, v58, v59
    v_mul_f32 v52, v116, v116
    v_mul_f32 v53, v117, v117
    v_fma_f32 v52, v52, v29, v28
    v_fma_f32 v53, v53, v29, v28
    v_mul_f32 v52, v52, v116
    v_mul_f32 v53, v53, v117
    v_exp_f32 v52, v52
    v_exp_f32 v53, v53
    v_mul_f32 v60, v116, v124
    v_mul_f32 v61, v117, v125
    v_fma_f32 v52, v52, v30, v30
    v_fma_f32 v53, v53, v30, v30
    v_rcp_f32 v52, v52
    v_rcp_f32 v53, v53
    v_mul_f32 v60, v60, v52
    v_mul_f32 v61, v61, v53
    v_cvt_pk_bf16_f32 v70, v60, v61
    v_mul_f32 v54, v118, v118
    v_mul_f32 v55, v119, v119
    v_fma_f32 v54, v54, v29, v28
    s_barrier
    v_fma_f32 v55, v55, v29, v28
    v_mul_f32 v54, v54, v118
    v_mul_f32 v55, v55, v119
    v_exp_f32 v54, v54
    v_exp_f32 v55, v55
    v_mul_f32 v62, v118, v126
    v_mul_f32_e64 v63, v119, v127
    v_fma_f32 v54, v54, v30, v30
    v_fma_f32 v55, v55, v30, v30
    v_rcp_f32 v54, v54
    v_rcp_f32 v55, v55
    v_mul_f32 v62, v62, v54
    v_mul_f32 v63, v63, v55
    v_cvt_pk_bf16_f32 v71, v62, v63
    global_store_dwordx4 v13, v[68:71], s[30:31] offset:0 sc0 sc1
    v_mul_f32 v48, v128, v128
    v_mul_f32 v49, v129, v129
    v_fma_f32 v48, v48, v25, v24
    v_fma_f32 v49, v49, v25, v24
    v_mul_f32 v48, v48, v128
    v_mul_f32 v49, v49, v129
    v_exp_f32 v48, v48
    v_exp_f32 v49, v49
    v_mul_f32 v56, v128, v136
    v_mul_f32 v57, v129, v137
    v_fma_f32 v48, v48, v26, v26
    v_fma_f32 v49, v49, v26, v26
    v_rcp_f32 v48, v48
    v_rcp_f32 v49, v49
    v_mul_f32 v56, v56, v48
    v_mul_f32 v57, v57, v49
    v_cvt_pk_bf16_f32 v64, v56, v57
    v_mul_f32 v50, v130, v130
    v_mul_f32 v51, v131, v131
    v_fma_f32 v50, v50, v25, v24
    v_fma_f32 v51, v51, v25, v24
    v_mul_f32 v50, v50, v130
    v_mul_f32 v51, v51, v131
    s_barrier
    v_exp_f32 v50, v50
    v_exp_f32 v51, v51
    v_mul_f32 v58, v130, v138
    v_mul_f32_e64 v59, v131, v139
    v_fma_f32 v50, v50, v26, v26
    v_fma_f32 v51, v51, v26, v26
    v_rcp_f32 v50, v50
    v_rcp_f32 v51, v51
    v_mul_f32 v58, v58, v50
    v_mul_f32 v59, v59, v51
    v_cvt_pk_bf16_f32 v65, v58, v59
    v_mul_f32 v52, v132, v132
    v_mul_f32 v53, v133, v133
    v_fma_f32 v52, v52, v25, v24
    v_fma_f32 v53, v53, v25, v24
    v_mul_f32 v52, v52, v132
    v_mul_f32 v53, v53, v133
    v_exp_f32 v52, v52
    v_exp_f32 v53, v53
    v_mul_f32 v60, v132, v140
    v_mul_f32 v61, v133, v141
    v_fma_f32 v52, v52, v26, v26
    v_fma_f32 v53, v53, v26, v26
    v_rcp_f32 v52, v52
    v_rcp_f32 v53, v53
    v_mul_f32 v60, v60, v52
    v_mul_f32 v61, v61, v53
    v_cvt_pk_bf16_f32 v66, v60, v61
    v_mul_f32 v54, v134, v134
    v_mul_f32 v55, v135, v135
    v_fma_f32 v54, v54, v25, v24
    v_fma_f32 v55, v55, v25, v24
    v_mul_f32 v54, v54, v134
    v_mul_f32 v55, v55, v135
    v_exp_f32 v54, v54
    v_exp_f32 v55, v55
    v_mul_f32 v62, v134, v142
    v_mul_f32 v63, v135, v143
    v_fma_f32 v54, v54, v26, v26
    v_fma_f32 v55, v55, v26, v26
    v_rcp_f32 v54, v54
    s_barrier
    v_rcp_f32 v55, v55
    v_mul_f32 v62, v62, v54
    v_mul_f32_e64 v63, v63, v55
    v_cvt_pk_bf16_f32 v67, v62, v63
    global_store_dwordx4 v12, v[64:67], s[30:31] offset:1024 sc0 sc1
    v_mul_f32 v48, v144, v144
    v_mul_f32 v49, v145, v145
    v_fma_f32 v48, v48, v29, v28
    v_fma_f32 v49, v49, v29, v28
    v_mul_f32 v48, v48, v144
    v_mul_f32 v49, v49, v145
    v_exp_f32 v48, v48
    v_exp_f32 v49, v49
    v_mul_f32 v56, v144, v152
    v_mul_f32 v57, v145, v153
    v_fma_f32 v48, v48, v30, v30
    v_fma_f32 v49, v49, v30, v30
    v_rcp_f32 v48, v48
    v_rcp_f32 v49, v49
    v_mul_f32 v56, v56, v48
    v_mul_f32 v57, v57, v49
    v_cvt_pk_bf16_f32 v68, v56, v57
    v_mul_f32 v50, v146, v146
    v_mul_f32 v51, v147, v147
    v_fma_f32 v50, v50, v29, v28
    v_fma_f32 v51, v51, v29, v28
    v_mul_f32 v50, v50, v146
    v_mul_f32 v51, v51, v147
    v_exp_f32 v50, v50
    v_exp_f32 v51, v51
    v_mul_f32 v58, v146, v154
    v_mul_f32 v59, v147, v155
    v_fma_f32 v50, v50, v30, v30
    v_fma_f32 v51, v51, v30, v30
    v_rcp_f32 v50, v50
    v_rcp_f32 v51, v51
    v_mul_f32 v58, v58, v50
    s_barrier
    s_mov_b32 s70, 1
    s_waitcnt vmcnt(1)
    s_atomic_add s70, s[30:31], s58
    s_add_u32 s58, s58, 128
    v_mul_f32_e64 v59, v59, v51
    v_cvt_pk_bf16_f32 v69, v58, v59
    v_mul_f32 v52, v148, v148
    v_mul_f32 v53, v149, v149
    v_fma_f32 v52, v52, v29, v28
    v_fma_f32 v53, v53, v29, v28
    v_mul_f32 v52, v52, v148
    v_mul_f32 v53, v53, v149
    v_exp_f32 v52, v52
    v_exp_f32 v53, v53
    v_mul_f32 v60, v148, v156
    v_mul_f32 v61, v149, v157
    v_fma_f32 v52, v52, v30, v30
    v_fma_f32 v53, v53, v30, v30
    v_rcp_f32 v52, v52
    v_rcp_f32 v53, v53
    v_mul_f32 v60, v60, v52
    v_mul_f32 v61, v61, v53
    v_cvt_pk_bf16_f32 v70, v60, v61
    v_mul_f32 v54, v150, v150
    v_mul_f32 v55, v151, v151
    v_fma_f32 v54, v54, v29, v28
    v_fma_f32 v55, v55, v29, v28
    v_mul_f32 v54, v54, v150
    v_mul_f32 v55, v55, v151
    v_exp_f32 v54, v54
    v_exp_f32 v55, v55
    v_mul_f32 v62, v150, v158
    v_mul_f32 v63, v151, v159
    v_fma_f32 v54, v54, v30, v30
    v_fma_f32 v55, v55, v30, v30
    v_rcp_f32 v54, v54
    v_rcp_f32 v55, v55
    v_mul_f32 v62, v62, v54
    v_mul_f32 v63, v63, v55
    v_cvt_pk_bf16_f32 v71, v62, v63
    global_store_dwordx4 v13, v[68:71], s[30:31] offset:1024 sc0 sc1
    s_barrier
    v_lshl_add_u32 v7, v4, 2, v2
    v_lshlrev_b32 v7, 7, v7
    v_lshrrev_b32 v8, 1, v2
    v_xor_b32 v8, s41, v8
    v_lshl_add_u32 v7, v8, 6, v7
    v_lshl_add_u32 v7, v3, 5, v7
    v_lshl_add_u32 v7, v6, 3, v7
    s_lshl_b32 s43, s41, 12
    v_add_u32 v8, s43, v7
    v_xor_b32_e64 v9, 64, v8
    v_add_u32 v10, 0x10000, v8
    v_add_u32 v11, 0x10000, v9
    v_lshlrev_b32 v14, 4, v1
    s_barrier
    s_lshl_b32 s43, s39, 2
    s_lshl_b32 s44, s34, 1
    s_add_u32 s43, s43, s44
    s_add_u32 s43, s43, s40
    s_mul_i32 s55, s43, 114688
    s_mul_i32 s43, s43, 28672
    s_lshl_b32 s44, s35, 7
    s_add_u32 s43, s43, s44
    s_lshl_b32 s44, s41, 6
    s_add_u32 s43, s43, s44
    v_mul_u32_u24 v5, 896, v5
    v_lshl_add_u32 v5, v4, 4, v5
    v_add_u32_e64 v5, s43, v5
    s_lshl_b32 s44, s41, 11
    s_add_u32 s55, s55, s44
    s_lshl_b32 s4, s33, 13
    s_add_u32 s4, s4, s55
    s_add_u32 s54, s55, 114688
    s_add_u32 s64, s30, 2097152
    s_addc_u32 s65, s31, 0
    s_mov_b32 s66, 7340032
    s_mov_b32 s67, 0x20000
    s_barrier
    s_mov_b32 s69, 0
    s_add_u32 s68, s59, 0
    s_atomic_add s69, s[30:31], s68 glc
    s_add_u32 s5, s4, 8192
    s_cmp_ge_u32 s5, s54
    s_cselect_b32 s5, s55, s5
    s_add_u32 s6, s5, 8192
    s_cmp_ge_u32 s6, s54
    s_cselect_b32 s6, s55, s6
    s_add_u32 s7, s6, 8192
    s_cmp_ge_u32 s7, s54
    s_cselect_b32 s7, s55, s7
    s_add_u32 s8, s7, 8192
    s_cmp_ge_u32 s8, s54
    s_cselect_b32 s8, s55, s8
    s_add_u32 s9, s8, 8192
    s_cmp_ge_u32 s9, s54
    s_cselect_b32 s9, s55, s9
    s_add_u32 s10, s9, 8192
    s_cmp_ge_u32 s10, s54
    s_cselect_b32 s10, s55, s10
    s_add_u32 s11, s10, 8192
    s_cmp_ge_u32 s11, s54
    s_cselect_b32 s11, s55, s11
    s_add_u32 s12, s11, 8192
    s_cmp_ge_u32 s12, s54
    s_cselect_b32 s12, s55, s12
    s_add_u32 s13, s12, 8192
    s_cmp_ge_u32 s13, s54
    s_cselect_b32 s13, s55, s13
    s_add_u32 s14, s13, 8192
    s_cmp_ge_u32 s14, s54
    s_cselect_b32 s14, s55, s14
    s_add_u32 s15, s14, 8192
    s_cmp_ge_u32 s15, s54
    s_cselect_b32 s15, s55, s15
    s_add_u32 s16, s15, 8192
    s_cmp_ge_u32 s16, s54
    s_cselect_b32 s16, s55, s16
    s_add_u32 s17, s16, 8192
    s_cmp_ge_u32 s17, s54
    s_cselect_b32 s17, s55, s17
    s_barrier
    s_mov_b32 s70, 1
    s_waitcnt vmcnt(0)
    s_atomic_add s70, s[30:31], s58
    s_add_u32 s58, s58, 128
    v_add_u32 v12, 0x20000, v8
    v_add_u32 v13, 0x20000, v9
    s_barrier
    s_barrier
    s_waitcnt lgkmcnt(0)
    s_cmp_lt_u32 s69, 14
    s_cbranch_scc1 et_12
    buffer_load_dwordx4 v[96:99], v14, s[64:67], s4 offen offset:0 sc1
    buffer_load_dwordx4 v[100:103], v14, s[64:67], s5 offen offset:0 sc1
    buffer_load_dwordx4 v[104:107], v14, s[64:67], s6 offen offset:0 sc1
    buffer_load_dwordx4 v[108:111], v14, s[64:67], s7 offen offset:0 sc1
et_12:
    s_barrier
    s_mov_b32 s71, 0
    s_add_u32 s68, s59, 128
    s_atomic_add s71, s[30:31], s68 glc
    s_cmp_lt_u32 s69, 14
    s_cbranch_scc1 et_13
    buffer_load_dwordx4 v[112:115], v14, s[64:67], s8 offen offset:0 sc1
et_13:
    s_barrier
    v_mfma_f32_32x32x16_bf16 v[80:95], v[160:163], v[72:75], 0
    v_mfma_f32_32x32x16_bf16 v[80:95], v[164:167], v[76:79], v[80:95]
    s_cmp_lt_u32 s69, 14
    s_cbranch_scc1 et_14c
et_14:
    buffer_load_dwordx4 v[116:119], v14, s[64:67], s9 offen offset:0 sc1
    buffer_load_dwordx4 v[120:123], v14, s[64:67], s10 offen offset:0 sc1
    buffer_load_dwordx4 v[124:127], v14, s[64:67], s11 offen offset:0 sc1
    buffer_load_dwordx4 v[128:131], v14, s[64:67], s12 offen offset:0 sc1
    s_waitcnt vmcnt(8)
    buffer_load_dwordx4 v[132:135], v14, s[64:67], s13 offen offset:0 sc1
    s_waitcnt vmcnt(8)
    buffer_load_dwordx4 v[136:139], v14, s[64:67], s14 offen offset:0 sc1
    s_waitcnt vmcnt(8)
    buffer_load_dwordx4 v[140:143], v14, s[64:67], s15 offen offset:0 sc1
    s_waitcnt vmcnt(8)
    buffer_load_dwordx4 v[144:147], v14, s[64:67], s16 offen offset:0 sc1
    s_waitcnt vmcnt(8)
    buffer_load_dwordx4 v[148:151], v14, s[64:67], s17 offen offset:0 sc1
    s_waitcnt vmcnt(8)
    s_mov_b32 s45, 0
poll_17:
    s_waitcnt lgkmcnt(0)
    s_cmp_ge_u32 s71, 14
    s_cbranch_scc1 ok_18
    s_mov_b32 s71, 0
    s_add_u32 s68, s59, 128
    s_atomic_add s71, s[30:31], s68 glc
    s_add_u32 s45, s45, 1
    s_cmp_lt_u32 s45, 262144
    s_cbranch_scc1 poll_17
    s_waitcnt lgkmcnt(0)
ok_18:
    buffer_load_dwordx4 v[152:155], v14, s[64:67], s4 offen offset:1024 sc1
    s_waitcnt vmcnt(8)
    buffer_load_dwordx4 v[156:159], v14, s[64:67], s5 offen offset:1024 sc1
    s_waitcnt vmcnt(8)
    buffer_load_dwordx4 v[160:163], v14, s[64:67], s6 offen offset:1024 sc1
    s_waitcnt vmcnt(8)
    buffer_load_dwordx4 v[164:167], v14, s[64:67], s7 offen offset:1024 sc1
    s_waitcnt vmcnt(8)
    buffer_load_dwordx4 v[16:19], v14, s[64:67], s8 offen offset:1024 sc1
    s_waitcnt vmcnt(8)
    buffer_load_dwordx4 v[20:23], v14, s[64:67], s9 offen offset:1024 sc1
    s_waitcnt vmcnt(8)
    buffer_load_dwordx4 v[24:27], v14, s[64:67], s10 offen offset:1024 sc1
    s_waitcnt vmcnt(8)
    buffer_load_dwordx4 v[28:31], v14, s[64:67], s11 offen offset:1024 sc1
    s_waitcnt vmcnt(8)
    s_nop 0
    ds_read_b64_tr_b16 v[32:33], v8 offset:0
    ds_read_b64_tr_b16 v[34:35], v8 offset:1024
    ds_read_b64_tr_b16 v[36:37], v9 offset:0
    ds_read_b64_tr_b16 v[38:39], v9 offset:1024
    ds_read_b64_tr_b16 v[40:41], v8 offset:2048
    ds_read_b64_tr_b16 v[42:43], v8 offset:3072
    ds_read_b64_tr_b16 v[44:45], v9 offset:2048
    ds_read_b64_tr_b16 v[46:47], v9 offset:3072
    s_barrier
    s_waitcnt vmcnt(21) lgkmcnt(4)
    v_mfma_f32_32x32x16_bf16 v[64:79], v[36:39], v[96:99], 0
    ds_read_b64_tr_b16 v[48:49], v8 offset:8192
    ds_read_b64_tr_b16 v[50:51], v8 offset:9216
    v_mfma_f32_32x32x16_bf16 v[80:95], v[32:35], v[96:99], v[80:95]
    ds_read_b64_tr_b16 v[52:53], v9 offset:8192
    ds_read_b64_tr_b16 v[54:55], v9 offset:9216
    s_waitcnt vmcnt(7) lgkmcnt(4)
    s_nop 0
    v_mfma_f32_32x32x16_bf16 v[64:79], v[44:47], v[152:155], v[64:79]
    buffer_load_dwordx4 v[96:99], v14, s[64:67], s12 offen offset:1024 sc1
    ds_read_b64_tr_b16 v[56:57], v8 offset:10240
    ds_read_b64_tr_b16 v[58:59], v8 offset:11264
    v_mfma_f32_32x32x16_bf16 v[80:95], v[40:43], v[152:155], v[80:95]
    ds_read_b64_tr_b16 v[60:61], v9 offset:10240
    ds_read_b64_tr_b16 v[62:63], v9 offset:11264
    s_waitcnt vmcnt(21) lgkmcnt(4)
    s_nop 0
    v_mfma_f32_32x32x16_bf16 v[64:79], v[52:55], v[100:103], v[64:79]
    buffer_load_dwordx4 v[152:155], v14, s[64:67], s13 offen offset:1024 sc1
    ds_read_b64_tr_b16 v[32:33], v8 offset:16384
    ds_read_b64_tr_b16 v[34:35], v8 offset:17408
    v_mfma_f32_32x32x16_bf16 v[80:95], v[48:51], v[100:103], v[80:95]
    ds_read_b64_tr_b16 v[36:37], v9 offset:16384
    ds_read_b64_tr_b16 v[38:39], v9 offset:17408
    s_waitcnt vmcnt(8) lgkmcnt(4)
    s_nop 0
    v_mfma_f32_32x32x16_bf16 v[64:79], v[60:63], v[156:159], v[64:79]
    buffer_load_dwordx4 v[100:103], v14, s[64:67], s14 offen offset:1024 sc1
    ds_read_b64_tr_b16 v[40:41], v8 offset:18432
    ds_read_b64_tr_b16 v[42:43], v8 offset:19456
    v_mfma_f32_32x32x16_bf16 v[80:95], v[56:59], v[156:159], v[80:95]
    ds_read_b64_tr_b16 v[44:45], v9 offset:18432
    ds_read_b64_tr_b16 v[46:47], v9 offset:19456
    s_waitcnt vmcnt(22) lgkmcnt(4)
    s_nop 0
    v_mfma_f32_32x32x16_bf16 v[64:79], v[36:39], v[104:107], v[64:79]
    buffer_load_dwordx4 v[156:159], v14, s[64:67], s15 offen offset:1024 sc1
    ds_read_b64_tr_b16 v[48:49], v8 offset:24576
    ds_read_b64_tr_b16 v[50:51], v8 offset:25600
    v_mfma_f32_32x32x16_bf16 v[80:95], v[32:35], v[104:107], v[80:95]
    ds_read_b64_tr_b16 v[52:53], v9 offset:24576
    ds_read_b64_tr_b16 v[54:55], v9 offset:25600
    s_waitcnt vmcnt(9) lgkmcnt(4)
    s_nop 0
    v_mfma_f32_32x32x16_bf16 v[64:79], v[44:47], v[160:163], v[64:79]
    buffer_load_dwordx4 v[104:107], v14, s[64:67], s16 offen offset:1024 sc1
    ds_read_b64_tr_b16 v[56:57], v8 offset:26624
    ds_read_b64_tr_b16 v[58:59], v8 offset:27648
    v_mfma_f32_32x32x16_bf16 v[80:95], v[40:43], v[160:163], v[80:95]
    ds_read_b64_tr_b16 v[60:61], v9 offset:26624
    ds_read_b64_tr_b16 v[62:63], v9 offset:27648
    s_waitcnt vmcnt(23) lgkmcnt(4)
    s_nop 0
    v_mfma_f32_32x32x16_bf16 v[64:79], v[52:55], v[108:111], v[64:79]
    buffer_load_dwordx4 v[160:163], v14, s[64:67], s17 offen offset:1024 sc1
    ds_read_b64_tr_b16 v[32:33], v8 offset:32768
    ds_read_b64_tr_b16 v[34:35], v8 offset:33792
    v_mfma_f32_32x32x16_bf16 v[80:95], v[48:51], v[108:111], v[80:95]
    ds_read_b64_tr_b16 v[36:37], v9 offset:32768
    ds_read_b64_tr_b16 v[38:39], v9 offset:33792
    s_waitcnt vmcnt(10) lgkmcnt(4)
    s_nop 0
    v_mfma_f32_32x32x16_bf16 v[64:79], v[60:63], v[164:167], v[64:79]
    ds_read_b64_tr_b16 v[40:41], v8 offset:34816
    ds_read_b64_tr_b16 v[42:43], v8 offset:35840
    v_mfma_f32_32x32x16_bf16 v[80:95], v[56:59], v[164:167], v[80:95]
    ds_read_b64_tr_b16 v[44:45], v9 offset:34816
    ds_read_b64_tr_b16 v[46:47], v9 offset:35840
    s_waitcnt vmcnt(23) lgkmcnt(4)
    s_nop 0
    v_mfma_f32_32x32x16_bf16 v[64:79], v[36:39], v[112:115], v[64:79]
    ds_read_b64_tr_b16 v[48:49], v8 offset:40960
    ds_read_b64_tr_b16 v[50:51], v8 offset:41984
    v_mfma_f32_32x32x16_bf16 v[80:95], v[32:35], v[112:115], v[80:95]
    ds_read_b64_tr_b16 v[52:53], v9 offset:40960
    ds_read_b64_tr_b16 v[54:55], v9 offset:41984
    s_waitcnt vmcnt(9) lgkmcnt(4)
    s_nop 0
    v_mfma_f32_32x32x16_bf16 v[64:79], v[44:47], v[16:19], v[64:79]
    ds_read_b64_tr_b16 v[56:57], v8 offset:43008
    ds_read_b64_tr_b16 v[58:59], v8 offset:44032
    v_mfma_f32_32x32x16_bf16 v[80:95], v[40:43], v[16:19], v[80:95]
    ds_read_b64_tr_b16 v[60:61], v9 offset:43008
    ds_read_b64_tr_b16 v[62:63], v9 offset:44032
    s_waitcnt vmcnt(22) lgkmcnt(4)
    s_nop 0
    v_mfma_f32_32x32x16_bf16 v[64:79], v[52:55], v[116:119], v[64:79]
    ds_read_b64_tr_b16 v[32:33], v8 offset:49152
    ds_read_b64_tr_b16 v[34:35], v8 offset:50176
    v_mfma_f32_32x32x16_bf16 v[80:95], v[48:51], v[116:119], v[80:95]
    ds_read_b64_tr_b16 v[36:37], v9 offset:49152
    ds_read_b64_tr_b16 v[38:39], v9 offset:50176
    s_waitcnt vmcnt(8) lgkmcnt(4)
    s_nop 0
    v_mfma_f32_32x32x16_bf16 v[64:79], v[60:63], v[20:23], v[64:79]
    ds_read_b64_tr_b16 v[40:41], v8 offset:51200
    ds_read_b64_tr_b16 v[42:43], v8 offset:52224
    v_mfma_f32_32x32x16_bf16 v[80:95], v[56:59], v[20:23], v[80:95]
    ds_read_b64_tr_b16 v[44:45], v9 offset:51200
    ds_read_b64_tr_b16 v[46:47], v9 offset:52224
    s_waitcnt vmcnt(21) lgkmcnt(4)
    s_nop 0
    v_mfma_f32_32x32x16_bf16 v[64:79], v[36:39], v[120:123], v[64:79]
    ds_read_b64_tr_b16 v[48:49], v8 offset:57344
    ds_read_b64_tr_b16 v[50:51], v8 offset:58368
    v_mfma_f32_32x32x16_bf16 v[80:95], v[32:35], v[120:123], v[80:95]
    ds_read_b64_tr_b16 v[52:53], v9 offset:57344
    ds_read_b64_tr_b16 v[54:55], v9 offset:58368
    s_waitcnt vmcnt(7) lgkmcnt(4)
    s_nop 0
    v_mfma_f32_32x32x16_bf16 v[64:79], v[44:47], v[24:27], v[64:79]
    ds_read_b64_tr_b16 v[56:57], v8 offset:59392
    ds_read_b64_tr_b16 v[58:59], v8 offset:60416
    v_mfma_f32_32x32x16_bf16 v[80:95], v[40:43], v[24:27], v[80:95]
    ds_read_b64_tr_b16 v[60:61], v9 offset:59392
    ds_read_b64_tr_b16 v[62:63], v9 offset:60416
    s_waitcnt lgkmcnt(0)
    s_barrier
    s_waitcnt vmcnt(20) lgkmcnt(4)
    s_nop 0
    v_mfma_f32_32x32x16_bf16 v[64:79], v[52:55], v[124:127], v[64:79]
    ds_read_b64_tr_b16 v[32:33], v10 offset:0
    ds_read_b64_tr_b16 v[34:35], v10 offset:1024
    v_mfma_f32_32x32x16_bf16 v[80:95], v[48:51], v[124:127], v[80:95]
    ds_read_b64_tr_b16 v[36:37], v11 offset:0
    ds_read_b64_tr_b16 v[38:39], v11 offset:1024
    s_waitcnt vmcnt(6) lgkmcnt(4)
    s_nop 0
    v_mfma_f32_32x32x16_bf16 v[64:79], v[60:63], v[28:31], v[64:79]
    ds_read_b64_tr_b16 v[40:41], v10 offset:2048
    ds_read_b64_tr_b16 v[42:43], v10 offset:3072
    v_mfma_f32_32x32x16_bf16 v[80:95], v[56:59], v[28:31], v[80:95]
    ds_read_b64_tr_b16 v[44:45], v11 offset:2048
    ds_read_b64_tr_b16 v[46:47], v11 offset:3072
    s_waitcnt vmcnt(19) lgkmcnt(4)
    s_nop 0
    v_mfma_f32_32x32x16_bf16 v[64:79], v[36:39], v[128:131], v[64:79]
    ds_read_b64_tr_b16 v[48:49], v10 offset:49152
    ds_read_b64_tr_b16 v[50:51], v10 offset:50176
    v_mfma_f32_32x32x16_bf16 v[80:95], v[32:35], v[128:131], v[80:95]
    ds_read_b64_tr_b16 v[52:53], v11 offset:49152
    ds_read_b64_tr_b16 v[54:55], v11 offset:50176
    s_barrier
    s_waitcnt vmcnt(5) lgkmcnt(4)
    v_mfma_f32_32x32x16_bf16 v[64:79], v[44:47], v[96:99], v[64:79]
    v_add_u32 v15, 4096, v14
    buffer_load_dwordx4 v[108:111], v15, s[64:67], s4 offen offset:0 sc1
    ds_read_b64_tr_b16 v[56:57], v10 offset:51200
    ds_read_b64_tr_b16 v[58:59], v10 offset:52224
    v_mfma_f32_32x32x16_bf16 v[80:95], v[40:43], v[96:99], v[80:95]
    buffer_load_dwordx4 v[164:167], v15, s[64:67], s5 offen offset:0 sc1
    ds_read_b64_tr_b16 v[60:61], v11 offset:51200
    ds_read_b64_tr_b16 v[62:63], v11 offset:52224
    s_waitcnt vmcnt(20) lgkmcnt(4)
    s_nop 0
    v_mfma_f32_32x32x16_bf16 v[64:79], v[52:55], v[132:135], v[64:79]
    buffer_load_dwordx4 v[112:115], v15, s[64:67], s6 offen offset:0 sc1
    ds_read_b64_tr_b16 v[32:33], v10 offset:8192
    ds_read_b64_tr_b16 v[34:35], v10 offset:9216
    v_mfma_f32_32x32x16_bf16 v[80:95], v[48:51], v[132:135], v[80:95]
    buffer_load_dwordx4 v[16:19], v15, s[64:67], s7 offen offset:0 sc1
    ds_read_b64_tr_b16 v[36:37], v11 offset:8192
    ds_read_b64_tr_b16 v[38:39], v11 offset:9216
    s_waitcnt vmcnt(8) lgkmcnt(4)
    s_nop 0
    v_mfma_f32_32x32x16_bf16 v[64:79], v[60:63], v[152:155], v[64:79]
    buffer_load_dwordx4 v[116:119], v15, s[64:67], s8 offen offset:0 sc1
    ds_read_b64_tr_b16 v[40:41], v10 offset:10240
    ds_read_b64_tr_b16 v[42:43], v10 offset:11264
    v_mfma_f32_32x32x16_bf16 v[80:95], v[56:59], v[152:155], v[80:95]
    buffer_load_dwordx4 v[20:23], v15, s[64:67], s9 offen offset:0 sc1
    ds_read_b64_tr_b16 v[44:45], v11 offset:10240
    ds_read_b64_tr_b16 v[46:47], v11 offset:11264
    s_waitcnt vmcnt(23) lgkmcnt(4)
    s_nop 0
    s_branch Lpg2
.p2align 12
Lpw2:
    s_setpc_b64 s[96:97]
    s_nop 0
Lpg2:
    v_mfma_f32_32x32x16_bf16 v[64:79], v[36:39], v[136:139], v[64:79]
    buffer_load_dwordx4 v[120:123], v15, s[64:67], s10 offen offset:0 sc1
    ds_read_b64_tr_b16 v[48:49], v10 offset:57344
    ds_read_b64_tr_b16 v[50:51], v10 offset:58368
    v_mfma_f32_32x32x16_bf16 v[80:95], v[32:35], v[136:139], v[80:95]
    buffer_load_dwordx4 v[24:27], v15, s[64:67], s11 offen offset:0 sc1
    ds_read_b64_tr_b16 v[52:53], v11 offset:57344
    ds_read_b64_tr_b16 v[54:55], v11 offset:58368
    s_waitcnt vmcnt(11) lgkmcnt(4)
    s_nop 0
    v_mfma_f32_32x32x16_bf16 v[64:79], v[44:47], v[100:103], v[64:79]
    buffer_load_dwordx4 v[124:127], v15, s[64:67], s12 offen offset:0 sc1
    ds_read_b64_tr_b16 v[56:57], v10 offset:59392
    ds_read_b64_tr_b16 v[58:59], v10 offset:60416
    v_mfma_f32_32x32x16_bf16 v[80:95], v[40:43], v[100:103], v[80:95]
    buffer_load_dwordx4 v[28:31], v15, s[64:67], s13 offen offset:0 sc1
    ds_read_b64_tr_b16 v[60:61], v11 offset:59392
    ds_read_b64_tr_b16 v[62:63], v11 offset:60416
    s_waitcnt vmcnt(26) lgkmcnt(4)
    s_nop 0
    v_mfma_f32_32x32x16_bf16 v[64:79], v[52:55], v[140:143], v[64:79]
    buffer_load_dwordx4 v[128:131], v15, s[64:67], s14 offen offset:0 sc1
    ds_read_b64_tr_b16 v[32:33], v10 offset:16384
    ds_read_b64_tr_b16 v[34:35], v10 offset:17408
    v_mfma_f32_32x32x16_bf16 v[80:95], v[48:51], v[140:143], v[80:95]
    buffer_load_dwordx4 v[96:99], v15, s[64:67], s15 offen offset:0 sc1
    ds_read_b64_tr_b16 v[36:37], v11 offset:16384
    ds_read_b64_tr_b16 v[38:39], v11 offset:17408
    s_waitcnt vmcnt(14) lgkmcnt(4)
    s_nop 0
    v_mfma_f32_32x32x16_bf16 v[64:79], v[60:63], v[156:159], v[64:79]
    buffer_load_dwordx4 v[132:135], v15, s[64:67], s16 offen offset:0 sc1
    ds_read_b64_tr_b16 v[40:41], v10 offset:18432
    ds_read_b64_tr_b16 v[42:43], v10 offset:19456
    v_mfma_f32_32x32x16_bf16 v[80:95], v[56:59], v[156:159], v[80:95]
    buffer_load_dwordx4 v[152:155], v15, s[64:67], s17 offen offset:0 sc1
    ds_read_b64_tr_b16 v[44:45], v11 offset:18432
    ds_read_b64_tr_b16 v[46:47], v11 offset:19456
    s_barrier
    s_waitcnt vmcnt(29) lgkmcnt(4)
    v_mfma_f32_32x32x16_bf16 v[64:79], v[36:39], v[144:147], v[64:79]
    buffer_load_dwordx4 v[136:139], v15, s[64:67], s4 offen offset:1024 sc1
    ds_read_b64_tr_b16 v[48:49], v12 offset:0
    ds_read_b64_tr_b16 v[50:51], v12 offset:1024
    v_mfma_f32_32x32x16_bf16 v[80:95], v[32:35], v[144:147], v[80:95]
    buffer_load_dwordx4 v[100:103], v15, s[64:67], s5 offen offset:1024 sc1
    ds_read_b64_tr_b16 v[52:53], v13 offset:0
    ds_read_b64_tr_b16 v[54:55], v13 offset:1024
    s_waitcnt vmcnt(17) lgkmcnt(4)
    s_nop 0
    v_mfma_f32_32x32x16_bf16 v[64:79], v[44:47], v[104:107], v[64:79]
    buffer_load_dwordx4 v[140:143], v15, s[64:67], s6 offen offset:1024 sc1
    ds_read_b64_tr_b16 v[56:57], v12 offset:2048
    ds_read_b64_tr_b16 v[58:59], v12 offset:3072
    v_mfma_f32_32x32x16_bf16 v[80:95], v[40:43], v[104:107], v[80:95]
    buffer_load_dwordx4 v[156:159], v15, s[64:67], s7 offen offset:1024 sc1
    ds_read_b64_tr_b16 v[60:61], v13 offset:2048
    ds_read_b64_tr_b16 v[62:63], v13 offset:3072
    s_waitcnt vmcnt(32) lgkmcnt(4)
    s_nop 0
    v_mfma_f32_32x32x16_bf16 v[64:79], v[52:55], v[148:151], v[64:79]
    buffer_load_dwordx4 v[144:147], v15, s[64:67], s8 offen offset:1024 sc1
    ds_read_b64_tr_b16 v[32:33], v10 offset:24576
    ds_read_b64_tr_b16 v[34:35], v10 offset:25600
    v_mfma_f32_32x32x16_bf16 v[80:95], v[48:51], v[148:151], v[80:95]
    buffer_load_dwordx4 v[104:107], v15, s[64:67], s9 offen offset:1024 sc1
    ds_read_b64_tr_b16 v[36:37], v11 offset:24576
    ds_read_b64_tr_b16 v[38:39], v11 offset:25600
    s_waitcnt vmcnt(20) lgkmcnt(4)
    s_nop 0
    v_mfma_f32_32x32x16_bf16 v[64:79], v[60:63], v[160:163], v[64:79]
    buffer_load_dwordx4 v[148:151], v15, s[64:67], s10 offen offset:1024 sc1
    ds_read_b64_tr_b16 v[40:41], v12 offset:24576
    ds_read_b64_tr_b16 v[42:43], v12 offset:25600
    v_mfma_f32_32x32x16_bf16 v[80:95], v[56:59], v[160:163], v[80:95]
    ds_read_b64_tr_b16 v[44:45], v13 offset:24576
    ds_read_b64_tr_b16 v[46:47], v13 offset:25600
    s_waitcnt vmcnt(20) lgkmcnt(4)
    s_nop 0
    v_mfma_f32_32x32x16_bf16 v[64:79], v[36:39], v[108:111], v[64:79]
    ds_read_b64_tr_b16 v[48:49], v10 offset:32768
    ds_read_b64_tr_b16 v[50:51], v10 offset:33792
    v_mfma_f32_32x32x16_bf16 v[80:95], v[32:35], v[108:111], v[80:95]
    buffer_load_dwordx4 v[160:163], v15, s[64:67], s11 offen offset:1024 sc1
    ds_read_b64_tr_b16 v[52:53], v11 offset:32768
    ds_read_b64_tr_b16 v[54:55], v11 offset:33792
    s_waitcnt vmcnt(20) lgkmcnt(4)
    s_nop 0
    v_mfma_f32_32x32x16_bf16 v[64:79], v[44:47], v[164:167], v[64:79]
    ds_read_b64_tr_b16 v[56:57], v12 offset:8192
    ds_read_b64_tr_b16 v[58:59], v12 offset:9216
    v_mfma_f32_32x32x16_bf16 v[80:95], v[40:43], v[164:167], v[80:95]
    buffer_load_dwordx4 v[108:111], v15, s[64:67], s12 offen offset:1024 sc1
    ds_read_b64_tr_b16 v[60:61], v13 offset:8192
    ds_read_b64_tr_b16 v[62:63], v13 offset:9216
    s_waitcnt vmcnt(20) lgkmcnt(4)
    s_nop 0
    v_mfma_f32_32x32x16_bf16 v[64:79], v[52:55], v[112:115], v[64:79]
    ds_read_b64_tr_b16 v[32:33], v10 offset:40960
    ds_read_b64_tr_b16 v[34:35], v10 offset:41984
    v_mfma_f32_32x32x16_bf16 v[80:95], v[48:51], v[112:115], v[80:95]
    buffer_load_dwordx4 v[164:167], v15, s[64:67], s13 offen offset:1024 sc1
    ds_read_b64_tr_b16 v[36:37], v11 offset:40960
    ds_read_b64_tr_b16 v[38:39], v11 offset:41984
    s_waitcnt vmcnt(20) lgkmcnt(4)
    s_nop 0
    v_mfma_f32_32x32x16_bf16 v[64:79], v[60:63], v[16:19], v[64:79]
    ds_read_b64_tr_b16 v[40:41], v12 offset:16384
    ds_read_b64_tr_b16 v[42:43], v12 offset:17408
    v_mfma_f32_32x32x16_bf16 v[80:95], v[56:59], v[16:19], v[80:95]
    buffer_load_dwordx4 v[112:115], v15, s[64:67], s14 offen offset:1024 sc1
    ds_read_b64_tr_b16 v[44:45], v13 offset:16384
    ds_read_b64_tr_b16 v[46:47], v13 offset:17408
    s_waitcnt vmcnt(20) lgkmcnt(4)
    s_nop 0
    v_mfma_f32_32x32x16_bf16 v[64:79], v[36:39], v[116:119], v[64:79]
    ds_read_b64_tr_b16 v[48:49], v8 offset:0
    ds_read_b64_tr_b16 v[50:51], v8 offset:1024
    v_mfma_f32_32x32x16_bf16 v[80:95], v[32:35], v[116:119], v[80:95]
    buffer_load_dwordx4 v[16:19], v15, s[64:67], s15 offen offset:1024 sc1
    ds_read_b64_tr_b16 v[52:53], v9 offset:0
    ds_read_b64_tr_b16 v[54:55], v9 offset:1024
    s_waitcnt vmcnt(20) lgkmcnt(4)
    s_nop 0
    v_mfma_f32_32x32x16_bf16 v[64:79], v[44:47], v[20:23], v[64:79]
    ds_read_b64_tr_b16 v[56:57], v8 offset:8192
    ds_read_b64_tr_b16 v[58:59], v8 offset:9216
    v_mfma_f32_32x32x16_bf16 v[80:95], v[40:43], v[20:23], v[80:95]
    buffer_load_dwordx4 v[116:119], v15, s[64:67], s16 offen offset:1024 sc1
    ds_read_b64_tr_b16 v[60:61], v9 offset:8192
    ds_read_b64_tr_b16 v[62:63], v9 offset:9216
    s_waitcnt vmcnt(20) lgkmcnt(4)
    s_nop 0
    v_mfma_f32_32x32x16_bf16 v[64:79], v[52:55], v[120:123], v[64:79]
    ds_read_b64_tr_b16 v[32:33], v8 offset:16384
    ds_read_b64_tr_b16 v[34:35], v8 offset:17408
    v_mfma_f32_32x32x16_bf16 v[80:95], v[48:51], v[120:123], v[80:95]
    buffer_load_dwordx4 v[20:23], v15, s[64:67], s17 offen offset:1024 sc1
    ds_read_b64_tr_b16 v[36:37], v9 offset:16384
    ds_read_b64_tr_b16 v[38:39], v9 offset:17408
    s_waitcnt vmcnt(20) lgkmcnt(4)
    s_nop 0
    v_mfma_f32_32x32x16_bf16 v[64:79], v[60:63], v[24:27], v[64:79]
    ds_read_b64_tr_b16 v[40:41], v8 offset:24576
    ds_read_b64_tr_b16 v[42:43], v8 offset:25600
    v_mfma_f32_32x32x16_bf16 v[80:95], v[56:59], v[24:27], v[80:95]
    ds_read_b64_tr_b16 v[44:45], v9 offset:24576
    ds_read_b64_tr_b16 v[46:47], v9 offset:25600
    s_waitcnt vmcnt(19) lgkmcnt(4)
    s_nop 0
    v_mfma_f32_32x32x16_bf16 v[64:79], v[36:39], v[124:127], v[64:79]
    ds_read_b64_tr_b16 v[48:49], v8 offset:32768
    ds_read_b64_tr_b16 v[50:51], v8 offset:33792
    v_mfma_f32_32x32x16_bf16 v[80:95], v[32:35], v[124:127], v[80:95]
    ds_read_b64_tr_b16 v[52:53], v9 offset:32768
    ds_read_b64_tr_b16 v[54:55], v9 offset:33792
    s_waitcnt vmcnt(18) lgkmcnt(4)
    s_nop 0
    v_mfma_f32_32x32x16_bf16 v[64:79], v[44:47], v[28:31], v[64:79]
    ds_read_b64_tr_b16 v[56:57], v8 offset:40960
    ds_read_b64_tr_b16 v[58:59], v8 offset:41984
    v_mfma_f32_32x32x16_bf16 v[80:95], v[40:43], v[28:31], v[80:95]
    ds_read_b64_tr_b16 v[60:61], v9 offset:40960
    ds_read_b64_tr_b16 v[62:63], v9 offset:41984
    s_waitcnt vmcnt(17) lgkmcnt(4)
    s_nop 0
    v_mfma_f32_32x32x16_bf16 v[64:79], v[52:55], v[128:131], v[64:79]
    ds_read_b64_tr_b16 v[32:33], v8 offset:49152
    ds_read_b64_tr_b16 v[34:35], v8 offset:50176
    v_mfma_f32_32x32x16_bf16 v[80:95], v[48:51], v[128:131], v[80:95]
    ds_read_b64_tr_b16 v[36:37], v9 offset:49152
    ds_read_b64_tr_b16 v[38:39], v9 offset:50176
    s_waitcnt vmcnt(16) lgkmcnt(4)
    s_nop 0
    v_mfma_f32_32x32x16_bf16 v[64:79], v[60:63], v[96:99], v[64:79]
    ds_read_b64_tr_b16 v[40:41], v8 offset:57344
    ds_read_b64_tr_b16 v[42:43], v8 offset:58368
    v_mfma_f32_32x32x16_bf16 v[80:95], v[56:59], v[96:99], v[80:95]
    ds_read_b64_tr_b16 v[44:45], v9 offset:57344
    ds_read_b64_tr_b16 v[46:47], v9 offset:58368
    s_waitcnt vmcnt(15) lgkmcnt(4)
    s_nop 0
    v_mfma_f32_32x32x16_bf16 v[64:79], v[36:39], v[132:135], v[64:79]
    ds_read_b64_tr_b16 v[48:49], v10 offset:26624
    ds_read_b64_tr_b16 v[50:51], v10 offset:27648
    v_mfma_f32_32x32x16_bf16 v[80:95], v[32:35], v[132:135], v[80:95]
    ds_read_b64_tr_b16 v[52:53], v11 offset:26624
    ds_read_b64_tr_b16 v[54:55], v11 offset:27648
    s_waitcnt vmcnt(14) lgkmcnt(4)
    s_nop 0
    v_mfma_f32_32x32x16_bf16 v[64:79], v[44:47], v[152:155], v[64:79]
    ds_read_b64_tr_b16 v[56:57], v12 offset:26624
    ds_read_b64_tr_b16 v[58:59], v12 offset:27648
    v_mfma_f32_32x32x16_bf16 v[80:95], v[40:43], v[152:155], v[80:95]
    ds_read_b64_tr_b16 v[60:61], v13 offset:26624
    ds_read_b64_tr_b16 v[62:63], v13 offset:27648
    s_waitcnt vmcnt(13) lgkmcnt(4)
    s_nop 0
    v_mfma_f32_32x32x16_bf16 v[64:79], v[52:55], v[136:139], v[64:79]
    ds_read_b64_tr_b16 v[32:33], v10 offset:34816
    ds_read_b64_tr_b16 v[34:35], v10 offset:35840
    v_mfma_f32_32x32x16_bf16 v[80:95], v[48:51], v[136:139], v[80:95]
    ds_read_b64_tr_b16 v[36:37], v11 offset:34816
    ds_read_b64_tr_b16 v[38:39], v11 offset:35840
    s_waitcnt vmcnt(12) lgkmcnt(4)
    s_nop 0
    v_mfma_f32_32x32x16_bf16 v[64:79], v[60:63], v[100:103], v[64:79]
    ds_read_b64_tr_b16 v[40:41], v12 offset:10240
    ds_read_b64_tr_b16 v[42:43], v12 offset:11264
    v_mfma_f32_32x32x16_bf16 v[80:95], v[56:59], v[100:103], v[80:95]
    ds_read_b64_tr_b16 v[44:45], v13 offset:10240
    ds_read_b64_tr_b16 v[46:47], v13 offset:11264
    s_waitcnt vmcnt(11) lgkmcnt(4)
    s_nop 0
    v_mfma_f32_32x32x16_bf16 v[64:79], v[36:39], v[140:143], v[64:79]
    ds_read_b64_tr_b16 v[48:49], v10 offset:43008
    ds_read_b64_tr_b16 v[50:51], v10 offset:44032
    v_mfma_f32_32x32x16_bf16 v[80:95], v[32:35], v[140:143], v[80:95]
    ds_read_b64_tr_b16 v[52:53], v11 offset:43008
    ds_read_b64_tr_b16 v[54:55], v11 offset:44032
    s_waitcnt vmcnt(10) lgkmcnt(4)
    s_nop 0
    v_mfma_f32_32x32x16_bf16 v[64:79], v[44:47], v[156:159], v[64:79]
    ds_read_b64_tr_b16 v[56:57], v12 offset:18432
    ds_read_b64_tr_b16 v[58:59], v12 offset:19456
    v_mfma_f32_32x32x16_bf16 v[80:95], v[40:43], v[156:159], v[80:95]
    ds_read_b64_tr_b16 v[60:61], v13 offset:18432
    ds_read_b64_tr_b16 v[62:63], v13 offset:19456
    s_waitcnt vmcnt(9) lgkmcnt(4)
    s_nop 0
    v_mfma_f32_32x32x16_bf16 v[64:79], v[52:55], v[144:147], v[64:79]
    ds_read_b64_tr_b16 v[32:33], v8 offset:2048
    ds_read_b64_tr_b16 v[34:35], v8 offset:3072
    v_mfma_f32_32x32x16_bf16 v[80:95], v[48:51], v[144:147], v[80:95]
    ds_read_b64_tr_b16 v[36:37], v9 offset:2048
    ds_read_b64_tr_b16 v[38:39], v9 offset:3072
    s_waitcnt vmcnt(8) lgkmcnt(4)
    s_nop 0
    v_mfma_f32_32x32x16_bf16 v[64:79], v[60:63], v[104:107], v[64:79]
    ds_read_b64_tr_b16 v[40:41], v8 offset:10240
    ds_read_b64_tr_b16 v[42:43], v8 offset:11264
    v_mfma_f32_32x32x16_bf16 v[80:95], v[56:59], v[104:107], v[80:95]
    ds_read_b64_tr_b16 v[44:45], v9 offset:10240
    ds_read_b64_tr_b16 v[46:47], v9 offset:11264
    s_waitcnt vmcnt(7) lgkmcnt(4)
    s_nop 0
    v_mfma_f32_32x32x16_bf16 v[64:79], v[36:39], v[148:151], v[64:79]
    ds_read_b64_tr_b16 v[48:49], v8 offset:18432
    ds_read_b64_tr_b16 v[50:51], v8 offset:19456
    v_mfma_f32_32x32x16_bf16 v[80:95], v[32:35], v[148:151], v[80:95]
    ds_read_b64_tr_b16 v[52:53], v9 offset:18432
    ds_read_b64_tr_b16 v[54:55], v9 offset:19456
    s_waitcnt vmcnt(6) lgkmcnt(4)
    s_nop 0
    v_mfma_f32_32x32x16_bf16 v[64:79], v[44:47], v[160:163], v[64:79]
    ds_read_b64_tr_b16 v[56:57], v8 offset:26624
    ds_read_b64_tr_b16 v[58:59], v8 offset:27648
    v_mfma_f32_32x32x16_bf16 v[80:95], v[40:43], v[160:163], v[80:95]
    ds_read_b64_tr_b16 v[60:61], v9 offset:26624
    ds_read_b64_tr_b16 v[62:63], v9 offset:27648
    s_waitcnt vmcnt(5) lgkmcnt(4)
    s_nop 0
    v_mfma_f32_32x32x16_bf16 v[64:79], v[52:55], v[108:111], v[64:79]
    ds_read_b64_tr_b16 v[32:33], v8 offset:34816
    ds_read_b64_tr_b16 v[34:35], v8 offset:35840
    v_mfma_f32_32x32x16_bf16 v[80:95], v[48:51], v[108:111], v[80:95]
    ds_read_b64_tr_b16 v[36:37], v9 offset:34816
    ds_read_b64_tr_b16 v[38:39], v9 offset:35840
    s_waitcnt vmcnt(4) lgkmcnt(4)
    s_nop 0
    v_mfma_f32_32x32x16_bf16 v[64:79], v[60:63], v[164:167], v[64:79]
    ds_read_b64_tr_b16 v[40:41], v8 offset:43008
    ds_read_b64_tr_b16 v[42:43], v8 offset:44032
    v_mfma_f32_32x32x16_bf16 v[80:95], v[56:59], v[164:167], v[80:95]
    ds_read_b64_tr_b16 v[44:45], v9 offset:43008
    ds_read_b64_tr_b16 v[46:47], v9 offset:44032
    s_waitcnt vmcnt(3) lgkmcnt(4)
    s_nop 0
    v_mfma_f32_32x32x16_bf16 v[64:79], v[36:39], v[112:115], v[64:79]
    ds_read_b64_tr_b16 v[48:49], v8 offset:51200
    ds_read_b64_tr_b16 v[50:51], v8 offset:52224
    v_mfma_f32_32x32x16_bf16 v[80:95], v[32:35], v[112:115], v[80:95]
    ds_read_b64_tr_b16 v[52:53], v9 offset:51200
    ds_read_b64_tr_b16 v[54:55], v9 offset:52224
    s_waitcnt vmcnt(2) lgkmcnt(4)
    v_mfma_f32_32x32x16_bf16 v[64:79], v[44:47], v[16:19], v[64:79]
    ds_read_b64_tr_b16 v[56:57], v8 offset:59392
    ds_read_b64_tr_b16 v[58:59], v8 offset:60416
    ds_read_b64_tr_b16 v[60:61], v9 offset:59392
    ds_read_b64_tr_b16 v[62:63], v9 offset:60416
    s_waitcnt vmcnt(1) lgkmcnt(4)
    v_mfma_f32_32x32x16_bf16 v[64:79], v[52:55], v[116:119], v[64:79]
    s_waitcnt vmcnt(0) lgkmcnt(0)
    v_mfma_f32_32x32x16_bf16 v[64:79], v[60:63], v[20:23], v[64:79]
    s_lshl_b32 s43, s36, 12
    s_add_u32 s43, s43, 65536
    v_lshl_add_u32 v2, v1, 4, s43
    v_xor_b32 v3, 0x2000, v2
    v_mfma_f32_32x32x16_bf16 v[80:95], v[40:43], v[16:19], v[80:95]
    s_nop 6
    s_nop 0
    ds_write_b128 v2, v[64:67] offset:0
    v_mfma_f32_32x32x16_bf16 v[80:95], v[48:51], v[116:119], v[80:95]
    ds_write_b128 v2, v[68:71] offset:1024
    ds_write_b128 v2, v[72:75] offset:2048
    v_mfma_f32_32x32x16_bf16 v[80:95], v[56:59], v[20:23], v[80:95]
    ds_write_b128 v2, v[76:79] offset:3072
    s_waitcnt lgkmcnt(0)
    s_barrier
    ds_read_b128 v[64:67], v3 offset:0
    ds_read_b128 v[68:71], v3 offset:1024
    ds_read_b128 v[72:75], v3 offset:2048
    ds_read_b128 v[76:79], v3 offset:3072
    s_waitcnt lgkmcnt(2)
    s_nop 3
    v_pk_add_f32 v[80:81], v[80:81], v[64:65]
    v_pk_add_f32 v[82:83], v[82:83], v[66:67]
    v_pk_add_f32 v[84:85], v[84:85], v[68:69]
    v_pk_add_f32 v[86:87], v[86:87], v[70:71]
    v_cvt_pk_bf16_f32 v48, v80, v81
    v_cvt_pk_bf16_f32 v49, v82, v83
    v_cvt_pk_bf16_f32 v50, v84, v85
    v_cvt_pk_bf16_f32 v51, v86, v87
    s_nop 0
    v_permlane32_swap_b32 v48, v50
    v_permlane32_swap_b32 v49, v51
    global_store_dwordx4 v5, v[48:51], s[26:27] offset:0
    s_waitcnt lgkmcnt(0)
    v_pk_add_f32 v[88:89], v[88:89], v[72:73]
    v_pk_add_f32 v[90:91], v[90:91], v[74:75]
    v_pk_add_f32 v[92:93], v[92:93], v[76:77]
    v_pk_add_f32 v[94:95], v[94:95], v[78:79]
    v_cvt_pk_bf16_f32 v52, v88, v89
    v_cvt_pk_bf16_f32 v53, v90, v91
    v_cvt_pk_bf16_f32 v54, v92, v93
    v_cvt_pk_bf16_f32 v55, v94, v95
    s_nop 0
    v_permlane32_swap_b32 v52, v54
    v_permlane32_swap_b32 v53, v55
    global_store_dwordx4 v5, v[52:55], s[26:27] offset:32
    s_endpgm
.p2align 6
nw_4w:
    s_setpc_b64 s[96:97]
    s_nop 0
nw_4:
    s_and_b32 s46, s36, 3
    s_mov_b32 s45, 0
    v_mov_b32 v11, 148480
    s_waitcnt lgkmcnt(0)
    s_barrier
    ds_read_b32 v11, v11
    s_lshl_b32 s47, s37, 2
    s_load_dword s53, s[16:17], s47
    s_lshl_b32 s47, s46, 10
    s_add_u32 s47, s47, 74752
    v_xor_b32_e64 v9, 3, v1
    v_lshl_add_u32 v9, v9, 2, s47
    s_lshl_b32 s47, s46, 11
    v_lshrrev_b32 v5, 3, v1
    v_lshl_add_u32 v5, v5, 4, s47
    v_bfe_u32 v6, v1, 1, 2
    v_lshl_add_u32 v5, v6, 8, v5
    v_and_b32_e64 v6, 1, v1
    v_lshl_add_u32 v10, v6, 3, v5
    global_load_dwordx4 v[116:119], v97, s[30:31] offset:0 sc1
    global_load_dwordx4 v[120:123], v97, s[30:31] offset:1024 sc1
    buffer_load_dwordx4 v[100:103], v97, s[64:67], s44 offen offset:0 sc1
    buffer_load_dwordx4 v[104:107], v97, s[64:67], s44 offen offset:1024 sc1
    global_load_dwordx4 v[124:127], v97, s[30:31] offset:2048 sc1
    global_load_dwordx4 v[128:131], v97, s[30:31] offset:3072 sc1
    buffer_load_dwordx4 v[108:111], v97, s[64:67], s44 offen offset:2048 sc1
    buffer_load_dwordx4 v[112:115], v97, s[64:67], s44 offen offset:3072 sc1
    s_mov_b32 s45, 1
    s_barrier
    s_setprio 2
    s_waitcnt vmcnt(4)
xp_19:
    v_and_b32 v62, s43, v116
    v_and_b32 v66, s43, v118
    v_and_b32 v70, s43, v120
    v_and_b32 v74, s43, v122
    v_rcp_f32 v62, v62
    v_rcp_f32 v66, v66
    v_rcp_f32 v70, v70
    v_rcp_f32 v74, v74
    v_lshlrev_b32 v60, 16, v116
    v_lshlrev_b32 v64, 16, v118
    v_lshlrev_b32 v68, 16, v120
    v_lshlrev_b32 v72, 16, v122
    v_lshlrev_b32 v32, 16, v100
    v_lshlrev_b32 v34, 16, v102
    v_lshlrev_b32 v36, 16, v104
    v_lshlrev_b32 v38, 16, v106
    v_and_b32 v33, s43, v100
    v_and_b32 v35, s43, v102
    v_and_b32 v37, s43, v104
    v_and_b32 v39, s43, v106
    v_pk_add_f32 v[16:17], v[32:33], v[60:61] op_sel_hi:[1,0] neg_lo:[0,1] neg_hi:[0,1]
    v_pk_add_f32 v[18:19], v[34:35], v[64:65] op_sel_hi:[1,0] neg_lo:[0,1] neg_hi:[0,1]
    v_pk_add_f32 v[20:21], v[36:37], v[68:69] op_sel_hi:[1,0] neg_lo:[0,1] neg_hi:[0,1]
    v_pk_add_f32 v[22:23], v[38:39], v[72:73] op_sel_hi:[1,0] neg_lo:[0,1] neg_hi:[0,1]
    v_cvt_pk_bf16_f32 v17, v16, v17
    v_cvt_pk_bf16_f32 v19, v18, v19
    v_cvt_pk_bf16_f32 v21, v20, v21
    v_cvt_pk_bf16_f32 v23, v22, v23
    v_lshlrev_b32 v16, 16, v17
    v_lshlrev_b32 v18, 16, v19
    v_lshlrev_b32 v20, 16, v21
    v_lshlrev_b32 v22, 16, v23
    v_and_b32 v17, s43, v17
    v_and_b32 v19, s43, v19
    v_and_b32 v21, s43, v21
    v_and_b32 v23, s43, v23
    v_pk_mul_f32 v[16:17], v[16:17], v[62:63] op_sel_hi:[1,0]
    v_pk_mul_f32 v[18:19], v[18:19], v[66:67] op_sel_hi:[1,0]
    v_pk_mul_f32 v[20:21], v[20:21], v[70:71] op_sel_hi:[1,0]
    v_pk_mul_f32 v[22:23], v[22:23], v[74:75] op_sel_hi:[1,0]
    v_cvt_pk_bf16_f32 v48, v18, v16
    v_cvt_pk_bf16_f32 v49, v22, v20
    v_cvt_pk_bf16_f32 v52, v19, v17
    v_cvt_pk_bf16_f32 v53, v23, v21
    s_waitcnt vmcnt(0) lgkmcnt(0)
    s_nop 0
    v_min3_u32 v4, v101, v103, v11
    v_max3_u32 v5, v101, v103, v11
    v_min3_u32 v4, v4, v105, v107
    v_max3_u32 v5, v5, v105, v107
    v_min3_u32 v4, v4, v109, v111
    v_max3_u32 v5, v5, v109, v111
    v_min3_u32 v4, v4, v113, v115
    v_max3_u32 v5, v5, v113, v115
    v_min3_u32 v4, v4, v117, v119
    v_max3_u32 v5, v5, v117, v119
    v_min3_u32 v4, v4, v121, v123
    v_max3_u32 v5, v5, v121, v123
    v_min3_u32 v4, v4, v125, v127
    v_max3_u32 v5, v5, v125, v127
    v_min3_u32 v4, v4, v129, v131
    v_max3_u32 v5, v5, v129, v131
    v_cmp_ne_u32 vcc, v4, v5
    s_cbranch_vccnz xp_19c
xok_20:
    v_and_b32 v62, s43, v124
    v_and_b32 v66, s43, v126
    v_and_b32 v70, s43, v128
    v_and_b32 v74, s43, v130
    v_rcp_f32 v62, v62
    v_rcp_f32 v66, v66
    v_rcp_f32 v70, v70
    v_rcp_f32 v74, v74
    v_lshlrev_b32 v60, 16, v124
    v_lshlrev_b32 v64, 16, v126
    v_lshlrev_b32 v68, 16, v128
    v_lshlrev_b32 v72, 16, v130
    v_lshlrev_b32 v40, 16, v108
    v_lshlrev_b32 v42, 16, v110
    v_lshlrev_b32 v44, 16, v112
    v_lshlrev_b32 v46, 16, v114
    v_and_b32 v41, s43, v108
    v_and_b32 v43, s43, v110
    v_and_b32 v45, s43, v112
    v_and_b32 v47, s43, v114
    v_pk_add_f32 v[24:25], v[40:41], v[60:61] op_sel_hi:[1,0] neg_lo:[0,1] neg_hi:[0,1]
    v_pk_add_f32 v[26:27], v[42:43], v[64:65] op_sel_hi:[1,0] neg_lo:[0,1] neg_hi:[0,1]
    v_pk_add_f32 v[28:29], v[44:45], v[68:69] op_sel_hi:[1,0] neg_lo:[0,1] neg_hi:[0,1]
    v_pk_add_f32 v[30:31], v[46:47], v[72:73] op_sel_hi:[1,0] neg_lo:[0,1] neg_hi:[0,1]
    v_cvt_pk_bf16_f32 v25, v24, v25
    v_cvt_pk_bf16_f32 v27, v26, v27
    v_cvt_pk_bf16_f32 v29, v28, v29
    v_cvt_pk_bf16_f32 v31, v30, v31
    v_lshlrev_b32 v24, 16, v25
    v_lshlrev_b32 v26, 16, v27
    v_lshlrev_b32 v28, 16, v29
    v_lshlrev_b32 v30, 16, v31
    v_and_b32 v25, s43, v25
    v_and_b32 v27, s43, v27
    v_and_b32 v29, s43, v29
    v_and_b32 v31, s43, v31
    v_pk_mul_f32 v[24:25], v[24:25], v[62:63] op_sel_hi:[1,0]
    v_pk_mul_f32 v[26:27], v[26:27], v[66:67] op_sel_hi:[1,0]
    v_pk_mul_f32 v[28:29], v[28:29], v[70:71] op_sel_hi:[1,0]
    v_pk_mul_f32 v[30:31], v[30:31], v[74:75] op_sel_hi:[1,0]
    v_cvt_pk_bf16_f32 v50, v26, v24
    v_cvt_pk_bf16_f32 v51, v30, v28
    v_cvt_pk_bf16_f32 v54, v27, v25
    v_cvt_pk_bf16_f32 v55, v31, v29
    ds_write2st64_b32 v9, v48, v49 offset0:0 offset1:1
    ds_write2st64_b32 v9, v52, v53 offset0:18 offset1:19
    ds_write2st64_b32 v9, v50, v51 offset0:2 offset1:3
    ds_write2st64_b32 v9, v54, v55 offset0:20 offset1:21
    s_setprio 0
    s_waitcnt lgkmcnt(0)
    s_barrier
    s_and_b32 s59, s53, s43
    s_lshl_b32 s58, s53, 16
    v_lshlrev_b32 v4, 16, v48
    v_and_b32_e64 v5, s43, v48
    v_fma_f32 v61, v4, s58, v34
    v_fma_f32 v60, v5, s58, v32
    ds_write_b64 v10, v[60:61] offset:0
    v_lshlrev_b32 v4, 16, v49
    v_and_b32 v5, s43, v49
    v_fma_f32 v63, v4, s58, v38
    v_fma_f32 v62, v5, s58, v36
    ds_write_b64 v10, v[62:63] offset:128
    v_lshlrev_b32 v4, 16, v50
    v_and_b32 v5, s43, v50
    v_fma_f32 v65, v4, s58, v42
    v_fma_f32 v64, v5, s58, v40
    ds_write_b64 v10, v[64:65] offset:1024
    v_lshlrev_b32 v4, 16, v51
    v_and_b32 v5, s43, v51
    v_fma_f32 v67, v4, s58, v46
    v_fma_f32 v66, v5, s58, v44
    ds_write_b64 v10, v[66:67] offset:1152
    v_lshlrev_b32 v4, 16, v52
    v_and_b32 v5, s43, v52
    v_fma_f32 v69, v4, s59, v35
    v_fma_f32 v68, v5, s59, v33
    ds_write_b64 v10, v[68:69] offset:32768
    v_lshlrev_b32 v4, 16, v53
    v_and_b32 v5, s43, v53
    v_fma_f32 v71, v4, s59, v39
    v_fma_f32 v70, v5, s59, v37
    ds_write_b64 v10, v[70:71] offset:32896
    v_lshlrev_b32 v4, 16, v54
    v_and_b32 v5, s43, v54
    v_fma_f32 v73, v4, s59, v43
    v_fma_f32 v72, v5, s59, v41
    ds_write_b64 v10, v[72:73] offset:33792
    v_lshlrev_b32 v4, 16, v55
    v_and_b32 v5, s43, v55
    v_fma_f32 v75, v4, s59, v47
    v_fma_f32 v74, v5, s59, v45
    ds_write_b64 v10, v[74:75] offset:33920
    v_mov_b32 v90, v11
    s_and_b32 s37, s2, 7
    s_lshr_b32 s38, s2, 3
    s_and_b32 s40, s38, 3
    s_lshr_b32 s39, s37, 1
    s_lshl_b32 s39, s39, 2
    s_add_u32 s39, s39, s40
    s_and_b32 s34, s37, 1
    s_lshr_b32 s35, s38, 2
    s_mul_i32 s38, s34, 7
    s_add_u32 s38, s38, s35
    s_mul_i32 s33, s40, 3
    s_lshl_b32 s37, s35, 1
    s_add_u32 s33, s33, s37
    s_cmp_ge_u32 s33, 14
    s_cselect_b32 s37, 14, 0
    s_sub_u32 s33, s33, s37
    s_and_b32 s40, s36, 1
    s_bfe_u32 s41, s36, 0x10001
    s_lshr_b32 s49, s36, 2
    v_bfe_u32 v2, v1, 2, 2
    v_bfe_u32 v3, v1, 4, 1
    v_lshrrev_b32 v4, 5, v1
    v_and_b32_e64 v6, 3, v1
    v_lshl_add_u32 v5, v4, 3, v2
    v_lshlrev_b32_e64 v7, 8, v5
    v_lshl_add_u32 v7, v6, 3, v7
    v_lshl_add_u32 v7, v3, 5, v7
    s_lshl_b32 s42, s40, 1
    s_add_u32 s42, s42, s41
    v_xor_b32_e64 v8, s42, v2
    v_lshl_add_u32 v8, v8, 6, v7
    v_xor_b32_e64 v9, 64, v8
    v_add_u32 v17, 0x10000, v8
    v_add_u32 v46, 0x10000, v9
    s_lshl_b32 s42, s34, 1
    s_add_u32 s42, s42, s40
    v_xor_b32_e64 v18, s42, v2
    v_lshl_add_u32 v18, v18, 6, v7
    v_lshlrev_b32_e64 v7, 7, v5
    v_lshl_add_u32 v7, v6, 3, v7
    v_lshl_add_u32 v7, v3, 12, v7
    v_lshrrev_b32_e64 v5, 1, v2
    v_lshl_add_u32 v5, v3, 1, v5
    s_lshl_b32 s42, s41, 1
    v_xor_b32 v5, s42, v5
    v_lshl_add_u32 v7, v5, 5, v7
    v_add_u32 v10, 98304, v7
    v_xor_b32 v11, 32, v10
    s_lshl_b32 s42, s39, 2
    s_lshl_b32 s43, s40, 1
    s_add_u32 s42, s42, s43
    s_add_u32 s43, s42, s41
    s_xor_b32 s44, s43, 1
    s_lshl_b32 s45, s38, 3
    s_lshl_b32 s46, s41, 1
    s_add_u32 s45, s45, s46
    s_lshl_b32 s46, s49, 2
    s_add_u32 s45, s45, s46
    s_lshl_b32 s46, s45, 7
    s_add_u32 s45, s45, 2048
    s_mul_i32 s43, s43, 112
    s_mul_i32 s44, s44, 112
    s_add_u32 s43, s43, s45
    s_add_u32 s44, s44, s45
    s_lshl_b32 s43, s43, 10
    s_lshl_b32 s44, s44, 10
    v_lshl_add_u32 v12, v1, 4, s43
    v_lshl_add_u32 v13, v1, 4, s44
    v_and_b32_e64 v5, 15, v1
    v_mul_u32_u24 v7, 14336, v3
    v_lshl_add_u32 v5, v5, 3, v7
    s_add_u32 s46, s46, 32768
    v_add_u32 v16, s46, v5
    v_and_b32_e64 v5, 31, v1
    s_lshl_b32 s42, s40, 1
    s_add_u32 s42, s42, s41
    s_lshl_b32 s43, s42, 9
    s_add_u32 s43, s43, 155648
    v_lshl_add_u32 v14, v5, 4, s43
    v_xor_b32 v15, 512, v14
    s_lshl_b32 s43, s39, 11
    s_lshl_b32 s44, s41, 8
    s_add_u32 s43, s43, s44
    s_add_u32 s43, s43, 14680064
    s_lshl_b32 s44, s34, 10
    s_add_u32 s59, s43, s44
    s_lshl_b32 s44, s40, 10
    s_add_u32 s58, s43, s44
    s_lshl_b32 s44, s49, 9
    s_add_u32 s58, s58, s44
    v_mov_b32 v36, 0
    v_mov_b32 v37, 0
    s_branch Lpg3
.p2align 12
Lpw3:
    s_setpc_b64 s[96:97]
Lpg3:
    v_mov_b32 v40, 0
    v_mov_b32 v41, 0
    v_mov_b32 v44, 0
    v_mov_b32_e64 v45, 0
    v_cmp_eq_u32 s[52:53], 0, v4
    s_mov_b32 s47, 0x3f803f80
    s_mov_b32 s48, 0xffff0000
    s_mul_i32 s43, s39, 14336
    s_lshl_b32 s44, s42, 8
    s_add_u32 s43, s43, s44
    s_add_u32 s43, s43, 14712832
    v_lshl_add_u32 v22, v5, 3, s43
    v_mul_u32_u24 v7, 7168, v4
    v_add3_u32 v23, v22, v7, 64
    v_add_u32 v23, 3008, v23
    s_lshl_b32 s44, s38, 10
    v_add_u32 v22, s44, v22
    s_cmp_lg_u32 s36, 4
    s_cbranch_scc1 nb_22a
    v_min_u32 v47, 55, v1
    v_lshlrev_b32 v47, 5, v47
    v_add_u32 v47, 20480, v47
    s_mov_b32 s45, 0
    global_load_dwordx4 v[48:51], v47, s[30:31] sc1
    global_load_dwordx4 v[52:55], v47, s[30:31] offset:16 sc1
nb_22a:
    s_waitcnt lgkmcnt(0)
    s_barrier
    s_cmp_lg_u32 s36, 4
    s_cbranch_scc1 nb_22
pz_23:
    s_waitcnt vmcnt(0)
    v_min3_u32 v56, v48, v49, v90
    v_max3_u32 v57, v48, v49, v90
    v_min3_u32 v56, v50, v51, v56
    v_max3_u32 v57, v50, v51, v57
    v_min3_u32 v56, v52, v53, v56
    v_max3_u32 v57, v52, v53, v57
    v_min3_u32 v56, v54, v55, v56
    v_max3_u32 v57, v54, v55, v57
    v_cmp_ne_u32_e64 vcc, v56, v57
    s_cbranch_vccz pzo_24
    s_sleep 4
    global_load_dwordx4 v[48:51], v47, s[30:31] sc1
    global_load_dwordx4 v[52:55], v47, s[30:31] offset:16 sc1
    s_add_u32 s45, s45, 1
    s_cmp_lt_u32 s45, 262144
    s_cbranch_scc1 pz_23
pzo_24:
    s_cmp_lg_u32 s2, 0
    s_cbranch_scc1 nb_22
    v_mov_b32 v47, 16384
    s_mov_b64 exec, 1
    global_store_dword v47, v90, s[30:31]
    s_mov_b64 exec, -1
nb_22:
    s_barrier
    s_barrier
    ds_read_b64_tr_b16 v[48:49], v8 offset:0
    ds_read_b64_tr_b16 v[50:51], v8 offset:1024
    ds_read_b64_tr_b16 v[52:53], v8 offset:4096
    ds_read_b64_tr_b16 v[54:55], v8 offset:5120
    s_barrier
    s_waitcnt lgkmcnt(0)
    v_dot2_f32_bf16 v18, v48, s47, 0
    v_dot2_f32_bf16 v20, v48, v48, 0
    v_dot2_f32_bf16 v19, v49, s47, 0
    v_dot2_f32_bf16 v21, v49, v49, 0
    v_dot2_f32_bf16 v18, v50, s47, v18
    v_dot2_f32_bf16 v20, v50, v50, v20
    v_dot2_f32_bf16 v19, v51, s47, v19
    v_dot2_f32_bf16 v21, v51, v51, v21
    v_dot2_f32_bf16 v18, v52, s47, v18
    v_dot2_f32_bf16 v20, v52, v52, v20
    v_dot2_f32_bf16 v19, v53, s47, v19
    v_dot2_f32_bf16 v21, v53, v53, v21
    v_dot2_f32_bf16 v18, v54, s47, v18
    v_dot2_f32_bf16 v20, v54, v54, v20
    v_dot2_f32_bf16 v19, v55, s47, v19
    v_dot2_f32_bf16 v21, v55, v55, v21
    s_barrier
    s_nop 0
    v_add_f32 v18, v18, v19
    v_add_f32 v19, v20, v21
    v_mov_b32 v20, v18
    v_mov_b32 v21, v19
    s_nop 0
    v_permlane32_swap_b32 v18, v20
    v_permlane32_swap_b32 v19, v21
    v_add_f32 v18, v18, v20
    v_add_f32 v19, v19, v21
    v_or_b32_e64 v19, 1, v19
    s_mov_b32 exec_hi, 0
    global_store_dwordx2 v22, v[18:19], s[30:31] sc0 sc1
    s_mov_b32 exec_hi, -1
    s_barrier
    s_barrier
    s_barrier
    s_barrier
    s_barrier
    s_cmp_lg_u32 s36, 4
    s_cbranch_scc1 css_25
    global_load_dword v47, v40, s[28:29] sc1
css_25:
    global_load_dwordx2 v[96:97], v23, s[30:31] offset:-3072 sc1
    global_load_dwordx2 v[98:99], v23, s[30:31] offset:-2048 sc1
    global_load_dwordx2 v[100:101], v23, s[30:31] offset:-1024 sc1
    s_barrier
    global_load_dwordx2 v[102:103], v23, s[30:31] offset:0 sc1
    global_load_dwordx2 v[104:105], v23, s[30:31] offset:1024 sc1
    global_load_dwordx2 v[106:107], v23, s[30:31] offset:2048 sc1
    global_load_dwordx2 v[108:109], v23, s[30:31] offset:3072 sc1
    s_barrier
    s_barrier
    s_cmp_lg_u32 s36, 4
    s_cbranch_scc1 css_26
    s_mov_b32 s45, 0
cs_27:
    s_waitcnt vmcnt(0)
    v_cmp_gt_u32 vcc, 32, v47
    s_cbranch_vccz css_26
    s_sleep 16
    global_load_dword v47, v40, s[28:29] sc1
    s_add_u32 s45, s45, 1
    s_cmp_lt_u32 s45, 262144
    s_cbranch_scc1 cs_27
css_26:
    s_mov_b32 s45, 0
gp_28:
    s_waitcnt vmcnt(0)
    v_min3_u32 v7, v97, v99, v101
    v_min3_u32 v7, v7, v103, v105
    v_min3_u32 v7, v7, v107, v109
    v_cmp_eq_u32 vcc, 0, v7
    s_cbranch_vccnz gp_28c
gok_29:
    s_barrier
    v_add_f32 v96, v96, v98
    v_add_f32 v97, v97, v99
    v_add_f32 v96, v96, v100
    v_add_f32 v97, v97, v101
    v_add_f32 v96, v96, v102
    v_add_f32 v97, v97, v103
    v_add_f32 v96, v96, v104
    v_add_f32 v97, v97, v105
    v_add_f32 v96, v96, v106
    v_add_f32 v97, v97, v107
    v_add_f32 v96, v96, v108
    v_add_f32 v97, v97, v109
    v_mov_b32 v98, v96
    v_mov_b32 v99, v97
    s_nop 0
    v_permlane32_swap_b32 v96, v98
    v_permlane32_swap_b32 v97, v99
    v_add_f32 v96, v96, v98
    v_add_f32 v97, v97, v99
    v_mul_f32 v96, 0x3b124925, v96
    s_barrier
    v_mul_f32 v97, 0x3b124925, v97
    v_fma_f32 v97, -v96, v96, v97
    v_max_f32 v97, 0, v97
    v_cvt_pk_bf16_f32 v27, -v96, -v96
    v_cvt_pk_bf16_f32 v97, v97, v97
    v_and_b32_e64 v97, s48, v97
    v_add_f32 v97, 0x3727c5ac, v97
    v_cvt_pk_bf16_f32 v97, v97, v97
    v_and_b32 v97, s48, v97
    v_sqrt_f32_e64 v97, v97
    s_nop 0
    v_cvt_pk_bf16_f32 v97, v97, v97
    v_and_b32 v97, s48, v97
    v_rcp_f32 v96, v97
    v_mul_f32_e64 v26, v97, v97
    v_mul_f32 v24, 0xc0135761, v96
    v_mul_f32 v25, v96, v96
    v_mul_f32 v25, v25, v96
    v_mul_f32 v25, 0xbdd2d3e8, v25
    ds_write_b128 v14, v[24:27]
    s_barrier
    s_waitcnt vmcnt(0) lgkmcnt(0)
    s_barrier
    s_nop 0
    ds_read_b128 v[28:31], v15
    ds_read_b64_tr_b16 v[56:57], v8 offset:0
    ds_read_b64_tr_b16 v[58:59], v8 offset:1024
    ds_read_b64_tr_b16 v[48:49], v10 offset:40960
    ds_read_b64_tr_b16 v[50:51], v10 offset:41472
    ds_read_b64_tr_b16 v[60:61], v9 offset:0
    ds_read_b64_tr_b16 v[62:63], v9 offset:1024
    ds_read_b64_tr_b16 v[52:53], v11 offset:40960
    ds_read_b64_tr_b16 v[54:55], v11 offset:41472
    s_waitcnt lgkmcnt(8)
    s_nop 0
    v_cndmask_b32 v38, 0, v27, s[52:53]
    v_cndmask_b32 v39, 0, v27, s[52:53]
    v_cndmask_b32 v42, 0, v31, s[52:53]
    v_cndmask_b32 v43, 0, v31, s[52:53]
    ds_read_b64_tr_b16 v[72:73], v8 offset:4096
    ds_read_b64_tr_b16 v[74:75], v8 offset:5120
    ds_read_b64_tr_b16 v[64:65], v10 offset:43008
    ds_read_b64_tr_b16 v[66:67], v10 offset:43520
    ds_read_b64_tr_b16 v[76:77], v9 offset:4096
    ds_read_b64_tr_b16 v[78:79], v9 offset:5120
    ds_read_b64_tr_b16 v[68:69], v11 offset:43008
    ds_read_b64_tr_b16 v[70:71], v11 offset:43520
    s_setprio 2
    s_barrier
    s_waitcnt lgkmcnt(8)
    s_nop 0
    v_mfma_f32_32x32x16_bf16 v[96:111], v[48:51], v[56:59], 0
    ds_read_b64_tr_b16 v[88:89], v8 offset:8192
    ds_read_b64_tr_b16 v[90:91], v8 offset:9216
    v_mfma_f32_32x32x16_bf16 v[112:127], v[48:51], v[60:63], 0
    ds_read_b64_tr_b16 v[80:81], v10 offset:49152
    ds_read_b64_tr_b16 v[82:83], v10 offset:49664
    v_mfma_f32_32x32x16_bf16 v[128:143], v[52:55], v[56:59], 0
    ds_read_b64_tr_b16 v[92:93], v9 offset:8192
    ds_read_b64_tr_b16 v[94:95], v9 offset:9216
    v_mfma_f32_32x32x16_bf16 v[144:159], v[52:55], v[60:63], 0
    ds_read_b64_tr_b16 v[84:85], v11 offset:49152
    ds_read_b64_tr_b16 v[86:87], v11 offset:49664
    s_waitcnt lgkmcnt(8)
    s_nop 0
    v_mfma_f32_32x32x16_bf16 v[96:111], v[64:67], v[72:75], v[96:111]
    ds_read_b64_tr_b16 v[56:57], v8 offset:12288
    ds_read_b64_tr_b16 v[58:59], v8 offset:13312
    v_mfma_f32_32x32x16_bf16 v[112:127], v[64:67], v[76:79], v[112:127]
    ds_read_b64_tr_b16 v[48:49], v10 offset:51200
    ds_read_b64_tr_b16 v[50:51], v10 offset:51712
    v_mfma_f32_32x32x16_bf16 v[128:143], v[68:71], v[72:75], v[128:143]
    ds_read_b64_tr_b16 v[60:61], v9 offset:12288
    ds_read_b64_tr_b16 v[62:63], v9 offset:13312
    v_mfma_f32_32x32x16_bf16 v[144:159], v[68:71], v[76:79], v[144:159]
    ds_read_b64_tr_b16 v[52:53], v11 offset:51200
    ds_read_b64_tr_b16 v[54:55], v11 offset:51712
    s_barrier
    s_waitcnt lgkmcnt(8)
    v_mfma_f32_32x32x16_bf16 v[96:111], v[80:83], v[88:91], v[96:111]
    ds_read_b64_tr_b16 v[72:73], v8 offset:16384
    ds_read_b64_tr_b16 v[74:75], v8 offset:17408
    v_mfma_f32_32x32x16_bf16 v[112:127], v[80:83], v[92:95], v[112:127]
    ds_read_b64_tr_b16 v[64:65], v10 offset:16384
    ds_read_b64_tr_b16 v[66:67], v10 offset:16896
    v_mfma_f32_32x32x16_bf16 v[128:143], v[84:87], v[88:91], v[128:143]
    ds_read_b64_tr_b16 v[76:77], v9 offset:16384
    ds_read_b64_tr_b16 v[78:79], v9 offset:17408
    v_mfma_f32_32x32x16_bf16 v[144:159], v[84:87], v[92:95], v[144:159]
    ds_read_b64_tr_b16 v[68:69], v11 offset:16384
    ds_read_b64_tr_b16 v[70:71], v11 offset:16896
    s_waitcnt lgkmcnt(8)
    s_nop 0
    v_mfma_f32_32x32x16_bf16 v[96:111], v[48:51], v[56:59], v[96:111]
    ds_read_b64_tr_b16 v[88:89], v8 offset:20480
    ds_read_b64_tr_b16 v[90:91], v8 offset:21504
    v_mfma_f32_32x32x16_bf16 v[112:127], v[48:51], v[60:63], v[112:127]
    ds_read_b64_tr_b16 v[80:81], v10 offset:18432
    ds_read_b64_tr_b16 v[82:83], v10 offset:18944
    v_mfma_f32_32x32x16_bf16 v[128:143], v[52:55], v[56:59], v[128:143]
    ds_read_b64_tr_b16 v[92:93], v9 offset:20480
    ds_read_b64_tr_b16 v[94:95], v9 offset:21504
    v_mfma_f32_32x32x16_bf16 v[144:159], v[52:55], v[60:63], v[144:159]
    ds_read_b64_tr_b16 v[84:85], v11 offset:18432
    ds_read_b64_tr_b16 v[86:87], v11 offset:18944
    s_barrier
    s_waitcnt lgkmcnt(8)
    v_mfma_f32_32x32x16_bf16 v[96:111], v[64:67], v[72:75], v[96:111]
    ds_read_b64_tr_b16 v[56:57], v8 offset:24576
    ds_read_b64_tr_b16 v[58:59], v8 offset:25600
    v_mfma_f32_32x32x16_bf16 v[112:127], v[64:67], v[76:79], v[112:127]
    ds_read_b64_tr_b16 v[48:49], v10 offset:24576
    ds_read_b64_tr_b16 v[50:51], v10 offset:25088
    v_mfma_f32_32x32x16_bf16 v[128:143], v[68:71], v[72:75], v[128:143]
    ds_read_b64_tr_b16 v[60:61], v9 offset:24576
    ds_read_b64_tr_b16 v[62:63], v9 offset:25600
    v_mfma_f32_32x32x16_bf16 v[144:159], v[68:71], v[76:79], v[144:159]
    ds_read_b64_tr_b16 v[52:53], v11 offset:24576
    ds_read_b64_tr_b16 v[54:55], v11 offset:25088
    s_waitcnt lgkmcnt(8)
    s_nop 0
    v_mfma_f32_32x32x16_bf16 v[96:111], v[80:83], v[88:91], v[96:111]
    ds_read_b64_tr_b16 v[72:73], v8 offset:28672
    ds_read_b64_tr_b16 v[74:75], v8 offset:29696
    v_mfma_f32_32x32x16_bf16 v[112:127], v[80:83], v[92:95], v[112:127]
    ds_read_b64_tr_b16 v[64:65], v10 offset:26624
    ds_read_b64_tr_b16 v[66:67], v10 offset:27136
    v_mfma_f32_32x32x16_bf16 v[128:143], v[84:87], v[88:91], v[128:143]
    ds_read_b64_tr_b16 v[76:77], v9 offset:28672
    ds_read_b64_tr_b16 v[78:79], v9 offset:29696
    v_mfma_f32_32x32x16_bf16 v[144:159], v[84:87], v[92:95], v[144:159]
    ds_read_b64_tr_b16 v[68:69], v11 offset:26624
    ds_read_b64_tr_b16 v[70:71], v11 offset:27136
    s_barrier
    s_waitcnt lgkmcnt(8)
    v_mfma_f32_32x32x16_bf16 v[96:111], v[48:51], v[56:59], v[96:111]
    ds_read_b64_tr_b16 v[88:89], v8 offset:32768
    ds_read_b64_tr_b16 v[90:91], v8 offset:33792
    v_mfma_f32_32x32x16_bf16 v[112:127], v[48:51], v[60:63], v[112:127]
    ds_read_b64_tr_b16 v[80:81], v10 offset:32768
    ds_read_b64_tr_b16 v[82:83], v10 offset:33280
    v_mfma_f32_32x32x16_bf16 v[128:143], v[52:55], v[56:59], v[128:143]
    ds_read_b64_tr_b16 v[92:93], v9 offset:32768
    ds_read_b64_tr_b16 v[94:95], v9 offset:33792
    v_mfma_f32_32x32x16_bf16 v[144:159], v[52:55], v[60:63], v[144:159]
    ds_read_b64_tr_b16 v[84:85], v11 offset:32768
    ds_read_b64_tr_b16 v[86:87], v11 offset:33280
    s_waitcnt lgkmcnt(8)
    s_nop 0
    v_mfma_f32_32x32x16_bf16 v[96:111], v[64:67], v[72:75], v[96:111]
    ds_read_b64_tr_b16 v[56:57], v8 offset:36864
    ds_read_b64_tr_b16 v[58:59], v8 offset:37888
    v_mfma_f32_32x32x16_bf16 v[112:127], v[64:67], v[76:79], v[112:127]
    ds_read_b64_tr_b16 v[48:49], v10 offset:34816
    ds_read_b64_tr_b16 v[50:51], v10 offset:35328
    v_mfma_f32_32x32x16_bf16 v[128:143], v[68:71], v[72:75], v[128:143]
    ds_read_b64_tr_b16 v[60:61], v9 offset:36864
    ds_read_b64_tr_b16 v[62:63], v9 offset:37888
    v_mfma_f32_32x32x16_bf16 v[144:159], v[68:71], v[76:79], v[144:159]
    ds_read_b64_tr_b16 v[52:53], v11 offset:34816
    ds_read_b64_tr_b16 v[54:55], v11 offset:35328
    s_barrier
    s_waitcnt lgkmcnt(8)
    v_mfma_f32_32x32x16_bf16 v[96:111], v[80:83], v[88:91], v[96:111]
    ds_read_b64_tr_b16 v[72:73], v8 offset:40960
    ds_read_b64_tr_b16 v[74:75], v8 offset:41984
    v_mfma_f32_32x32x16_bf16 v[112:127], v[80:83], v[92:95], v[112:127]
    ds_read_b64_tr_b16 v[64:65], v10 offset:57344
    ds_read_b64_tr_b16 v[66:67], v10 offset:57856
    v_mfma_f32_32x32x16_bf16 v[128:143], v[84:87], v[88:91], v[128:143]
    ds_read_b64_tr_b16 v[76:77], v9 offset:40960
    ds_read_b64_tr_b16 v[78:79], v9 offset:41984
    v_mfma_f32_32x32x16_bf16 v[144:159], v[84:87], v[92:95], v[144:159]
    ds_read_b64_tr_b16 v[68:69], v11 offset:57344
    ds_read_b64_tr_b16 v[70:71], v11 offset:57856
    s_waitcnt lgkmcnt(8)
    s_nop 0
    v_mfma_f32_32x32x16_bf16 v[96:111], v[48:51], v[56:59], v[96:111]
    ds_read_b64_tr_b16 v[88:89], v8 offset:45056
    ds_read_b64_tr_b16 v[90:91], v8 offset:46080
    v_mfma_f32_32x32x16_bf16 v[112:127], v[48:51], v[60:63], v[112:127]
    ds_read_b64_tr_b16 v[80:81], v10 offset:59392
    ds_read_b64_tr_b16 v[82:83], v10 offset:59904
    v_mfma_f32_32x32x16_bf16 v[128:143], v[52:55], v[56:59], v[128:143]
    ds_read_b64_tr_b16 v[92:93], v9 offset:45056
    ds_read_b64_tr_b16 v[94:95], v9 offset:46080
    v_mfma_f32_32x32x16_bf16 v[144:159], v[52:55], v[60:63], v[144:159]
    ds_read_b64_tr_b16 v[84:85], v11 offset:59392
    ds_read_b64_tr_b16 v[86:87], v11 offset:59904
    s_barrier
    s_waitcnt lgkmcnt(8)
    v_mfma_f32_32x32x16_bf16 v[96:111], v[64:67], v[72:75], v[96:111]
    ds_read_b64_tr_b16 v[56:57], v8 offset:49152
    ds_read_b64_tr_b16 v[58:59], v8 offset:50176
    v_mfma_f32_32x32x16_bf16 v[112:127], v[64:67], v[76:79], v[112:127]
    ds_read_b64_tr_b16 v[48:49], v10 offset:40960
    ds_read_b64_tr_b16 v[50:51], v10 offset:41472
    v_mfma_f32_32x32x16_bf16 v[128:143], v[68:71], v[72:75], v[128:143]
    ds_read_b64_tr_b16 v[60:61], v9 offset:49152
    ds_read_b64_tr_b16 v[62:63], v9 offset:50176
    v_mfma_f32_32x32x16_bf16 v[144:159], v[68:71], v[76:79], v[144:159]
    ds_read_b64_tr_b16 v[52:53], v11 offset:40960
    ds_read_b64_tr_b16 v[54:55], v11 offset:41472
    s_waitcnt lgkmcnt(8)
    s_nop 0
    v_mfma_f32_32x32x16_bf16 v[96:111], v[80:83], v[88:91], v[96:111]
    ds_read_b64_tr_b16 v[72:73], v8 offset:53248
    ds_read_b64_tr_b16 v[74:75], v8 offset:54272
    v_mfma_f32_32x32x16_bf16 v[112:127], v[80:83], v[92:95], v[112:127]
    ds_read_b64_tr_b16 v[64:65], v10 offset:43008
    ds_read_b64_tr_b16 v[66:67], v10 offset:43520
    v_mfma_f32_32x32x16_bf16 v[128:143], v[84:87], v[88:91], v[128:143]
    ds_read_b64_tr_b16 v[76:77], v9 offset:53248
    ds_read_b64_tr_b16 v[78:79], v9 offset:54272
    v_mfma_f32_32x32x16_bf16 v[144:159], v[84:87], v[92:95], v[144:159]
    ds_read_b64_tr_b16 v[68:69], v11 offset:43008
    ds_read_b64_tr_b16 v[70:71], v11 offset:43520
    s_barrier
    s_waitcnt lgkmcnt(8)
    v_mfma_f32_32x32x16_bf16 v[96:111], v[48:51], v[56:59], v[96:111]
    ds_read_b64_tr_b16 v[88:89], v8 offset:57344
    ds_read_b64_tr_b16 v[90:91], v8 offset:58368
    v_mfma_f32_32x32x16_bf16 v[112:127], v[48:51], v[60:63], v[112:127]
    ds_read_b64_tr_b16 v[80:81], v10 offset:49152
    ds_read_b64_tr_b16 v[82:83], v10 offset:49664
    v_mfma_f32_32x32x16_bf16 v[128:143], v[52:55], v[56:59], v[128:143]
    ds_read_b64_tr_b16 v[92:93], v9 offset:57344
    ds_read_b64_tr_b16 v[94:95], v9 offset:58368
    v_mfma_f32_32x32x16_bf16 v[144:159], v[52:55], v[60:63], v[144:159]
    ds_read_b64_tr_b16 v[84:85], v11 offset:49152
    ds_read_b64_tr_b16 v[86:87], v11 offset:49664
    s_waitcnt lgkmcnt(8)
    s_nop 0
    v_mfma_f32_32x32x16_bf16 v[96:111], v[64:67], v[72:75], v[96:111]
    ds_read_b64_tr_b16 v[56:57], v8 offset:61440
    ds_read_b64_tr_b16 v[58:59], v8 offset:62464
    v_mfma_f32_32x32x16_bf16 v[112:127], v[64:67], v[76:79], v[112:127]
    ds_read_b64_tr_b16 v[48:49], v10 offset:51200
    ds_read_b64_tr_b16 v[50:51], v10 offset:51712
    v_mfma_f32_32x32x16_bf16 v[128:143], v[68:71], v[72:75], v[128:143]
    ds_read_b64_tr_b16 v[60:61], v9 offset:61440
    ds_read_b64_tr_b16 v[62:63], v9 offset:62464
    v_mfma_f32_32x32x16_bf16 v[144:159], v[68:71], v[76:79], v[144:159]
    ds_read_b64_tr_b16 v[52:53], v11 offset:51200
    ds_read_b64_tr_b16 v[54:55], v11 offset:51712
    global_load_dwordx2 v[32:33], v16, s[30:31] sc1
    s_barrier
    s_waitcnt lgkmcnt(8)
    v_mfma_f32_32x32x16_bf16 v[96:111], v[80:83], v[88:91], v[96:111]
    ds_read_b64_tr_b16 v[72:73], v17 offset:0
    ds_read_b64_tr_b16 v[74:75], v17 offset:1024
    v_mfma_f32_32x32x16_bf16 v[112:127], v[80:83], v[92:95], v[112:127]
    ds_read_b64_tr_b16 v[64:65], v10 offset:16384
    ds_read_b64_tr_b16 v[66:67], v10 offset:16896
    v_mfma_f32_32x32x16_bf16 v[128:143], v[84:87], v[88:91], v[128:143]
    ds_read_b64_tr_b16 v[76:77], v46 offset:0
    ds_read_b64_tr_b16 v[78:79], v46 offset:1024
    v_mfma_f32_32x32x16_bf16 v[144:159], v[84:87], v[92:95], v[144:159]
    ds_read_b64_tr_b16 v[68:69], v11 offset:16384
    ds_read_b64_tr_b16 v[70:71], v11 offset:16896
    s_waitcnt lgkmcnt(8)
    s_nop 0
    v_mfma_f32_32x32x16_bf16 v[96:111], v[48:51], v[56:59], v[96:111]
    ds_read_b64_tr_b16 v[88:89], v17 offset:4096
    ds_read_b64_tr_b16 v[90:91], v17 offset:5120
    v_mfma_f32_32x32x16_bf16 v[112:127], v[48:51], v[60:63], v[112:127]
    ds_read_b64_tr_b16 v[80:81], v10 offset:18432
    ds_read_b64_tr_b16 v[82:83], v10 offset:18944
    v_mfma_f32_32x32x16_bf16 v[128:143], v[52:55], v[56:59], v[128:143]
    ds_read_b64_tr_b16 v[92:93], v46 offset:4096
    ds_read_b64_tr_b16 v[94:95], v46 offset:5120
    v_mfma_f32_32x32x16_bf16 v[144:159], v[52:55], v[60:63], v[144:159]
    ds_read_b64_tr_b16 v[84:85], v11 offset:18432
    ds_read_b64_tr_b16 v[86:87], v11 offset:18944
    global_load_dwordx2 v[34:35], v16, s[30:31] offset:128 sc1
    s_barrier
    s_waitcnt lgkmcnt(8)
    v_mfma_f32_32x32x16_bf16 v[96:111], v[64:67], v[72:75], v[96:111]
    ds_read_b64_tr_b16 v[56:57], v17 offset:8192
    ds_read_b64_tr_b16 v[58:59], v17 offset:9216
    v_mfma_f32_32x32x16_bf16 v[112:127], v[64:67], v[76:79], v[112:127]
    ds_read_b64_tr_b16 v[48:49], v10 offset:24576
    ds_read_b64_tr_b16 v[50:51], v10 offset:25088
    v_mfma_f32_32x32x16_bf16 v[128:143], v[68:71], v[72:75], v[128:143]
    ds_read_b64_tr_b16 v[60:61], v46 offset:8192
    ds_read_b64_tr_b16 v[62:63], v46 offset:9216
    v_mfma_f32_32x32x16_bf16 v[144:159], v[68:71], v[76:79], v[144:159]
    ds_read_b64_tr_b16 v[52:53], v11 offset:24576
    ds_read_b64_tr_b16 v[54:55], v11 offset:25088
    s_waitcnt lgkmcnt(8)
    s_nop 0
    v_mfma_f32_32x32x16_bf16 v[96:111], v[80:83], v[88:91], v[96:111]
    ds_read_b64_tr_b16 v[72:73], v17 offset:12288
    ds_read_b64_tr_b16 v[74:75], v17 offset:13312
    v_mfma_f32_32x32x16_bf16 v[112:127], v[80:83], v[92:95], v[112:127]
    ds_read_b64_tr_b16 v[64:65], v10 offset:26624
    ds_read_b64_tr_b16 v[66:67], v10 offset:27136
    v_mfma_f32_32x32x16_bf16 v[128:143], v[84:87], v[88:91], v[128:143]
    ds_read_b64_tr_b16 v[76:77], v46 offset:12288
    ds_read_b64_tr_b16 v[78:79], v46 offset:13312
    v_mfma_f32_32x32x16_bf16 v[144:159], v[84:87], v[92:95], v[144:159]
    ds_read_b64_tr_b16 v[68:69], v11 offset:26624
    ds_read_b64_tr_b16 v[70:71], v11 offset:27136
    s_barrier
    s_waitcnt lgkmcnt(8)
    v_mfma_f32_32x32x16_bf16 v[96:111], v[48:51], v[56:59], v[96:111]
    ds_read_b64_tr_b16 v[88:89], v17 offset:16384
    ds_read_b64_tr_b16 v[90:91], v17 offset:17408
    v_mfma_f32_32x32x16_bf16 v[112:127], v[48:51], v[60:63], v[112:127]
    ds_read_b64_tr_b16 v[80:81], v10 offset:32768
    ds_read_b64_tr_b16 v[82:83], v10 offset:33280
    v_mfma_f32_32x32x16_bf16 v[128:143], v[52:55], v[56:59], v[128:143]
    ds_read_b64_tr_b16 v[92:93], v46 offset:16384
    ds_read_b64_tr_b16 v[94:95], v46 offset:17408
    v_mfma_f32_32x32x16_bf16 v[144:159], v[52:55], v[60:63], v[144:159]
    ds_read_b64_tr_b16 v[84:85], v11 offset:32768
    ds_read_b64_tr_b16 v[86:87], v11 offset:33280
    s_waitcnt lgkmcnt(8)
    s_nop 0
    v_mfma_f32_32x32x16_bf16 v[96:111], v[64:67], v[72:75], v[96:111]
    ds_read_b64_tr_b16 v[56:57], v17 offset:20480
    ds_read_b64_tr_b16 v[58:59], v17 offset:21504
    v_mfma_f32_32x32x16_bf16 v[112:127], v[64:67], v[76:79], v[112:127]
    ds_read_b64_tr_b16 v[48:49], v10 offset:34816
    ds_read_b64_tr_b16 v[50:51], v10 offset:35328
    v_mfma_f32_32x32x16_bf16 v[128:143], v[68:71], v[72:75], v[128:143]
    ds_read_b64_tr_b16 v[60:61], v46 offset:20480
    ds_read_b64_tr_b16 v[62:63], v46 offset:21504
    v_mfma_f32_32x32x16_bf16 v[144:159], v[68:71], v[76:79], v[144:159]
    ds_read_b64_tr_b16 v[52:53], v11 offset:34816
    ds_read_b64_tr_b16 v[54:55], v11 offset:35328
    s_barrier
    s_waitcnt lgkmcnt(8)
    v_mfma_f32_32x32x16_bf16 v[96:111], v[80:83], v[88:91], v[96:111]
    ds_read_b64_tr_b16 v[72:73], v17 offset:24576
    ds_read_b64_tr_b16 v[74:75], v17 offset:25600
    v_mfma_f32_32x32x16_bf16 v[112:127], v[80:83], v[92:95], v[112:127]
    ds_read_b64_tr_b16 v[64:65], v10 offset:57344
    ds_read_b64_tr_b16 v[66:67], v10 offset:57856
    v_mfma_f32_32x32x16_bf16 v[128:143], v[84:87], v[88:91], v[128:143]
    ds_read_b64_tr_b16 v[76:77], v46 offset:24576
    ds_read_b64_tr_b16 v[78:79], v46 offset:25600
    v_mfma_f32_32x32x16_bf16 v[144:159], v[84:87], v[92:95], v[144:159]
    ds_read_b64_tr_b16 v[68:69], v11 offset:57344
    ds_read_b64_tr_b16 v[70:71], v11 offset:57856
    s_waitcnt lgkmcnt(8)
    s_nop 0
    v_mfma_f32_32x32x16_bf16 v[96:111], v[48:51], v[56:59], v[96:111]
    ds_read_b64_tr_b16 v[88:89], v17 offset:28672
    ds_read_b64_tr_b16 v[90:91], v17 offset:29696
    v_mfma_f32_32x32x16_bf16 v[112:127], v[48:51], v[60:63], v[112:127]
    ds_read_b64_tr_b16 v[80:81], v10 offset:59392
    ds_read_b64_tr_b16 v[82:83], v10 offset:59904
    v_mfma_f32_32x32x16_bf16 v[128:143], v[52:55], v[56:59], v[128:143]
    ds_read_b64_tr_b16 v[92:93], v46 offset:28672
    ds_read_b64_tr_b16 v[94:95], v46 offset:29696
    v_mfma_f32_32x32x16_bf16 v[144:159], v[52:55], v[60:63], v[144:159]
    ds_read_b64_tr_b16 v[84:85], v11 offset:59392
    ds_read_b64_tr_b16 v[86:87], v11 offset:59904
    s_barrier
    s_waitcnt lgkmcnt(8)
    v_mfma_f32_32x32x16_bf16 v[96:111], v[64:67], v[72:75], v[96:111]
    ds_read_b64_tr_b16 v[56:57], v17 offset:32768
    ds_read_b64_tr_b16 v[58:59], v17 offset:33792
    v_mfma_f32_32x32x16_bf16 v[112:127], v[64:67], v[76:79], v[112:127]
    ds_read_b64_tr_b16 v[48:49], v10 offset:40960
    ds_read_b64_tr_b16 v[50:51], v10 offset:41472
    v_mfma_f32_32x32x16_bf16 v[128:143], v[68:71], v[72:75], v[128:143]
    ds_read_b64_tr_b16 v[60:61], v46 offset:32768
    ds_read_b64_tr_b16 v[62:63], v46 offset:33792
    v_mfma_f32_32x32x16_bf16 v[144:159], v[68:71], v[76:79], v[144:159]
    ds_read_b64_tr_b16 v[52:53], v11 offset:40960
    ds_read_b64_tr_b16 v[54:55], v11 offset:41472
    s_waitcnt lgkmcnt(8)
    s_nop 0
    v_mfma_f32_32x32x16_bf16 v[96:111], v[80:83], v[88:91], v[96:111]
    ds_read_b64_tr_b16 v[72:73], v17 offset:36864
    ds_read_b64_tr_b16 v[74:75], v17 offset:37888
    v_mfma_f32_32x32x16_bf16 v[112:127], v[80:83], v[92:95], v[112:127]
    ds_read_b64_tr_b16 v[64:65], v10 offset:43008
    ds_read_b64_tr_b16 v[66:67], v10 offset:43520
    v_mfma_f32_32x32x16_bf16 v[128:143], v[84:87], v[88:91], v[128:143]
    ds_read_b64_tr_b16 v[76:77], v46 offset:36864
    ds_read_b64_tr_b16 v[78:79], v46 offset:37888
    v_mfma_f32_32x32x16_bf16 v[144:159], v[84:87], v[92:95], v[144:159]
    ds_read_b64_tr_b16 v[68:69], v11 offset:43008
    ds_read_b64_tr_b16 v[70:71], v11 offset:43520
    s_barrier
    s_waitcnt lgkmcnt(8)
    v_mfma_f32_32x32x16_bf16 v[96:111], v[48:51], v[56:59], v[96:111]
    ds_read_b64_tr_b16 v[88:89], v17 offset:40960
    ds_read_b64_tr_b16 v[90:91], v17 offset:41984
    v_mfma_f32_32x32x16_bf16 v[112:127], v[48:51], v[60:63], v[112:127]
    ds_read_b64_tr_b16 v[80:81], v10 offset:49152
    ds_read_b64_tr_b16 v[82:83], v10 offset:49664
    v_mfma_f32_32x32x16_bf16 v[128:143], v[52:55], v[56:59], v[128:143]
    ds_read_b64_tr_b16 v[92:93], v46 offset:40960
    ds_read_b64_tr_b16 v[94:95], v46 offset:41984
    v_mfma_f32_32x32x16_bf16 v[144:159], v[52:55], v[60:63], v[144:159]
    ds_read_b64_tr_b16 v[84:85], v11 offset:49152
    ds_read_b64_tr_b16 v[86:87], v11 offset:49664
    s_waitcnt lgkmcnt(8)
    s_nop 0
    v_mfma_f32_32x32x16_bf16 v[96:111], v[64:67], v[72:75], v[96:111]
    ds_read_b64_tr_b16 v[56:57], v17 offset:45056
    ds_read_b64_tr_b16 v[58:59], v17 offset:46080
    v_mfma_f32_32x32x16_bf16 v[112:127], v[64:67], v[76:79], v[112:127]
    ds_read_b64_tr_b16 v[48:49], v10 offset:51200
    ds_read_b64_tr_b16 v[50:51], v10 offset:51712
    v_mfma_f32_32x32x16_bf16 v[128:143], v[68:71], v[72:75], v[128:143]
    ds_read_b64_tr_b16 v[60:61], v46 offset:45056
    ds_read_b64_tr_b16 v[62:63], v46 offset:46080
    v_mfma_f32_32x32x16_bf16 v[144:159], v[68:71], v[76:79], v[144:159]
    ds_read_b64_tr_b16 v[52:53], v11 offset:51200
    ds_read_b64_tr_b16 v[54:55], v11 offset:51712
    s_waitcnt vmcnt(0)
    v_mfma_f32_32x32x16_bf16 v[96:111], v[32:35], v[38:41], v[96:111]
    v_mfma_f32_32x32x16_bf16 v[112:127], v[32:35], v[42:45], v[112:127]
    v_mfma_f32_32x32x16_bf16 v[128:143], v[34:37], v[38:41], v[128:143]
    v_mfma_f32_32x32x16_bf16 v[144:159], v[34:37], v[42:45], v[144:159]
    s_barrier
    s_waitcnt lgkmcnt(8)
    v_mfma_f32_32x32x16_bf16 v[96:111], v[80:83], v[88:91], v[96:111]
    v_mfma_f32_32x32x16_bf16 v[112:127], v[80:83], v[92:95], v[112:127]
    v_mfma_f32_32x32x16_bf16 v[128:143], v[84:87], v[88:91], v[128:143]
    v_mfma_f32_32x32x16_bf16 v[144:159], v[84:87], v[92:95], v[144:159]
    s_waitcnt lgkmcnt(0)
    s_barrier
    v_mfma_f32_32x32x16_bf16 v[96:111], v[48:51], v[56:59], v[96:111]
    v_mfma_f32_32x32x16_bf16 v[112:127], v[48:51], v[60:63], v[112:127]
    v_mfma_f32_32x32x16_bf16 v[128:143], v[52:55], v[56:59], v[128:143]
    v_mfma_f32_32x32x16_bf16 v[144:159], v[52:55], v[60:63], v[144:159]
    s_nop 8
    v_pk_mul_f32 v[48:49], v[96:97], v[96:97]
    v_pk_mul_f32 v[50:51], v[98:99], v[98:99]
    v_pk_mul_f32 v[52:53], v[100:101], v[100:101]
    v_pk_mul_f32 v[54:55], v[102:103], v[102:103]
    v_pk_fma_f32 v[48:49], v[48:49], v[24:25], v[24:25] op_sel:[0,1,0] op_sel_hi:[1,1,0]
    v_pk_fma_f32 v[50:51], v[50:51], v[24:25], v[24:25] op_sel:[0,1,0] op_sel_hi:[1,1,0]
    v_pk_fma_f32 v[52:53], v[52:53], v[24:25], v[24:25] op_sel:[0,1,0] op_sel_hi:[1,1,0]
    v_pk_fma_f32 v[54:55], v[54:55], v[24:25], v[24:25] op_sel:[0,1,0] op_sel_hi:[1,1,0]
    s_branch Lpg4
.p2align 12
Lpw4:
    s_setpc_b64 s[96:97]
    s_nop 0
Lpg4:
    v_pk_mul_f32 v[48:49], v[48:49], v[96:97]
    v_pk_mul_f32 v[50:51], v[50:51], v[98:99]
    v_pk_mul_f32 v[52:53], v[52:53], v[100:101]
    v_pk_mul_f32 v[54:55], v[54:55], v[102:103]
    v_exp_f32 v48, v48
    v_exp_f32 v49, v49
    v_exp_f32 v50, v50
    v_exp_f32 v51, v51
    v_exp_f32 v52, v52
    v_exp_f32 v53, v53
    v_exp_f32 v54, v54
    v_exp_f32 v55, v55
    v_pk_mul_f32 v[56:57], v[96:97], v[104:105]
    v_pk_mul_f32 v[58:59], v[98:99], v[106:107]
    v_pk_mul_f32 v[60:61], v[100:101], v[108:109]
    v_pk_mul_f32 v[62:63], v[102:103], v[110:111]
    v_pk_fma_f32 v[48:49], v[48:49], v[26:27], v[26:27] op_sel_hi:[1,0,0]
    v_pk_fma_f32 v[50:51], v[50:51], v[26:27], v[26:27] op_sel_hi:[1,0,0]
    v_pk_fma_f32 v[52:53], v[52:53], v[26:27], v[26:27] op_sel_hi:[1,0,0]
    v_pk_fma_f32 v[54:55], v[54:55], v[26:27], v[26:27] op_sel_hi:[1,0,0]
    v_rcp_f32 v48, v48
    v_rcp_f32 v49, v49
    v_rcp_f32 v50, v50
    v_rcp_f32 v51, v51
    v_rcp_f32 v52, v52
    v_rcp_f32 v53, v53
    v_rcp_f32 v54, v54
    v_rcp_f32 v55, v55
    v_pk_mul_f32 v[56:57], v[56:57], v[48:49]
    v_pk_mul_f32 v[58:59], v[58:59], v[50:51]
    v_pk_mul_f32 v[60:61], v[60:61], v[52:53]
    v_pk_mul_f32 v[62:63], v[62:63], v[54:55]
    v_cvt_pk_bf16_f32 v64, v56, v57
    v_cvt_pk_bf16_f32 v65, v58, v59
    v_cvt_pk_bf16_f32 v66, v60, v61
    v_cvt_pk_bf16_f32 v67, v62, v63
    global_store_dwordx4 v12, v[64:67], s[30:31] offset:0 sc0 sc1
    v_pk_mul_f32 v[48:49], v[112:113], v[112:113]
    v_pk_mul_f32 v[50:51], v[114:115], v[114:115]
    v_pk_mul_f32 v[52:53], v[116:117], v[116:117]
    v_pk_mul_f32 v[54:55], v[118:119], v[118:119]
    v_pk_fma_f32 v[48:49], v[48:49], v[28:29], v[28:29] op_sel:[0,1,0] op_sel_hi:[1,1,0]
    v_pk_fma_f32 v[50:51], v[50:51], v[28:29], v[28:29] op_sel:[0,1,0] op_sel_hi:[1,1,0]
    v_pk_fma_f32 v[52:53], v[52:53], v[28:29], v[28:29] op_sel:[0,1,0] op_sel_hi:[1,1,0]
    v_pk_fma_f32 v[54:55], v[54:55], v[28:29], v[28:29] op_sel:[0,1,0] op_sel_hi:[1,1,0]
    v_pk_mul_f32 v[48:49], v[48:49], v[112:113]
    v_pk_mul_f32 v[50:51], v[50:51], v[114:115]
    v_pk_mul_f32 v[52:53], v[52:53], v[116:117]
    v_pk_mul_f32 v[54:55], v[54:55], v[118:119]
    v_exp_f32 v48, v48
    v_exp_f32 v49, v49
    v_exp_f32 v50, v50
    v_exp_f32 v51, v51
    v_exp_f32 v52, v52
    v_exp_f32 v53, v53
    v_exp_f32 v54, v54
    v_exp_f32 v55, v55
    v_pk_mul_f32 v[56:57], v[112:113], v[120:121]
    v_pk_mul_f32 v[58:59], v[114:115], v[122:123]
    v_pk_mul_f32 v[60:61], v[116:117], v[124:125]
    v_pk_mul_f32 v[62:63], v[118:119], v[126:127]
    v_pk_fma_f32 v[48:49], v[48:49], v[30:31], v[30:31] op_sel_hi:[1,0,0]
    v_pk_fma_f32 v[50:51], v[50:51], v[30:31], v[30:31] op_sel_hi:[1,0,0]
    v_pk_fma_f32 v[52:53], v[52:53], v[30:31], v[30:31] op_sel_hi:[1,0,0]
    v_pk_fma_f32 v[54:55], v[54:55], v[30:31], v[30:31] op_sel_hi:[1,0,0]
    v_rcp_f32 v48, v48
    v_rcp_f32 v49, v49
    v_rcp_f32 v50, v50
    v_rcp_f32 v51, v51
    v_rcp_f32 v52, v52
    v_rcp_f32 v53, v53
    v_rcp_f32 v54, v54
    v_rcp_f32 v55, v55
    v_pk_mul_f32 v[56:57], v[56:57], v[48:49]
    v_pk_mul_f32 v[58:59], v[58:59], v[50:51]
    v_pk_mul_f32 v[60:61], v[60:61], v[52:53]
    v_pk_mul_f32 v[62:63], v[62:63], v[54:55]
    v_cvt_pk_bf16_f32 v68, v56, v57
    v_cvt_pk_bf16_f32 v69, v58, v59
    v_cvt_pk_bf16_f32 v70, v60, v61
    v_cvt_pk_bf16_f32 v71, v62, v63
    global_store_dwordx4 v13, v[68:71], s[30:31] offset:0 sc0 sc1
    v_pk_mul_f32 v[48:49], v[128:129], v[128:129]
    v_pk_mul_f32 v[50:51], v[130:131], v[130:131]
    v_pk_mul_f32 v[52:53], v[132:133], v[132:133]
    v_pk_mul_f32 v[54:55], v[134:135], v[134:135]
    v_pk_fma_f32 v[48:49], v[48:49], v[24:25], v[24:25] op_sel:[0,1,0] op_sel_hi:[1,1,0]
    v_pk_fma_f32 v[50:51], v[50:51], v[24:25], v[24:25] op_sel:[0,1,0] op_sel_hi:[1,1,0]
    v_pk_fma_f32 v[52:53], v[52:53], v[24:25], v[24:25] op_sel:[0,1,0] op_sel_hi:[1,1,0]
    v_pk_fma_f32 v[54:55], v[54:55], v[24:25], v[24:25] op_sel:[0,1,0] op_sel_hi:[1,1,0]
    v_pk_mul_f32 v[48:49], v[48:49], v[128:129]
    v_pk_mul_f32 v[50:51], v[50:51], v[130:131]
    v_pk_mul_f32 v[52:53], v[52:53], v[132:133]
    v_pk_mul_f32 v[54:55], v[54:55], v[134:135]
    v_exp_f32 v48, v48
    v_exp_f32 v49, v49
    v_exp_f32 v50, v50
    v_exp_f32 v51, v51
    v_exp_f32 v52, v52
    v_exp_f32 v53, v53
    v_exp_f32 v54, v54
    v_exp_f32 v55, v55
    v_pk_mul_f32 v[56:57], v[128:129], v[136:137]
    v_pk_mul_f32 v[58:59], v[130:131], v[138:139]
    v_pk_mul_f32 v[60:61], v[132:133], v[140:141]
    v_pk_mul_f32 v[62:63], v[134:135], v[142:143]
    v_pk_fma_f32 v[48:49], v[48:49], v[26:27], v[26:27] op_sel_hi:[1,0,0]
    v_pk_fma_f32 v[50:51], v[50:51], v[26:27], v[26:27] op_sel_hi:[1,0,0]
    v_pk_fma_f32 v[52:53], v[52:53], v[26:27], v[26:27] op_sel_hi:[1,0,0]
    v_pk_fma_f32 v[54:55], v[54:55], v[26:27], v[26:27] op_sel_hi:[1,0,0]
    v_rcp_f32 v48, v48
    v_rcp_f32 v49, v49
    v_rcp_f32 v50, v50
    v_rcp_f32 v51, v51
    v_rcp_f32 v52, v52
    v_rcp_f32 v53, v53
    v_rcp_f32 v54, v54
    v_rcp_f32 v55, v55
    v_pk_mul_f32 v[56:57], v[56:57], v[48:49]
    v_pk_mul_f32 v[58:59], v[58:59], v[50:51]
    v_pk_mul_f32 v[60:61], v[60:61], v[52:53]
    v_pk_mul_f32 v[62:63], v[62:63], v[54:55]
    v_cvt_pk_bf16_f32 v64, v56, v57
    v_cvt_pk_bf16_f32 v65, v58, v59
    v_cvt_pk_bf16_f32 v66, v60, v61
    v_cvt_pk_bf16_f32 v67, v62, v63
    global_store_dwordx4 v12, v[64:67], s[30:31] offset:1024 sc0 sc1
    v_pk_mul_f32 v[48:49], v[144:145], v[144:145]
    v_pk_mul_f32 v[50:51], v[146:147], v[146:147]
    v_pk_mul_f32 v[52:53], v[148:149], v[148:149]
    v_pk_mul_f32 v[54:55], v[150:151], v[150:151]
    v_pk_fma_f32 v[48:49], v[48:49], v[28:29], v[28:29] op_sel:[0,1,0] op_sel_hi:[1,1,0]
    v_pk_fma_f32 v[50:51], v[50:51], v[28:29], v[28:29] op_sel:[0,1,0] op_sel_hi:[1,1,0]
    v_pk_fma_f32 v[52:53], v[52:53], v[28:29], v[28:29] op_sel:[0,1,0] op_sel_hi:[1,1,0]
    v_pk_fma_f32 v[54:55], v[54:55], v[28:29], v[28:29] op_sel:[0,1,0] op_sel_hi:[1,1,0]
    v_pk_mul_f32 v[48:49], v[48:49], v[144:145]
    v_pk_mul_f32 v[50:51], v[50:51], v[146:147]
    v_pk_mul_f32 v[52:53], v[52:53], v[148:149]
    v_pk_mul_f32 v[54:55], v[54:55], v[150:151]
    v_exp_f32 v48, v48
    v_exp_f32 v49, v49
    v_exp_f32 v50, v50
    v_exp_f32 v51, v51
    v_exp_f32 v52, v52
    v_exp_f32 v53, v53
    v_exp_f32 v54, v54
    v_exp_f32 v55, v55
    v_pk_mul_f32 v[56:57], v[144:145], v[152:153]
    v_pk_mul_f32 v[58:59], v[146:147], v[154:155]
    v_pk_mul_f32 v[60:61], v[148:149], v[156:157]
    v_pk_mul_f32 v[62:63], v[150:151], v[158:159]
    v_pk_fma_f32 v[48:49], v[48:49], v[30:31], v[30:31] op_sel_hi:[1,0,0]
    v_pk_fma_f32 v[50:51], v[50:51], v[30:31], v[30:31] op_sel_hi:[1,0,0]
    v_pk_fma_f32 v[52:53], v[52:53], v[30:31], v[30:31] op_sel_hi:[1,0,0]
    v_pk_fma_f32 v[54:55], v[54:55], v[30:31], v[30:31] op_sel_hi:[1,0,0]
    v_rcp_f32 v48, v48
    v_rcp_f32 v49, v49
    v_rcp_f32 v50, v50
    v_rcp_f32 v51, v51
    v_rcp_f32 v52, v52
    v_rcp_f32 v53, v53
    v_rcp_f32 v54, v54
    v_rcp_f32 v55, v55
    v_pk_mul_f32 v[56:57], v[56:57], v[48:49]
    v_pk_mul_f32 v[58:59], v[58:59], v[50:51]
    v_pk_mul_f32 v[60:61], v[60:61], v[52:53]
    v_pk_mul_f32 v[62:63], v[62:63], v[54:55]
    v_cvt_pk_bf16_f32 v68, v56, v57
    v_cvt_pk_bf16_f32 v69, v58, v59
    v_cvt_pk_bf16_f32 v70, v60, v61
    v_cvt_pk_bf16_f32 v71, v62, v63
    global_store_dwordx4 v13, v[68:71], s[30:31] offset:1024 sc0 sc1
    s_setprio 0
    s_barrier
    s_mov_b32 s70, 1
    s_waitcnt vmcnt(2)
    s_atomic_add s70, s[30:31], s58
    s_add_u32 s58, s58, 128
    s_mov_b32 s70, 1
    s_waitcnt vmcnt(0)
    s_atomic_add s70, s[30:31], s58
    s_add_u32 s58, s58, 128
    s_mov_b32 s69, 0
    s_add_u32 s68, s59, 512
    s_atomic_add s69, s[30:31], s68 glc
    s_barrier
    s_mov_b32 s45, 0
poll_30:
    s_waitcnt lgkmcnt(0)
    s_cmp_ge_u32 s69, 14
    s_cbranch_scc1 ok_31
    s_mov_b32 s69, 0
    s_add_u32 s68, s59, 512
    s_atomic_add s69, s[30:31], s68 glc
    s_add_u32 s45, s45, 1
    s_cmp_lt_u32 s45, 262144
    s_cbranch_scc1 poll_30
    s_waitcnt lgkmcnt(0)
ok_31:
    s_mov_b32 s71, 0
    s_add_u32 s68, s59, 640
    s_atomic_add s71, s[30:31], s68 glc
    s_barrier
    s_mov_b32 s45, 0
poll_32:
    s_waitcnt lgkmcnt(0)
    s_cmp_ge_u32 s71, 14
    s_cbranch_scc1 ok_33
    s_mov_b32 s71, 0
    s_add_u32 s68, s59, 640
    s_atomic_add s71, s[30:31], s68 glc
    s_add_u32 s45, s45, 1
    s_cmp_lt_u32 s45, 262144
    s_cbranch_scc1 poll_32
    s_waitcnt lgkmcnt(0)
ok_33:
    s_barrier
    s_waitcnt lgkmcnt(0)
    s_endpgm
.p2align 3
auxt_6:
    s_setprio 3
    s_add_u32 s64, s30, 10489856
    s_addc_u32 s65, s31, 0
    s_mov_b32 s66, 3670016
    s_mov_b32 s67, 0x20000
    v_and_b32 v4, 15, v1
    v_lshrrev_b32 v5, 4, v1
    v_lshl_add_u32 v6, v4, 8, s46
    v_lshl_add_u32 v6, v5, 2, v6
    v_and_b32_e64 v7, 7, v4
    v_lshl_add_u32 v6, v7, 4, v6
    v_lshlrev_b32_e64 v9, 14, v5
    v_lshl_add_u32 v9, v4, 4, v9
    s_lshl_b32 s46, s36, 2
    s_add_u32 s46, s46, 148480
    v_mov_b32 v2, s46
    v_xor_b32 v81, 16, v6
    v_xor_b32 v82, 32, v6
    v_xor_b32 v83, 48, v6
    v_xor_b32 v84, 64, v6
    v_xor_b32 v85, 80, v6
    v_xor_b32 v86, 96, v6
    v_xor_b32 v87, 112, v6
    s_waitcnt lgkmcnt(0)
    s_add_u32 s57, s57, 1
    s_and_b32 s57, s57, 0xffff
    s_or_b32 s57, s57, 0x7f810000
    v_mov_b32 v49, s57
    v_mov_b32 v51, s57
    v_mov_b32 v53, s57
    v_mov_b32 v55, s57
    v_mov_b32 v57, s57
    v_mov_b32 v59, s57
    v_mov_b32 v61, s57
    v_mov_b32 v63, s57
    v_mov_b32 v65, s57
    v_mov_b32 v67, s57
    v_mov_b32 v69, s57
    v_mov_b32 v71, s57
    v_mov_b32 v73, s57
    v_mov_b32 v75, s57
    v_mov_b32 v77, s57
    v_mov_b32_e64 v79, s57
    s_mov_b64 exec, 1
    ds_write_b32 v2, v49
    s_mov_b64 exec, -1
    s_cmp_eq_u32 s36, 1
    s_cbranch_scc1 wm_34
    s_call_b64 s[96:97], Lmww
    s_call_b64 s[96:97], nw_4w
    s_call_b64 s[96:97], odd_10w
    s_call_b64 s[96:97], Lpw4
    s_branch wm_35
wm_34:
    s_call_b64 s[96:97], Lpw3
    s_call_b64 s[96:97], Lpw1
    s_call_b64 s[96:97], Lpw5
    s_call_b64 s[96:97], Lpw2
wm_35:
    s_waitcnt vmcnt(0)
    s_nop 0
    ds_read_b32 v48, v6
    ds_read_b32 v50, v6 offset:128
    ds_read_b32 v52, v81
    ds_read_b32 v54, v81 offset:128
    ds_read_b32 v56, v82
    ds_read_b32 v58, v82 offset:128
    ds_read_b32 v60, v83
    ds_read_b32 v62, v83 offset:128
    ds_read_b32 v64, v84
    ds_read_b32 v66, v84 offset:128
    ds_read_b32 v68, v85
    ds_read_b32 v70, v85 offset:128
    ds_read_b32 v72, v86
    ds_read_b32 v74, v86 offset:128
    ds_read_b32 v76, v87
    ds_read_b32 v78, v87 offset:128
    s_waitcnt lgkmcnt(14)
    buffer_store_dwordx4 v[48:51], v9, s[64:67], s51 offen sc0 sc1
    s_add_u32 s51, s51, 65536
    s_waitcnt lgkmcnt(12)
    buffer_store_dwordx4 v[52:55], v9, s[64:67], s51 offen sc0 sc1
    s_add_u32 s51, s51, 65536
    s_waitcnt lgkmcnt(10)
    buffer_store_dwordx4 v[56:59], v9, s[64:67], s51 offen sc0 sc1
    s_add_u32 s51, s51, 65536
    s_waitcnt lgkmcnt(8)
    buffer_store_dwordx4 v[60:63], v9, s[64:67], s51 offen sc0 sc1
    s_add_u32 s51, s51, 65536
    s_waitcnt lgkmcnt(6)
    buffer_store_dwordx4 v[64:67], v9, s[64:67], s51 offen sc0 sc1
    s_add_u32 s51, s51, 65536
    s_waitcnt lgkmcnt(4)
    buffer_store_dwordx4 v[68:71], v9, s[64:67], s51 offen sc0 sc1
    s_add_u32 s51, s51, 65536
    s_waitcnt lgkmcnt(2)
    buffer_store_dwordx4 v[72:75], v9, s[64:67], s51 offen sc0 sc1
    s_add_u32 s51, s51, 65536
    s_waitcnt lgkmcnt(0)
    buffer_store_dwordx4 v[76:79], v9, s[64:67], s51 offen sc0 sc1
    v_mov_b32 v24, 0
    v_mov_b32_e64 v25, 0
    s_lshl_b32 s43, s2, 1
    s_add_u32 s43, s43, s36
    s_lshl_b32 s44, s43, 9
    s_add_u32 s44, s44, 14712832
    v_lshl_add_u32 v3, v1, 3, s44
    global_store_dwordx2 v3, v[24:25], s[30:31] sc0 sc1
    s_and_b32 s44, s43, 255
    s_lshl_b32 s44, s44, 7
    s_add_u32 s44, s44, 14680064
    v_mov_b32_e64 v4, s44
    s_mov_b64 exec, 1
    global_store_dword v4, v24, s[30:31] sc0 sc1
    s_mov_b64 exec, -1
    s_lshl_b32 s44, s43, 2
    s_add_u32 s44, s44, 20480
    v_mov_b32 v22, s44
    v_mov_b32 v23, s57
    s_setprio 0
    s_barrier
    s_and_b32 s37, s2, 7
    s_lshr_b32 s38, s2, 3
    s_and_b32 s40, s38, 3
    s_lshr_b32 s39, s37, 1
    s_lshl_b32 s39, s39, 2
    s_add_u32 s39, s39, s40
    s_and_b32 s34, s37, 1
    s_lshr_b32 s35, s38, 2
    s_mul_i32 s38, s34, 7
    s_add_u32 s38, s38, s35
    s_mul_i32 s33, s40, 3
    s_lshl_b32 s37, s35, 1
    s_add_u32 s33, s33, s37
    s_cmp_ge_u32 s33, 14
    s_cselect_b32 s37, 14, 0
    s_sub_u32 s33, s33, s37
    v_lshrrev_b32 v6, 3, v1
    v_and_b32 v7, 7, v1
    v_and_b32 v5, 2, v6
    v_lshlrev_b32 v4, 1, v5
    v_xor_b32_e64 v4, v4, v7
    v_mul_u32_u24 v3, 896, v6
    v_lshl_add_u32 v12, v4, 4, v3
    v_add_u32 v13, 6144, v12
    v_add_u32 v14, 12288, v12
    v_add_u32 v15, 18432, v12
    s_lshl_b32 s46, s35, 7
    s_mul_i32 s32, s36, 28672
    s_add_u32 s46, s46, s32
    s_mul_i32 s42, s33, 114688
    s_add_u32 s42, s42, s46
    s_add_u32 s46, s46, 1605632
    s_lshl_b32 s32, s36, 12
    v_lshl_add_u32 v16, v1, 4, s32
    v_add_u32 v17, 0x10000, v16
    v_add_u32 v18, 0x20000, v16
    s_lshl_b32 s59, s39, 11
    s_lshl_b32 s58, s34, 10
    s_add_u32 s59, s59, s58
    s_lshl_b32 s58, s36, 8
    s_add_u32 s59, s59, s58
    s_add_u32 s59, s59, 14680064
    s_lshl_b32 s43, s39, 1
    s_add_u32 s43, s43, s34
    s_mul_i32 s43, s43, 229376
    s_lshl_b32 s44, s36, 11
    s_add_u32 s43, s43, s44
    s_add_u32 s43, s43, 2101248
    v_bfe_u32 v3, v1, 3, 1
    v_add_u32 v3, s33, v3
    v_cmp_gt_u32 vcc, 14, v3
    s_nop 1
    v_cndmask_b32 v3, 0, v3, vcc
    v_lshlrev_b32 v3, 13, v3
    v_bfe_u32 v4, v1, 4, 1
    v_mul_u32_u24 v4, 114688, v4
    v_add3_u32 v3, v3, v4, s43
    v_lshl_add_u32 v19, v7, 7, v3
    s_mov_b32 s60, s24
    s_mov_b32 s61, s25
    s_mov_b32 s62, 1605632
    s_mov_b32 s63, 0x20000
    v_xor_b32 v4, v5, v7
    s_lshl_b32 s43, s36, 2
    v_xor_b32_e64 v4, s43, v4
    v_mul_u32_u24 v3, 3584, v6
    v_lshl_add_u32 v8, v4, 4, v3
    v_add_u32 v9, 27648, v8
    v_add_u32 v10, 55296, v8
    v_add_u32 v11, 82944, v8
    s_lshl_b32 s45, s38, 8
    s_mul_i32 s41, s38, 114688
    s_add_u32 s41, s41, s45
    s_add_u32 s45, s45, 1605632
    s_cmp_eq_u32 s36, 0
    s_cselect_b32 s20, s20, s22
    s_cselect_b32 s21, s21, s23
    s_mov_b32 s52, s20
    s_mov_b32 s53, s21
    s_mov_b32 s54, 1605632
    s_mov_b32 s55, 0x20000
    v_mov_b32 v20, 0
    v_mov_b32 v21, 0
    v_lshrrev_b32 v4, 4, v1
    v_mul_u32_u24 v4, 4160, v4
    v_and_b32_e64 v5, 15, v1
    v_lshl_add_u32 v4, v5, 2, v4
    s_lshl_b32 s43, s36, 15
    v_add_u32 v4, s43, v4
    s_mul_i32 s43, s36, 4608
    s_add_u32 s43, s43, 74240
    v_lshl_add_u32 v3, v1, 3, s43
    s_barrier
    ds_write_b32 v4, v20 offset:8704
    ds_write_b64 v3, v[20:21]
    s_waitcnt vmcnt(0)
    s_mov_b64 exec, 1
    global_store_dword v22, v23, s[30:31] sc0 sc1
    s_mov_b64 exec, -1
    s_waitcnt lgkmcnt(0)
    s_barrier
    s_add_u32 m0, s32, 114688
    s_add_u32 s33, s41, 114688
    buffer_load_dwordx4 v8, s[52:55], s41 offen offset:0 lds
    s_cmp_ge_u32 s33, s45
    s_cselect_b32 s34, 1605632, 0
    buffer_load_dwordx4 v9, s[52:55], s41 offen offset:1024 lds
    buffer_load_dwordx4 v10, s[52:55], s41 offen offset:2048 lds
    buffer_load_dwordx4 v11, s[52:55], s41 offen offset:3072 lds
    s_sub_u32 s41, s33, s34
    s_add_u32 m0, s32, 122880
    s_add_u32 s33, s41, 114688
    buffer_load_dwordx4 v8, s[52:55], s41 offen offset:0 lds
    s_cmp_ge_u32 s33, s45
    s_cselect_b32 s34, 1605632, 0
    buffer_load_dwordx4 v9, s[52:55], s41 offen offset:1024 lds
    buffer_load_dwordx4 v10, s[52:55], s41 offen offset:2048 lds
    buffer_load_dwordx4 v11, s[52:55], s41 offen offset:3072 lds
    s_sub_u32 s41, s33, s34
    s_add_u32 m0, s32, 131072
    s_add_u32 s33, s41, 114688
    buffer_load_dwordx4 v8, s[52:55], s41 offen offset:0 lds
    s_cmp_ge_u32 s33, s45
    s_cselect_b32 s34, 1605632, 0
    buffer_load_dwordx4 v9, s[52:55], s41 offen offset:1024 lds
    buffer_load_dwordx4 v10, s[52:55], s41 offen offset:2048 lds
    buffer_load_dwordx4 v11, s[52:55], s41 offen offset:3072 lds
    s_sub_u32 s41, s33, s34
    s_add_u32 m0, s32, 139264
    s_add_u32 s33, s41, 114688
    buffer_load_dwordx4 v8, s[52:55], s41 offen offset:0 lds
    s_cmp_ge_u32 s33, s45
    s_cselect_b32 s34, 1605632, 0
    buffer_load_dwordx4 v9, s[52:55], s41 offen offset:1024 lds
    buffer_load_dwordx4 v10, s[52:55], s41 offen offset:2048 lds
    buffer_load_dwordx4 v11, s[52:55], s41 offen offset:3072 lds
    s_sub_u32 s41, s33, s34
    s_add_u32 m0, s32, 147456
    s_add_u32 s33, s41, 114688
    buffer_load_dwordx4 v8, s[52:55], s41 offen offset:0 lds
    s_cmp_ge_u32 s33, s45
    s_cselect_b32 s34, 1605632, 0
    buffer_load_dwordx4 v9, s[52:55], s41 offen offset:1024 lds
    buffer_load_dwordx4 v10, s[52:55], s41 offen offset:2048 lds
    buffer_load_dwordx4 v11, s[52:55], s41 offen offset:3072 lds
    s_sub_u32 s41, s33, s34
    s_add_u32 m0, s32, 155648
    s_add_u32 s33, s41, 114688
    buffer_load_dwordx4 v8, s[52:55], s41 offen offset:0 lds
    s_cmp_ge_u32 s33, s45
    s_cselect_b32 s34, 1605632, 0
    buffer_load_dwordx4 v9, s[52:55], s41 offen offset:1024 lds
    buffer_load_dwordx4 v10, s[52:55], s41 offen offset:2048 lds
    buffer_load_dwordx4 v11, s[52:55], s41 offen offset:3072 lds
    s_sub_u32 s41, s33, s34
    s_add_u32 s43, s42, 57344
    s_add_u32 s44, s46, 57344
    s_cmp_ge_u32 s43, s44
    s_cselect_b32 s34, 1605632, 0
    s_sub_u32 s43, s43, s34
    buffer_load_dwordx4 v[24:27], v12, s[60:63], s43 offen offset:0
    buffer_load_dwordx4 v[28:31], v13, s[60:63], s43 offen offset:1024
    buffer_load_dwordx4 v[32:35], v14, s[60:63], s43 offen offset:2048
    buffer_load_dwordx4 v[36:39], v15, s[60:63], s43 offen offset:3072
    s_add_u32 s43, s43, 114688
    s_cmp_ge_u32 s43, s44
    s_cselect_b32 s34, 1605632, 0
    s_sub_u32 s43, s43, s34
    buffer_load_dwordx4 v[40:43], v12, s[60:63], s43 offen offset:0
    buffer_load_dwordx4 v[44:47], v13, s[60:63], s43 offen offset:1024
    buffer_load_dwordx4 v[48:51], v14, s[60:63], s43 offen offset:2048
    buffer_load_dwordx4 v[52:55], v15, s[60:63], s43 offen offset:3072
    s_add_u32 s43, s43, 114688
    s_cmp_ge_u32 s43, s44
    s_cselect_b32 s34, 1605632, 0
    s_sub_u32 s43, s43, s34
    buffer_load_dwordx4 v[56:59], v12, s[60:63], s43 offen offset:0
    buffer_load_dwordx4 v[60:63], v13, s[60:63], s43 offen offset:1024
    buffer_load_dwordx4 v[64:67], v14, s[60:63], s43 offen offset:2048
    buffer_load_dwordx4 v[68:71], v15, s[60:63], s43 offen offset:3072
    s_add_u32 s43, s43, 114688
    v_lshrrev_b32 v2, 4, v1
    v_and_b32 v3, 15, v1
    v_lshlrev_b32 v4, 2, v2
    v_xor_b32 v4, v4, v3
    v_lshlrev_b32 v4, 4, v4
    v_and_b32 v3, 1, v2
    v_lshl_add_u32 v4, v3, 12, v4
    v_lshrrev_b32_e64 v2, 1, v2
    v_lshl_add_u32 v4, v2, 14, v4
    v_add_u32 v5, 31744, v4
    v_add_u32 v6, 63488, v4
    v_add_u32 v7, 95232, v4
    s_lshl_b32 s47, s39, 8
    s_lshl_b32 s43, s36, 17
    s_add_u32 s47, s47, s43
    s_add_u32 s40, s38, 5
    s_cmp_ge_u32 s40, 14
    s_cselect_b32 s43, 14, 0
    s_sub_u32 s40, s40, s43
    s_lshl_b32 s40, s40, 18
    s_add_u32 s40, s40, s47
    s_add_u32 s47, s47, 3670016
    s_add_u32 s48, s30, 10489856
    s_addc_u32 s49, s31, 0
    s_mov_b32 s50, 3670016
    s_mov_b32 s51, 0x20000
    s_barrier
    s_add_u32 s43, s42, 401408
    s_add_u32 s44, s46, 57344
    s_barrier
    s_waitcnt vmcnt(12)
    s_barrier
    s_add_u32 m0, s32, 40960
    s_add_u32 s33, s40, 262144
    buffer_load_dwordx4 v4, s[48:51], s40 offen offset:0 sc1 lds
    s_cmp_ge_u32 s33, s47
    s_cselect_b32 s34, 3670016, 0
    buffer_load_dwordx4 v5, s[48:51], s40 offen offset:1024 sc1 lds
    buffer_load_dwordx4 v6, s[48:51], s40 offen offset:2048 sc1 lds
    buffer_load_dwordx4 v7, s[48:51], s40 offen offset:3072 sc1 lds
    s_sub_u32 s40, s33, s34
    s_add_u32 m0, s32, 49152
    s_add_u32 s33, s40, 262144
    buffer_load_dwordx4 v4, s[48:51], s40 offen offset:0 sc1 lds
    s_cmp_ge_u32 s33, s47
    s_cselect_b32 s34, 3670016, 0
    buffer_load_dwordx4 v5, s[48:51], s40 offen offset:1024 sc1 lds
    buffer_load_dwordx4 v6, s[48:51], s40 offen offset:2048 sc1 lds
    buffer_load_dwordx4 v7, s[48:51], s40 offen offset:3072 sc1 lds
    s_sub_u32 s40, s33, s34
    s_barrier
    s_add_u32 m0, s32, 57344
    s_add_u32 s33, s40, 262144
    buffer_load_dwordx4 v4, s[48:51], s40 offen offset:0 sc1 lds
    s_cmp_ge_u32 s33, s47
    s_cselect_b32 s34, 3670016, 0
    buffer_load_dwordx4 v5, s[48:51], s40 offen offset:1024 sc1 lds
    buffer_load_dwordx4 v6, s[48:51], s40 offen offset:2048 sc1 lds
    buffer_load_dwordx4 v7, s[48:51], s40 offen offset:3072 sc1 lds
    s_sub_u32 s40, s33, s34
    s_add_u32 m0, s32, 65536
    s_add_u32 s33, s40, 262144
    buffer_load_dwordx4 v4, s[48:51], s40 offen offset:0 sc1 lds
    s_cmp_ge_u32 s33, s47
    s_cselect_b32 s34, 3670016, 0
    buffer_load_dwordx4 v5, s[48:51], s40 offen offset:1024 sc1 lds
    buffer_load_dwordx4 v6, s[48:51], s40 offen offset:2048 sc1 lds
    buffer_load_dwordx4 v7, s[48:51], s40 offen offset:3072 sc1 lds
    s_sub_u32 s40, s33, s34
    s_barrier
    s_add_u32 m0, s32, 114688
    s_add_u32 s33, s41, 114688
    buffer_load_dwordx4 v8, s[52:55], s41 offen offset:0 lds
    s_cmp_ge_u32 s33, s45
    s_cselect_b32 s34, 1605632, 0
    buffer_load_dwordx4 v9, s[52:55], s41 offen offset:1024 lds
    buffer_load_dwordx4 v10, s[52:55], s41 offen offset:2048 lds
    buffer_load_dwordx4 v11, s[52:55], s41 offen offset:3072 lds
    s_sub_u32 s41, s33, s34
    s_add_u32 m0, s32, 73728
    s_add_u32 s33, s40, 262144
    buffer_load_dwordx4 v4, s[48:51], s40 offen offset:0 sc1 lds
    s_cmp_ge_u32 s33, s47
    s_cselect_b32 s34, 3670016, 0
    buffer_load_dwordx4 v5, s[48:51], s40 offen offset:1024 sc1 lds
    buffer_load_dwordx4 v6, s[48:51], s40 offen offset:2048 sc1 lds
    buffer_load_dwordx4 v7, s[48:51], s40 offen offset:3072 sc1 lds
    s_sub_u32 s40, s33, s34
    s_waitcnt vmcnt(20)
    s_barrier
    s_add_u32 m0, s32, 122880
    s_add_u32 s33, s41, 114688
    buffer_load_dwordx4 v8, s[52:55], s41 offen offset:0 lds
    s_cmp_ge_u32 s33, s45
    s_cselect_b32 s34, 1605632, 0
    buffer_load_dwordx4 v9, s[52:55], s41 offen offset:1024 lds
    buffer_load_dwordx4 v10, s[52:55], s41 offen offset:2048 lds
    buffer_load_dwordx4 v11, s[52:55], s41 offen offset:3072 lds
    s_sub_u32 s41, s33, s34
    s_add_u32 m0, s32, 81920
    s_add_u32 s33, s40, 262144
    buffer_load_dwordx4 v4, s[48:51], s40 offen offset:0 sc1 lds
    s_cmp_ge_u32 s33, s47
    s_cselect_b32 s34, 3670016, 0
    buffer_load_dwordx4 v5, s[48:51], s40 offen offset:1024 sc1 lds
    buffer_load_dwordx4 v6, s[48:51], s40 offen offset:2048 sc1 lds
    buffer_load_dwordx4 v7, s[48:51], s40 offen offset:3072 sc1 lds
    s_sub_u32 s40, s33, s34
    s_waitcnt vmcnt(32)
    s_waitcnt vmcnt(24)
    s_barrier
    s_add_u32 m0, s32, 131072
    s_add_u32 s33, s41, 114688
    buffer_load_dwordx4 v8, s[52:55], s41 offen offset:0 lds
    s_cmp_ge_u32 s33, s45
    s_cselect_b32 s34, 1605632, 0
    buffer_load_dwordx4 v9, s[52:55], s41 offen offset:1024 lds
    buffer_load_dwordx4 v10, s[52:55], s41 offen offset:2048 lds
    buffer_load_dwordx4 v11, s[52:55], s41 offen offset:3072 lds
    s_sub_u32 s41, s33, s34
    s_add_u32 m0, s32, 90112
    s_add_u32 s33, s40, 262144
    buffer_load_dwordx4 v4, s[48:51], s40 offen offset:0 sc1 lds
    s_cmp_ge_u32 s33, s47
    s_cselect_b32 s34, 3670016, 0
    buffer_load_dwordx4 v5, s[48:51], s40 offen offset:1024 sc1 lds
    buffer_load_dwordx4 v6, s[48:51], s40 offen offset:2048 sc1 lds
    buffer_load_dwordx4 v7, s[48:51], s40 offen offset:3072 sc1 lds
    s_sub_u32 s40, s33, s34
    s_waitcnt vmcnt(28)
    s_barrier
    s_add_u32 m0, s32, 139264
    s_add_u32 s33, s41, 114688
    buffer_load_dwordx4 v8, s[52:55], s41 offen offset:0 lds
    s_cmp_ge_u32 s33, s45
    s_cselect_b32 s34, 1605632, 0
    s_branch Lpg5
.p2align 12
Lpw5:
    s_setpc_b64 s[96:97]
    s_nop 0
Lpg5:
    buffer_load_dwordx4 v9, s[52:55], s41 offen offset:1024 lds
    buffer_load_dwordx4 v10, s[52:55], s41 offen offset:2048 lds
    buffer_load_dwordx4 v11, s[52:55], s41 offen offset:3072 lds
    s_sub_u32 s41, s33, s34
    s_add_u32 m0, s32, 98304
    s_add_u32 s33, s40, 262144
    buffer_load_dwordx4 v4, s[48:51], s40 offen offset:0 sc1 lds
    s_cmp_ge_u32 s33, s47
    s_cselect_b32 s34, 3670016, 0
    buffer_load_dwordx4 v5, s[48:51], s40 offen offset:1024 sc1 lds
    buffer_load_dwordx4 v6, s[48:51], s40 offen offset:2048 sc1 lds
    buffer_load_dwordx4 v7, s[48:51], s40 offen offset:3072 sc1 lds
    s_sub_u32 s40, s33, s34
    s_waitcnt vmcnt(28)
    s_barrier
    s_add_u32 m0, s32, 147456
    s_add_u32 s33, s41, 114688
    buffer_load_dwordx4 v8, s[52:55], s41 offen offset:0 lds
    s_cmp_ge_u32 s33, s45
    s_cselect_b32 s34, 1605632, 0
    buffer_load_dwordx4 v9, s[52:55], s41 offen offset:1024 lds
    buffer_load_dwordx4 v10, s[52:55], s41 offen offset:2048 lds
    buffer_load_dwordx4 v11, s[52:55], s41 offen offset:3072 lds
    s_sub_u32 s41, s33, s34
    s_add_u32 m0, s32, 106496
    s_add_u32 s33, s40, 262144
    buffer_load_dwordx4 v4, s[48:51], s40 offen offset:0 sc1 lds
    s_cmp_ge_u32 s33, s47
    s_cselect_b32 s34, 3670016, 0
    buffer_load_dwordx4 v5, s[48:51], s40 offen offset:1024 sc1 lds
    buffer_load_dwordx4 v6, s[48:51], s40 offen offset:2048 sc1 lds
    buffer_load_dwordx4 v7, s[48:51], s40 offen offset:3072 sc1 lds
    s_sub_u32 s40, s33, s34
    s_waitcnt vmcnt(28)
    s_barrier
    s_cmp_ge_u32 s43, s44
    s_cselect_b32 s35, 1605632, 0
    s_sub_u32 s43, s43, s35
    buffer_load_dwordx4 v[72:75], v12, s[60:63], s43 offen offset:0
    buffer_load_dwordx4 v[76:79], v13, s[60:63], s43 offen offset:1024
    buffer_load_dwordx4 v[80:83], v14, s[60:63], s43 offen offset:2048
    buffer_load_dwordx4 v[84:87], v15, s[60:63], s43 offen offset:3072
    s_add_u32 s43, s43, 114688
    s_waitcnt vmcnt(24)
    s_barrier
    s_add_u32 m0, s32, 114688
    s_add_u32 s33, s41, 114688
    buffer_load_dwordx4 v8, s[52:55], s41 offen offset:0 lds
    s_cmp_ge_u32 s33, s45
    s_cselect_b32 s34, 1605632, 0
    buffer_load_dwordx4 v9, s[52:55], s41 offen offset:1024 lds
    buffer_load_dwordx4 v10, s[52:55], s41 offen offset:2048 lds
    buffer_load_dwordx4 v11, s[52:55], s41 offen offset:3072 lds
    s_sub_u32 s41, s33, s34
    s_waitcnt vmcnt(20)
    s_barrier
    s_add_u32 m0, s32, 122880
    s_add_u32 s33, s41, 114688
    buffer_load_dwordx4 v8, s[52:55], s41 offen offset:0 lds
    s_cmp_ge_u32 s33, s45
    s_cselect_b32 s34, 1605632, 0
    buffer_load_dwordx4 v9, s[52:55], s41 offen offset:1024 lds
    buffer_load_dwordx4 v10, s[52:55], s41 offen offset:2048 lds
    buffer_load_dwordx4 v11, s[52:55], s41 offen offset:3072 lds
    s_sub_u32 s41, s33, s34
    s_waitcnt vmcnt(16)
    s_barrier
    s_add_u32 m0, s32, 131072
    s_add_u32 s33, s41, 114688
    buffer_load_dwordx4 v8, s[52:55], s41 offen offset:0 lds
    s_cmp_ge_u32 s33, s45
    s_cselect_b32 s34, 1605632, 0
    buffer_load_dwordx4 v9, s[52:55], s41 offen offset:1024 lds
    buffer_load_dwordx4 v10, s[52:55], s41 offen offset:2048 lds
    buffer_load_dwordx4 v11, s[52:55], s41 offen offset:3072 lds
    s_sub_u32 s41, s33, s34
    s_waitcnt vmcnt(8)
    s_barrier
    s_add_u32 s41, s41, 128
    s_add_u32 s45, s45, 128
    s_add_u32 m0, s32, 139264
    s_add_u32 s33, s41, 114688
    buffer_load_dwordx4 v8, s[52:55], s41 offen offset:0 lds
    s_cmp_ge_u32 s33, s45
    s_cselect_b32 s34, 1605632, 0
    buffer_load_dwordx4 v9, s[52:55], s41 offen offset:1024 lds
    buffer_load_dwordx4 v10, s[52:55], s41 offen offset:2048 lds
    buffer_load_dwordx4 v11, s[52:55], s41 offen offset:3072 lds
    s_sub_u32 s41, s33, s34
    s_waitcnt vmcnt(8)
    s_barrier
    s_add_u32 m0, s32, 147456
    s_add_u32 s33, s41, 114688
    buffer_load_dwordx4 v8, s[52:55], s41 offen offset:0 lds
    s_cmp_ge_u32 s33, s45
    s_cselect_b32 s34, 1605632, 0
    buffer_load_dwordx4 v9, s[52:55], s41 offen offset:1024 lds
    buffer_load_dwordx4 v10, s[52:55], s41 offen offset:2048 lds
    buffer_load_dwordx4 v11, s[52:55], s41 offen offset:3072 lds
    s_sub_u32 s41, s33, s34
    s_cmp_ge_u32 s43, s44
    s_cselect_b32 s35, 1605632, 0
    s_sub_u32 s43, s43, s35
    buffer_load_dwordx4 v[88:91], v12, s[60:63], s43 offen offset:0
    buffer_load_dwordx4 v[92:95], v13, s[60:63], s43 offen offset:1024
    buffer_load_dwordx4 v[96:99], v14, s[60:63], s43 offen offset:2048
    buffer_load_dwordx4 v[100:103], v15, s[60:63], s43 offen offset:3072
    s_add_u32 s43, s43, 114688
    s_waitcnt vmcnt(12)
    s_barrier
    s_add_u32 m0, s32, 114688
    s_add_u32 s33, s41, 114688
    buffer_load_dwordx4 v8, s[52:55], s41 offen offset:0 lds
    s_cmp_ge_u32 s33, s45
    s_cselect_b32 s34, 1605632, 0
    buffer_load_dwordx4 v9, s[52:55], s41 offen offset:1024 lds
    buffer_load_dwordx4 v10, s[52:55], s41 offen offset:2048 lds
    buffer_load_dwordx4 v11, s[52:55], s41 offen offset:3072 lds
    s_sub_u32 s41, s33, s34
    s_cmp_ge_u32 s43, s44
    s_cselect_b32 s35, 1605632, 0
    s_sub_u32 s43, s43, s35
    buffer_load_dwordx4 v[104:107], v12, s[60:63], s43 offen offset:0
    buffer_load_dwordx4 v[108:111], v13, s[60:63], s43 offen offset:1024
    buffer_load_dwordx4 v[112:115], v14, s[60:63], s43 offen offset:2048
    buffer_load_dwordx4 v[116:119], v15, s[60:63], s43 offen offset:3072
    s_add_u32 s43, s43, 114688
    s_waitcnt vmcnt(16)
    s_barrier
    s_add_u32 m0, s32, 122880
    s_add_u32 s33, s41, 114688
    buffer_load_dwordx4 v8, s[52:55], s41 offen offset:0 lds
    s_cmp_ge_u32 s33, s45
    s_cselect_b32 s34, 1605632, 0
    buffer_load_dwordx4 v9, s[52:55], s41 offen offset:1024 lds
    buffer_load_dwordx4 v10, s[52:55], s41 offen offset:2048 lds
    buffer_load_dwordx4 v11, s[52:55], s41 offen offset:3072 lds
    s_sub_u32 s41, s33, s34
    s_waitcnt vmcnt(16)
    s_barrier
    s_add_u32 m0, s32, 131072
    s_add_u32 s33, s41, 114688
    buffer_load_dwordx4 v8, s[52:55], s41 offen offset:0 lds
    s_cmp_ge_u32 s33, s45
    s_cselect_b32 s34, 1605632, 0
    buffer_load_dwordx4 v9, s[52:55], s41 offen offset:1024 lds
    buffer_load_dwordx4 v10, s[52:55], s41 offen offset:2048 lds
    buffer_load_dwordx4 v11, s[52:55], s41 offen offset:3072 lds
    s_sub_u32 s41, s33, s34
    s_add_u32 m0, s32, 155648
    s_add_u32 s33, s41, 114688
    buffer_load_dwordx4 v8, s[52:55], s41 offen offset:0 lds
    s_cmp_ge_u32 s33, s45
    s_cselect_b32 s34, 1605632, 0
    buffer_load_dwordx4 v9, s[52:55], s41 offen offset:1024 lds
    buffer_load_dwordx4 v10, s[52:55], s41 offen offset:2048 lds
    buffer_load_dwordx4 v11, s[52:55], s41 offen offset:3072 lds
    s_sub_u32 s41, s33, s34
    s_waitcnt vmcnt(16)
    s_barrier
    s_add_u32 m0, s32, 139264
    s_add_u32 s33, s41, 114688
    buffer_load_dwordx4 v8, s[52:55], s41 offen offset:0 lds
    s_cmp_ge_u32 s33, s45
    s_cselect_b32 s34, 1605632, 0
    buffer_load_dwordx4 v9, s[52:55], s41 offen offset:1024 lds
    buffer_load_dwordx4 v10, s[52:55], s41 offen offset:2048 lds
    buffer_load_dwordx4 v11, s[52:55], s41 offen offset:3072 lds
    s_sub_u32 s41, s33, s34
    s_add_u32 m0, s32, 0
    s_add_u32 s33, s42, 114688
    buffer_load_dwordx4 v12, s[60:63], s42 offen offset:0 lds
    s_cmp_ge_u32 s33, s46
    s_cselect_b32 s34, 1605632, 0
    buffer_load_dwordx4 v13, s[60:63], s42 offen offset:1024 lds
    buffer_load_dwordx4 v14, s[60:63], s42 offen offset:2048 lds
    buffer_load_dwordx4 v15, s[60:63], s42 offen offset:3072 lds
    s_sub_u32 s42, s33, s34
    s_waitcnt vmcnt(16)
    s_barrier
    s_add_u32 m0, s32, 147456
    s_add_u32 s33, s41, 114688
    buffer_load_dwordx4 v8, s[52:55], s41 offen offset:0 lds
    s_cmp_ge_u32 s33, s45
    s_cselect_b32 s34, 1605632, 0
    buffer_load_dwordx4 v9, s[52:55], s41 offen offset:1024 lds
    buffer_load_dwordx4 v10, s[52:55], s41 offen offset:2048 lds
    buffer_load_dwordx4 v11, s[52:55], s41 offen offset:3072 lds
    s_sub_u32 s41, s33, s34
    s_add_u32 m0, s32, 8192
    s_add_u32 s33, s42, 114688
    buffer_load_dwordx4 v12, s[60:63], s42 offen offset:0 lds
    s_cmp_ge_u32 s33, s46
    s_cselect_b32 s34, 1605632, 0
    buffer_load_dwordx4 v13, s[60:63], s42 offen offset:1024 lds
    buffer_load_dwordx4 v14, s[60:63], s42 offen offset:2048 lds
    buffer_load_dwordx4 v15, s[60:63], s42 offen offset:3072 lds
    s_sub_u32 s42, s33, s34
    s_waitcnt vmcnt(20)
    s_barrier
    s_add_u32 m0, s32, 114688
    s_add_u32 s33, s41, 114688
    buffer_load_dwordx4 v8, s[52:55], s41 offen offset:0 lds
    s_cmp_ge_u32 s33, s45
    s_cselect_b32 s34, 1605632, 0
    buffer_load_dwordx4 v9, s[52:55], s41 offen offset:1024 lds
    buffer_load_dwordx4 v10, s[52:55], s41 offen offset:2048 lds
    buffer_load_dwordx4 v11, s[52:55], s41 offen offset:3072 lds
    s_sub_u32 s41, s33, s34
    s_add_u32 m0, s32, 16384
    s_add_u32 s33, s42, 114688
    buffer_load_dwordx4 v12, s[60:63], s42 offen offset:0 lds
    s_cmp_ge_u32 s33, s46
    s_cselect_b32 s34, 1605632, 0
    buffer_load_dwordx4 v13, s[60:63], s42 offen offset:1024 lds
    buffer_load_dwordx4 v14, s[60:63], s42 offen offset:2048 lds
    buffer_load_dwordx4 v15, s[60:63], s42 offen offset:3072 lds
    s_sub_u32 s42, s33, s34
    s_waitcnt vmcnt(24)
    s_barrier
    s_add_u32 m0, s32, 122880
    s_add_u32 s33, s41, 114688
    buffer_load_dwordx4 v8, s[52:55], s41 offen offset:0 lds
    s_cmp_ge_u32 s33, s45
    s_cselect_b32 s34, 1605632, 0
    buffer_load_dwordx4 v9, s[52:55], s41 offen offset:1024 lds
    buffer_load_dwordx4 v10, s[52:55], s41 offen offset:2048 lds
    buffer_load_dwordx4 v11, s[52:55], s41 offen offset:3072 lds
    s_sub_u32 s41, s33, s34
    s_add_u32 m0, s32, 24576
    s_add_u32 s33, s42, 114688
    buffer_load_dwordx4 v12, s[60:63], s42 offen offset:0 lds
    s_cmp_ge_u32 s33, s46
    s_cselect_b32 s34, 1605632, 0
    buffer_load_dwordx4 v13, s[60:63], s42 offen offset:1024 lds
    buffer_load_dwordx4 v14, s[60:63], s42 offen offset:2048 lds
    buffer_load_dwordx4 v15, s[60:63], s42 offen offset:3072 lds
    s_sub_u32 s42, s33, s34
    s_waitcnt vmcnt(28)
    s_barrier
    s_add_u32 m0, s32, 131072
    s_add_u32 s33, s41, 114688
    buffer_load_dwordx4 v8, s[52:55], s41 offen offset:0 lds
    s_cmp_ge_u32 s33, s45
    s_cselect_b32 s34, 1605632, 0
    buffer_load_dwordx4 v9, s[52:55], s41 offen offset:1024 lds
    buffer_load_dwordx4 v10, s[52:55], s41 offen offset:2048 lds
    buffer_load_dwordx4 v11, s[52:55], s41 offen offset:3072 lds
    s_sub_u32 s41, s33, s34
    s_add_u32 m0, s32, 32768
    s_add_u32 s33, s42, 114688
    buffer_load_dwordx4 v12, s[60:63], s42 offen offset:0 lds
    s_cmp_ge_u32 s33, s46
    s_cselect_b32 s34, 1605632, 0
    buffer_load_dwordx4 v13, s[60:63], s42 offen offset:1024 lds
    buffer_load_dwordx4 v14, s[60:63], s42 offen offset:2048 lds
    buffer_load_dwordx4 v15, s[60:63], s42 offen offset:3072 lds
    s_sub_u32 s42, s33, s34
    s_waitcnt vmcnt(28)
    s_barrier
    s_add_u32 m0, s32, 155648
    s_add_u32 s33, s41, 114688
    buffer_load_dwordx4 v8, s[52:55], s41 offen offset:0 lds
    s_cmp_ge_u32 s33, s45
    s_cselect_b32 s34, 1605632, 0
    buffer_load_dwordx4 v9, s[52:55], s41 offen offset:1024 lds
    buffer_load_dwordx4 v10, s[52:55], s41 offen offset:2048 lds
    buffer_load_dwordx4 v11, s[52:55], s41 offen offset:3072 lds
    s_sub_u32 s41, s33, s34
    s_add_u32 m0, s32, 40960
    s_add_u32 s33, s42, 114688
    buffer_load_dwordx4 v12, s[60:63], s42 offen offset:0 lds
    s_cmp_ge_u32 s33, s46
    s_cselect_b32 s34, 1605632, 0
    buffer_load_dwordx4 v13, s[60:63], s42 offen offset:1024 lds
    buffer_load_dwordx4 v14, s[60:63], s42 offen offset:2048 lds
    buffer_load_dwordx4 v15, s[60:63], s42 offen offset:3072 lds
    s_sub_u32 s42, s33, s34
    s_waitcnt vmcnt(28)
    s_barrier
    s_add_u32 m0, s32, 139264
    s_add_u32 s33, s41, 114688
    buffer_load_dwordx4 v8, s[52:55], s41 offen offset:0 lds
    s_cmp_ge_u32 s33, s45
    s_cselect_b32 s34, 1605632, 0
    buffer_load_dwordx4 v9, s[52:55], s41 offen offset:1024 lds
    buffer_load_dwordx4 v10, s[52:55], s41 offen offset:2048 lds
    buffer_load_dwordx4 v11, s[52:55], s41 offen offset:3072 lds
    s_sub_u32 s41, s33, s34
    s_add_u32 m0, s32, 49152
    s_add_u32 s33, s42, 114688
    buffer_load_dwordx4 v12, s[60:63], s42 offen offset:0 lds
    s_cmp_ge_u32 s33, s46
    s_cselect_b32 s34, 1605632, 0
    buffer_load_dwordx4 v13, s[60:63], s42 offen offset:1024 lds
    buffer_load_dwordx4 v14, s[60:63], s42 offen offset:2048 lds
    buffer_load_dwordx4 v15, s[60:63], s42 offen offset:3072 lds
    s_sub_u32 s42, s33, s34
    s_waitcnt vmcnt(28)
    s_barrier
    s_add_u32 m0, s32, 147456
    s_add_u32 s33, s41, 114688
    buffer_load_dwordx4 v8, s[52:55], s41 offen offset:0 lds
    s_cmp_ge_u32 s33, s45
    s_cselect_b32 s34, 1605632, 0
    buffer_load_dwordx4 v9, s[52:55], s41 offen offset:1024 lds
    buffer_load_dwordx4 v10, s[52:55], s41 offen offset:2048 lds
    buffer_load_dwordx4 v11, s[52:55], s41 offen offset:3072 lds
    s_sub_u32 s41, s33, s34
    s_add_u32 m0, s32, 57344
    s_add_u32 s33, s42, 114688
    buffer_load_dwordx4 v12, s[60:63], s42 offen offset:0 lds
    s_cmp_ge_u32 s33, s46
    s_cselect_b32 s34, 1605632, 0
    buffer_load_dwordx4 v13, s[60:63], s42 offen offset:1024 lds
    buffer_load_dwordx4 v14, s[60:63], s42 offen offset:2048 lds
    buffer_load_dwordx4 v15, s[60:63], s42 offen offset:3072 lds
    s_sub_u32 s42, s33, s34
    s_waitcnt vmcnt(28)
    s_barrier
    s_add_u32 m0, s32, 65536
    s_add_u32 s33, s42, 114688
    buffer_load_dwordx4 v12, s[60:63], s42 offen offset:0 lds
    s_cmp_ge_u32 s33, s46
    s_cselect_b32 s34, 1605632, 0
    buffer_load_dwordx4 v13, s[60:63], s42 offen offset:1024 lds
    buffer_load_dwordx4 v14, s[60:63], s42 offen offset:2048 lds
    buffer_load_dwordx4 v15, s[60:63], s42 offen offset:3072 lds
    s_sub_u32 s42, s33, s34
    s_add_u32 m0, s32, 114688
    s_add_u32 s33, s42, 114688
    buffer_load_dwordx4 v12, s[60:63], s42 offen offset:0 lds
    s_cmp_ge_u32 s33, s46
    s_cselect_b32 s34, 1605632, 0
    buffer_load_dwordx4 v13, s[60:63], s42 offen offset:1024 lds
    buffer_load_dwordx4 v14, s[60:63], s42 offen offset:2048 lds
    buffer_load_dwordx4 v15, s[60:63], s42 offen offset:3072 lds
    s_sub_u32 s42, s33, s34
    s_waitcnt vmcnt(28)
    s_barrier
    s_add_u32 m0, s32, 73728
    s_add_u32 s33, s42, 114688
    buffer_load_dwordx4 v12, s[60:63], s42 offen offset:0 lds
    s_cmp_ge_u32 s33, s46
    s_cselect_b32 s34, 1605632, 0
    buffer_load_dwordx4 v13, s[60:63], s42 offen offset:1024 lds
    buffer_load_dwordx4 v14, s[60:63], s42 offen offset:2048 lds
    buffer_load_dwordx4 v15, s[60:63], s42 offen offset:3072 lds
    s_sub_u32 s42, s33, s34
    s_add_u32 m0, s32, 122880
    s_add_u32 s33, s42, 114688
    buffer_load_dwordx4 v12, s[60:63], s42 offen offset:0 lds
    s_cmp_ge_u32 s33, s46
    s_cselect_b32 s34, 1605632, 0
    buffer_load_dwordx4 v13, s[60:63], s42 offen offset:1024 lds
    buffer_load_dwordx4 v14, s[60:63], s42 offen offset:2048 lds
    buffer_load_dwordx4 v15, s[60:63], s42 offen offset:3072 lds
    s_sub_u32 s42, s33, s34
    s_waitcnt vmcnt(28)
    s_barrier
    s_add_u32 m0, s32, 81920
    s_add_u32 s33, s42, 114688
    buffer_load_dwordx4 v12, s[60:63], s42 offen offset:0 lds
    s_cmp_ge_u32 s33, s46
    s_cselect_b32 s34, 1605632, 0
    buffer_load_dwordx4 v13, s[60:63], s42 offen offset:1024 lds
    buffer_load_dwordx4 v14, s[60:63], s42 offen offset:2048 lds
    buffer_load_dwordx4 v15, s[60:63], s42 offen offset:3072 lds
    s_sub_u32 s42, s33, s34
    s_add_u32 m0, s32, 131072
    s_add_u32 s33, s42, 114688
    buffer_load_dwordx4 v12, s[60:63], s42 offen offset:0 lds
    s_cmp_ge_u32 s33, s46
    s_cselect_b32 s34, 1605632, 0
    buffer_load_dwordx4 v13, s[60:63], s42 offen offset:1024 lds
    buffer_load_dwordx4 v14, s[60:63], s42 offen offset:2048 lds
    buffer_load_dwordx4 v15, s[60:63], s42 offen offset:3072 lds
    s_sub_u32 s42, s33, s34
    s_waitcnt vmcnt(28)
    s_barrier
    s_barrier
    s_waitcnt vmcnt(0)
    s_barrier
    s_barrier
    ds_write_b128 v17, v[24:27] offset:24576
    ds_write_b128 v17, v[28:31] offset:25600
    ds_write_b128 v17, v[32:35] offset:26624
    ds_write_b128 v17, v[36:39] offset:27648
    ds_write_b128 v18, v[40:43] offset:24576
    ds_write_b128 v18, v[44:47] offset:25600
    ds_write_b128 v18, v[48:51] offset:26624
    ds_write_b128 v18, v[52:55] offset:27648
    ds_write_b128 v17, v[56:59] offset:32768
    ds_write_b128 v17, v[60:63] offset:33792
    ds_write_b128 v17, v[64:67] offset:34816
    ds_write_b128 v17, v[68:71] offset:35840
    s_barrier
    s_nop 0
    ds_write_b128 v18, v[72:75] offset:8192
    ds_write_b128 v18, v[76:79] offset:9216
    ds_write_b128 v18, v[80:83] offset:10240
    ds_write_b128 v18, v[84:87] offset:11264
    ds_write_b128 v17, v[88:91] offset:40960
    ds_write_b128 v17, v[92:95] offset:41984
    ds_write_b128 v17, v[96:99] offset:43008
    ds_write_b128 v17, v[100:103] offset:44032
    ds_write_b128 v18, v[104:107] offset:16384
    ds_write_b128 v18, v[108:111] offset:17408
    ds_write_b128 v18, v[112:115] offset:18432
    ds_write_b128 v18, v[116:119] offset:19456
    s_waitcnt lgkmcnt(0)
    s_endpgm
hold_9t:
    s_branch hold_9
.p2align 3
auxs_7:
    s_setprio 3
    s_mov_b32 s42, 0x3f803f80
    v_and_b32 v4, 56, v1
    s_lshl_b32 s46, s47, 6
    v_add_u32 v4, s46, v4
    v_mov_b32 v2, 148480
    s_waitcnt lgkmcnt(0)
    s_add_u32 s57, s56, 1
    s_and_b32 s57, s57, 0xffff
    s_or_b32 s57, s57, 0x7f810000
    s_mov_b32 s45, 0
    s_waitcnt vmcnt(6)
    v_dot2_f32_bf16 v90, v16, s42, 0
    v_dot2_f32_bf16 v92, v16, v16, 0
    v_dot2_f32_bf16 v91, v17, s42, 0
    v_dot2_f32_bf16 v93, v17, v17, 0
    v_dot2_f32_bf16 v90, v18, s42, v90
    v_dot2_f32_bf16 v92, v18, v18, v92
    v_dot2_f32_bf16 v91, v19, s42, v91
    v_dot2_f32_bf16 v93, v19, v19, v93
    s_waitcnt vmcnt(5)
    s_nop 0
    v_dot2_f32_bf16 v90, v20, s42, v90
    v_dot2_f32_bf16 v92, v20, v20, v92
    v_dot2_f32_bf16 v91, v21, s42, v91
    v_dot2_f32_bf16 v93, v21, v21, v93
    v_dot2_f32_bf16 v90, v22, s42, v90
    v_dot2_f32_bf16 v92, v22, v22, v92
    v_dot2_f32_bf16 v91, v23, s42, v91
    v_dot2_f32_bf16 v93, v23, v23, v93
    s_waitcnt vmcnt(4)
    s_nop 0
    v_dot2_f32_bf16 v90, v24, s42, v90
    v_dot2_f32_bf16 v92, v24, v24, v92
    v_dot2_f32_bf16 v91, v25, s42, v91
    v_dot2_f32_bf16 v93, v25, v25, v93
    v_dot2_f32_bf16 v90, v26, s42, v90
    v_dot2_f32_bf16 v92, v26, v26, v92
    v_dot2_f32_bf16 v91, v27, s42, v91
    v_dot2_f32_bf16 v93, v27, v27, v93
    s_waitcnt vmcnt(3)
    s_nop 0
    v_dot2_f32_bf16 v90, v28, s42, v90
    v_dot2_f32_bf16 v92, v28, v28, v92
    v_dot2_f32_bf16 v91, v29, s42, v91
    v_dot2_f32_bf16 v93, v29, v29, v93
    v_dot2_f32_bf16 v90, v30, s42, v90
    v_dot2_f32_bf16 v92, v30, v30, v92
    v_dot2_f32_bf16 v91, v31, s42, v91
    v_dot2_f32_bf16 v93, v31, v31, v93
    s_waitcnt vmcnt(2)
    s_nop 0
    v_dot2_f32_bf16 v90, v32, s42, v90
    v_dot2_f32_bf16 v92, v32, v32, v92
    v_dot2_f32_bf16 v91, v33, s42, v91
    v_dot2_f32_bf16 v93, v33, v33, v93
    v_dot2_f32_bf16 v90, v34, s42, v90
    v_dot2_f32_bf16 v92, v34, v34, v92
    v_dot2_f32_bf16 v91, v35, s42, v91
    v_dot2_f32_bf16 v93, v35, v35, v93
    s_waitcnt vmcnt(1)
    s_nop 0
    v_dot2_f32_bf16 v90, v36, s42, v90
    v_dot2_f32_bf16 v92, v36, v36, v92
    v_dot2_f32_bf16 v91, v37, s42, v91
    v_dot2_f32_bf16 v93, v37, v37, v93
    v_dot2_f32_bf16 v90, v38, s42, v90
    v_dot2_f32_bf16 v92, v38, v38, v92
    v_dot2_f32_bf16 v91, v39, s42, v91
    v_dot2_f32_bf16 v93, v39, v39, v93
    s_waitcnt vmcnt(0)
    s_nop 0
    ds_read_b64 v[6:7], v2
    v_dot2_f32_bf16 v90, v40, s42, v90
    v_dot2_f32_bf16 v92, v40, v40, v92
    v_dot2_f32_bf16 v91, v41, s42, v91
    v_dot2_f32_bf16 v93, v41, v41, v93
    v_dot2_f32_bf16 v90, v42, s42, v90
    v_dot2_f32_bf16 v92, v42, v42, v92
    v_dot2_f32_bf16 v91, v43, s42, v91
    v_dot2_f32_bf16 v93, v43, v43, v93
    s_nop 1
    v_add_f32 v90, v90, v91
    v_add_f32 v92, v92, v93
    s_nop 0
    v_add_f32_dpp v90, v90, v90 quad_perm:[1,0,3,2] row_mask:0xf bank_mask:0xf
    v_add_f32_dpp v92, v92, v92 quad_perm:[1,0,3,2] row_mask:0xf bank_mask:0xf
    s_nop 0
    v_add_f32_dpp v90, v90, v90 quad_perm:[2,3,0,1] row_mask:0xf bank_mask:0xf
    v_add_f32_dpp v92, v92, v92 quad_perm:[2,3,0,1] row_mask:0xf bank_mask:0xf
    s_nop 0
    v_add_f32_dpp v90, v90, v90 row_half_mirror row_mask:0xf bank_mask:0xf
    v_add_f32_dpp v92, v92, v92 row_half_mirror row_mask:0xf bank_mask:0xf
    v_mul_f32 v90, 0x3b124925, v90
    v_mul_f32 v92, 0x3b124925, v92
    v_fma_f32 v92, -v90, v90, v92
    v_max_f32_e64 v92, 0, v92
    v_cvt_pk_bf16_f32 v92, v92, v92
    v_and_b32_e64 v92, s43, v92
    v_add_f32 v92, 0x3727c5ac, v92
    v_cvt_pk_bf16_f32 v92, v92, v92
    v_and_b32 v92, s43, v92
    v_sqrt_f32 v92, v92
    v_mov_b32_e64 v91, s57
    v_cvt_pk_bf16_f32 v90, v90, v92
    s_cmp_ge_u32 s2, 224
    s_cbranch_scc1 Ltg2
Ltg:
    s_waitcnt lgkmcnt(0)
    v_xor_b32 v6, s57, v6
    v_xor_b32 v7, s57, v7
    v_or_b32 v6, v6, v7
    v_cmp_ne_u32_e64 vcc, 0, v6
    s_cbranch_vccz Ltg2
    ds_read_b64 v[6:7], v2
    s_add_u32 s45, s45, 1
    s_cmp_lt_u32 s45, 262144
    s_cbranch_scc1 Ltg
Ltg2:
    s_mov_b32 exec_lo, 0x01010101
    s_mov_b32 exec_hi, 0x01010101
    global_store_dwordx2 v4, v[90:91], s[30:31] sc0 sc1
    s_mov_b64 exec, -1
hold_9:
    s_setprio 0
    s_barrier
    s_cmp_ge_u32 s2, 224
    s_cbranch_scc1 end_1
    s_and_b32 s37, s2, 7
    s_lshr_b32 s38, s2, 3
    s_and_b32 s40, s38, 3
    s_lshr_b32 s39, s37, 1
    s_lshl_b32 s39, s39, 2
    s_add_u32 s39, s39, s40
    s_and_b32 s34, s37, 1
    s_lshr_b32 s35, s38, 2
    s_mul_i32 s38, s34, 7
    s_add_u32 s38, s38, s35
    s_mul_i32 s33, s40, 3
    s_lshl_b32 s37, s35, 1
    s_add_u32 s33, s33, s37
    s_cmp_ge_u32 s33, 14
    s_cselect_b32 s37, 14, 0
    s_sub_u32 s33, s33, s37
    v_lshrrev_b32 v6, 3, v1
    v_and_b32 v7, 7, v1
    v_and_b32 v5, 2, v6
    v_lshlrev_b32 v4, 1, v5
    v_xor_b32_e64 v4, v4, v7
    v_mul_u32_u24 v3, 896, v6
    v_lshl_add_u32 v12, v4, 4, v3
    v_add_u32 v13, 6144, v12
    v_add_u32 v14, 12288, v12
    v_add_u32 v15, 18432, v12
    s_lshl_b32 s46, s35, 7
    s_mul_i32 s32, s36, 28672
    s_add_u32 s46, s46, s32
    s_mul_i32 s42, s33, 114688
    s_add_u32 s42, s42, s46
    s_add_u32 s46, s46, 1605632
    s_lshl_b32 s32, s36, 12
    v_lshl_add_u32 v16, v1, 4, s32
    v_add_u32 v17, 0x10000, v16
    v_add_u32 v18, 0x20000, v16
    s_lshl_b32 s59, s39, 11
    s_lshl_b32 s58, s34, 10
    s_add_u32 s59, s59, s58
    s_lshl_b32 s58, s36, 8
    s_add_u32 s59, s59, s58
    s_add_u32 s59, s59, 14680064
    s_lshl_b32 s43, s39, 1
    s_add_u32 s43, s43, s34
    s_mul_i32 s43, s43, 229376
    s_lshl_b32 s44, s36, 11
    s_add_u32 s43, s43, s44
    s_add_u32 s43, s43, 2101248
    v_bfe_u32 v3, v1, 3, 1
    v_add_u32 v3, s33, v3
    v_cmp_gt_u32 vcc, 14, v3
    s_nop 1
    v_cndmask_b32 v3, 0, v3, vcc
    v_lshlrev_b32 v3, 13, v3
    v_bfe_u32 v4, v1, 4, 1
    v_mul_u32_u24 v4, 114688, v4
    v_add3_u32 v3, v3, v4, s43
    v_lshl_add_u32 v19, v7, 7, v3
    s_mov_b32 s60, s24
    s_mov_b32 s61, s25
    s_mov_b32 s62, 1605632
    s_mov_b32 s63, 0x20000
    v_lshrrev_b32 v6, 4, v1
    v_and_b32 v7, 15, v1
    v_lshlrev_b32 v5, 2, v6
    v_xor_b32 v5, v5, v7
    v_lshlrev_b32 v5, 4, v5
    v_and_b32 v7, 1, v6
    v_lshl_add_u32 v5, v7, 12, v5
    v_lshrrev_b32_e64 v6, 1, v6
    v_lshl_add_u32 v8, v6, 14, v5
    v_add_u32 v9, 31744, v8
    v_add_u32 v10, 63488, v8
    v_add_u32 v11, 95232, v8
    s_lshl_b32 s41, s39, 8
    s_lshl_b32 s43, s36, 17
    s_add_u32 s41, s41, s43
    s_lshl_b32 s40, s38, 18
    s_add_u32 s40, s40, s41
    s_add_u32 s41, s41, 3670016
    s_mov_b32 s56, 0x7f810000
    s_mov_b32 s47, s40
    s_branch Lpg6
.p2align 12
Lpw6:
    s_setpc_b64 s[96:97]
    s_nop 0
Lpg6:
    s_add_u32 s48, s30, 10489856
    s_addc_u32 s49, s31, 0
    s_mov_b32 s50, 3670016
    s_mov_b32 s51, 0x20000
    s_lshl_b32 s43, s2, 1
    s_add_u32 s43, s43, s36
    s_mul_i32 s43, s43, 3584
    v_min_u32 v2, 27, v1
    v_lshl_add_u32 v2, v2, 7, s43
    s_barrier
    s_barrier
    s_mul_i32 s43, s39, 458752
    s_add_u32 s43, s43, 2097152
    v_and_b32 v2, 7, v1
    v_min_u32 v2, 6, v2
    v_lshl_add_u32 v2, v2, 16, s43
    global_load_dword v36, v2, s[30:31]
    s_and_b32 s44, s2, 1
    s_lshl_b32 s43, s39, 1
    s_add_u32 s43, s43, s44
    s_mul_i32 s43, s43, 57344
    s_lshr_b32 s44, s2, 5
    s_lshl_b32 s44, s44, 7
    s_add_u32 s43, s43, s44
    v_and_b32_e64 v2, 1, v1
    v_mul_u32_u24 v2, 56448, v2
    v_add_u32_e64 v2, s43, v2
    global_load_dword v37, v2, s[26:27]
    s_mov_b32 s43, 14942208
    s_load_dword s57, s[30:31], s43
    s_add_u32 s43, s42, 745472
    s_add_u32 s44, s46, 57344
    s_cmp_ge_u32 s43, s44
    s_cselect_b32 s34, 1605632, 0
    s_sub_u32 s43, s43, s34
    buffer_load_dwordx4 v[40:43], v12, s[60:63], s43 offen offset:0
    buffer_load_dwordx4 v[44:47], v13, s[60:63], s43 offen offset:1024
    buffer_load_dwordx4 v[48:51], v14, s[60:63], s43 offen offset:2048
    buffer_load_dwordx4 v[52:55], v15, s[60:63], s43 offen offset:3072
    s_add_u32 s43, s43, 114688
    s_cmp_ge_u32 s43, s44
    s_cselect_b32 s34, 1605632, 0
    s_sub_u32 s43, s43, s34
    buffer_load_dwordx4 v[56:59], v12, s[60:63], s43 offen offset:0
    buffer_load_dwordx4 v[60:63], v13, s[60:63], s43 offen offset:1024
    buffer_load_dwordx4 v[64:67], v14, s[60:63], s43 offen offset:2048
    buffer_load_dwordx4 v[68:71], v15, s[60:63], s43 offen offset:3072
    s_add_u32 s43, s43, 114688
    s_cmp_ge_u32 s43, s44
    s_cselect_b32 s34, 1605632, 0
    s_sub_u32 s43, s43, s34
    buffer_load_dwordx4 v[72:75], v12, s[60:63], s43 offen offset:0
    buffer_load_dwordx4 v[76:79], v13, s[60:63], s43 offen offset:1024
    buffer_load_dwordx4 v[80:83], v14, s[60:63], s43 offen offset:2048
    buffer_load_dwordx4 v[84:87], v15, s[60:63], s43 offen offset:3072
    s_add_u32 s43, s43, 114688
    s_cmp_ge_u32 s43, s44
    s_cselect_b32 s34, 1605632, 0
    s_sub_u32 s43, s43, s34
    buffer_load_dwordx4 v[88:91], v12, s[60:63], s43 offen offset:0
    buffer_load_dwordx4 v[92:95], v13, s[60:63], s43 offen offset:1024
    buffer_load_dwordx4 v[96:99], v14, s[60:63], s43 offen offset:2048
    buffer_load_dwordx4 v[100:103], v15, s[60:63], s43 offen offset:3072
    s_add_u32 s43, s43, 114688
    s_barrier
    s_barrier
    s_setprio 3
    s_add_u32 m0, s32, 0
    s_add_u32 s33, s40, 262144
    buffer_load_dwordx4 v8, s[48:51], s40 offen offset:0 sc1 lds
    s_cmp_ge_u32 s33, s41
    s_cselect_b32 s34, 3670016, 0
    buffer_load_dwordx4 v9, s[48:51], s40 offen offset:1024 sc1 lds
    buffer_load_dwordx4 v10, s[48:51], s40 offen offset:2048 sc1 lds
    buffer_load_dwordx4 v11, s[48:51], s40 offen offset:3072 sc1 lds
    s_sub_u32 s40, s33, s34
    s_waitcnt vmcnt(0)
    ds_read_b128 v[20:23], v16 offset:0
    ds_read_b128 v[24:27], v16 offset:1024
    ds_read_b128 v[28:31], v16 offset:2048
    ds_read_b128 v[32:35], v16 offset:3072
    s_mov_b32 s45, 0
hv_36:
    s_waitcnt lgkmcnt(0)
    v_max3_i32 v2, v21, v23, v25
    v_max3_i32 v3, v27, v29, v31
    v_max3_i32 v2, v2, v33, v35
    v_max_i32 v2, v2, v3
    v_cmp_le_i32 vcc, s56, v2
    s_cbranch_vccnz hrp_38f
hok_37:
    s_add_u32 s47, s47, 262144
    s_cmp_ge_u32 s47, s41
    s_cselect_b32 s34, 3670016, 0
    s_sub_u32 s47, s47, s34
    s_add_u32 m0, s32, 8192
    s_add_u32 s33, s40, 262144
    buffer_load_dwordx4 v8, s[48:51], s40 offen offset:0 sc1 lds
    s_cmp_ge_u32 s33, s41
    s_cselect_b32 s34, 3670016, 0
    buffer_load_dwordx4 v9, s[48:51], s40 offen offset:1024 sc1 lds
    buffer_load_dwordx4 v10, s[48:51], s40 offen offset:2048 sc1 lds
    buffer_load_dwordx4 v11, s[48:51], s40 offen offset:3072 sc1 lds
    s_sub_u32 s40, s33, s34
    s_add_u32 m0, s32, 16384
    s_add_u32 s33, s40, 262144
    buffer_load_dwordx4 v8, s[48:51], s40 offen offset:0 sc1 lds
    s_cmp_ge_u32 s33, s41
    s_cselect_b32 s34, 3670016, 0
    buffer_load_dwordx4 v9, s[48:51], s40 offen offset:1024 sc1 lds
    buffer_load_dwordx4 v10, s[48:51], s40 offen offset:2048 sc1 lds
    buffer_load_dwordx4 v11, s[48:51], s40 offen offset:3072 sc1 lds
    s_sub_u32 s40, s33, s34
    s_add_u32 m0, s32, 24576
    s_add_u32 s33, s40, 262144
    buffer_load_dwordx4 v8, s[48:51], s40 offen offset:0 sc1 lds
    s_cmp_ge_u32 s33, s41
    s_cselect_b32 s34, 3670016, 0
    buffer_load_dwordx4 v9, s[48:51], s40 offen offset:1024 sc1 lds
    buffer_load_dwordx4 v10, s[48:51], s40 offen offset:2048 sc1 lds
    buffer_load_dwordx4 v11, s[48:51], s40 offen offset:3072 sc1 lds
    s_sub_u32 s40, s33, s34
    s_add_u32 m0, s32, 32768
    s_add_u32 s33, s40, 262144
    buffer_load_dwordx4 v8, s[48:51], s40 offen offset:0 sc1 lds
    s_cmp_ge_u32 s33, s41
    s_cselect_b32 s34, 3670016, 0
    buffer_load_dwordx4 v9, s[48:51], s40 offen offset:1024 sc1 lds
    buffer_load_dwordx4 v10, s[48:51], s40 offen offset:2048 sc1 lds
    buffer_load_dwordx4 v11, s[48:51], s40 offen offset:3072 sc1 lds
    s_sub_u32 s40, s33, s34
    s_waitcnt vmcnt(12)
    ds_read_b128 v[20:23], v16 offset:8192
    ds_read_b128 v[24:27], v16 offset:9216
    ds_read_b128 v[28:31], v16 offset:10240
    ds_read_b128 v[32:35], v16 offset:11264
    s_barrier
    s_mov_b32 s45, 0
hv_39:
    s_waitcnt lgkmcnt(0)
    v_max3_i32 v2, v21, v23, v25
    v_max3_i32 v3, v27, v29, v31
    v_max3_i32 v2, v2, v33, v35
    v_max_i32 v2, v2, v3
    v_cmp_le_i32_e64 vcc, s56, v2
    s_cbranch_vccnz hrp_41f
hok_40:
    s_add_u32 s47, s47, 262144
    s_cmp_ge_u32 s47, s41
    s_cselect_b32 s34, 3670016, 0
    s_sub_u32 s47, s47, s34
    s_waitcnt vmcnt(8)
    ds_read_b128 v[20:23], v16 offset:16384
    ds_read_b128 v[24:27], v16 offset:17408
    ds_read_b128 v[28:31], v16 offset:18432
    ds_read_b128 v[32:35], v16 offset:19456
    s_barrier
    s_mov_b32 s45, 0
hv_42:
    s_waitcnt lgkmcnt(0)
    v_max3_i32 v2, v21, v23, v25
    v_max3_i32 v3, v27, v29, v31
    v_max3_i32 v2, v2, v33, v35
    v_max_i32 v2, v2, v3
    v_cmp_le_i32_e64 vcc, s56, v2
    s_cbranch_vccnz hrp_44f
hok_43:
    s_add_u32 s47, s47, 262144
    s_cmp_ge_u32 s47, s41
    s_cselect_b32 s34, 3670016, 0
    s_sub_u32 s47, s47, s34
    s_waitcnt vmcnt(4)
    ds_read_b128 v[20:23], v16 offset:24576
    ds_read_b128 v[24:27], v16 offset:25600
    ds_read_b128 v[28:31], v16 offset:26624
    ds_read_b128 v[32:35], v16 offset:27648
    s_barrier
    s_mov_b32 s45, 0
hv_45:
    s_waitcnt lgkmcnt(0)
    v_max3_i32 v2, v21, v23, v25
    v_max3_i32 v3, v27, v29, v31
    v_max3_i32 v2, v2, v33, v35
    v_max_i32 v2, v2, v3
    v_cmp_le_i32_e64 vcc, s56, v2
    s_cbranch_vccnz hrp_47f
hok_46:
    s_add_u32 s47, s47, 262144
    s_cmp_ge_u32 s47, s41
    s_cselect_b32 s34, 3670016, 0
    s_sub_u32 s47, s47, s34
    s_waitcnt vmcnt(0)
    ds_read_b128 v[20:23], v16 offset:32768
    ds_read_b128 v[24:27], v16 offset:33792
    ds_read_b128 v[28:31], v16 offset:34816
    ds_read_b128 v[32:35], v16 offset:35840
    s_barrier
    s_mov_b32 s45, 0
hv_48:
    s_waitcnt lgkmcnt(0)
    v_max3_i32 v2, v21, v23, v25
    v_max3_i32 v3, v27, v29, v31
    v_max3_i32 v2, v2, v33, v35
    v_max_i32 v2, v2, v3
    v_cmp_le_i32_e64 vcc, s56, v2
    s_cbranch_vccnz hrp_50f
hok_49:
    s_add_u32 s47, s47, 262144
    s_cmp_ge_u32 s47, s41
    s_cselect_b32 s34, 3670016, 0
    s_sub_u32 s47, s47, s34
    ds_read_b128 v[20:23], v16 offset:40960
    ds_read_b128 v[24:27], v16 offset:41984
    ds_read_b128 v[28:31], v16 offset:43008
    ds_read_b128 v[32:35], v16 offset:44032
    s_barrier
    s_mov_b32 s45, 0
hv_51:
    s_waitcnt lgkmcnt(0)
    v_max3_i32 v2, v21, v23, v25
    v_max3_i32 v3, v27, v29, v31
    v_max3_i32 v2, v2, v33, v35
    v_max_i32 v2, v2, v3
    v_cmp_le_i32 vcc, s56, v2
    s_cbranch_vccnz hrp_53f
hok_52:
    s_add_u32 s47, s47, 262144
    s_cmp_ge_u32 s47, s41
    s_cselect_b32 s34, 3670016, 0
    s_sub_u32 s47, s47, s34
    ds_read_b128 v[20:23], v16 offset:49152
    ds_read_b128 v[24:27], v16 offset:50176
    ds_read_b128 v[28:31], v16 offset:51200
    ds_read_b128 v[32:35], v16 offset:52224
    s_barrier
    s_mov_b32 s45, 0
hv_54:
    s_waitcnt lgkmcnt(0)
    v_max3_i32 v2, v21, v23, v25
    v_max3_i32 v3, v27, v29, v31
    v_max3_i32 v2, v2, v33, v35
    v_max_i32 v2, v2, v3
    v_cmp_le_i32 vcc, s56, v2
    s_cbranch_vccnz hrp_56f
hok_55:
    s_add_u32 s47, s47, 262144
    s_cmp_ge_u32 s47, s41
    s_cselect_b32 s34, 3670016, 0
    s_sub_u32 s47, s47, s34
    ds_read_b128 v[20:23], v16 offset:57344
    ds_read_b128 v[24:27], v16 offset:58368
    ds_read_b128 v[28:31], v16 offset:59392
    ds_read_b128 v[32:35], v16 offset:60416
    s_barrier
    s_mov_b32 s45, 0
hv_57:
    s_waitcnt lgkmcnt(0)
    v_max3_i32 v2, v21, v23, v25
    v_max3_i32 v3, v27, v29, v31
    v_max3_i32 v2, v2, v33, v35
    v_max_i32 v2, v2, v3
    v_cmp_le_i32 vcc, s56, v2
    s_cbranch_vccnz hrp_59f
hok_58:
    s_add_u32 s47, s47, 262144
    s_cmp_ge_u32 s47, s41
    s_cselect_b32 s34, 3670016, 0
    s_sub_u32 s47, s47, s34
    ds_read_b128 v[20:23], v17 offset:0
    ds_read_b128 v[24:27], v17 offset:1024
    ds_read_b128 v[28:31], v17 offset:2048
    ds_read_b128 v[32:35], v17 offset:3072
    s_barrier
    s_mov_b32 s45, 0
hv_60:
    s_waitcnt lgkmcnt(0)
    v_max3_i32 v2, v21, v23, v25
    v_max3_i32 v3, v27, v29, v31
    v_max3_i32 v2, v2, v33, v35
    v_max_i32 v2, v2, v3
    v_cmp_le_i32 vcc, s56, v2
    s_cbranch_vccnz hrp_62f
hok_61:
    s_add_u32 s47, s47, 262144
    s_cmp_ge_u32 s47, s41
    s_cselect_b32 s34, 3670016, 0
    s_sub_u32 s47, s47, s34
    ds_read_b128 v[20:23], v17 offset:8192
    ds_read_b128 v[24:27], v17 offset:9216
    ds_read_b128 v[28:31], v17 offset:10240
    ds_read_b128 v[32:35], v17 offset:11264
    s_barrier
    s_mov_b32 s45, 0
hv_63:
    s_waitcnt lgkmcnt(0)
    v_max3_i32 v2, v21, v23, v25
    v_max3_i32 v3, v27, v29, v31
    v_max3_i32 v2, v2, v33, v35
    v_max_i32 v2, v2, v3
    v_cmp_le_i32 vcc, s56, v2
    s_cbranch_vccnz hrp_65f
hok_64:
    s_add_u32 s47, s47, 262144
    s_cmp_ge_u32 s47, s41
    s_cselect_b32 s34, 3670016, 0
    s_sub_u32 s47, s47, s34
    ds_read_b128 v[20:23], v17 offset:16384
    ds_read_b128 v[24:27], v17 offset:17408
    ds_read_b128 v[28:31], v17 offset:18432
    ds_read_b128 v[32:35], v17 offset:19456
    s_barrier
    s_mov_b32 s45, 0
hv_66:
    s_waitcnt lgkmcnt(0)
    v_max3_i32 v2, v21, v23, v25
    v_max3_i32 v3, v27, v29, v31
    v_max3_i32 v2, v2, v33, v35
    v_max_i32 v2, v2, v3
    v_cmp_le_i32 vcc, s56, v2
    s_cbranch_vccnz hrp_68f
hok_67:
    s_add_u32 s47, s47, 262144
    s_cmp_ge_u32 s47, s41
    s_cselect_b32 s34, 3670016, 0
    s_sub_u32 s47, s47, s34
    ds_read_b128 v[20:23], v17 offset:24576
    ds_read_b128 v[24:27], v17 offset:25600
    ds_read_b128 v[28:31], v17 offset:26624
    ds_read_b128 v[32:35], v17 offset:27648
    s_barrier
    s_mov_b32 s45, 0
hv_69:
    s_waitcnt lgkmcnt(0)
    v_max3_i32 v2, v21, v23, v25
    v_max3_i32 v3, v27, v29, v31
    v_max3_i32 v2, v2, v33, v35
    v_max_i32 v2, v2, v3
    v_cmp_le_i32 vcc, s56, v2
    s_cbranch_vccnz hrp_71f
hok_70:
    s_add_u32 s47, s47, 262144
    s_cmp_ge_u32 s47, s41
    s_cselect_b32 s34, 3670016, 0
    s_sub_u32 s47, s47, s34
    ds_read_b128 v[20:23], v17 offset:32768
    ds_read_b128 v[24:27], v17 offset:33792
    ds_read_b128 v[28:31], v17 offset:34816
    ds_read_b128 v[32:35], v17 offset:35840
    s_add_u32 s43, s42, 1204224
    s_add_u32 s44, s46, 57344
    s_cmp_ge_u32 s43, s44
    s_cselect_b32 s34, 1605632, 0
    s_sub_u32 s43, s43, s34
    buffer_load_dwordx4 v[104:107], v12, s[60:63], s43 offen offset:0
    buffer_load_dwordx4 v[108:111], v13, s[60:63], s43 offen offset:1024
    buffer_load_dwordx4 v[112:115], v14, s[60:63], s43 offen offset:2048
    buffer_load_dwordx4 v[116:119], v15, s[60:63], s43 offen offset:3072
    s_add_u32 s43, s43, 114688
    s_barrier
    s_mov_b32 s45, 0
hv_72:
    s_waitcnt lgkmcnt(0)
    v_max3_i32 v2, v21, v23, v25
    v_max3_i32 v3, v27, v29, v31
    v_max3_i32 v2, v2, v33, v35
    v_max_i32 v2, v2, v3
    v_cmp_le_i32 vcc, s56, v2
    s_cbranch_vccnz hrp_74f
hok_73:
    s_add_u32 s47, s47, 262144
    s_cmp_ge_u32 s47, s41
    s_cselect_b32 s34, 3670016, 0
    s_sub_u32 s47, s47, s34
    ds_read_b128 v[20:23], v17 offset:40960
    ds_read_b128 v[24:27], v17 offset:41984
    ds_read_b128 v[28:31], v17 offset:43008
    ds_read_b128 v[32:35], v17 offset:44032
    s_add_u32 s43, s42, 1318912
    s_add_u32 s44, s46, 57344
    s_cmp_ge_u32 s43, s44
    s_cselect_b32 s34, 1605632, 0
    s_sub_u32 s43, s43, s34
    buffer_load_dwordx4 v[120:123], v12, s[60:63], s43 offen offset:0
    buffer_load_dwordx4 v[124:127], v13, s[60:63], s43 offen offset:1024
    buffer_load_dwordx4 v[128:131], v14, s[60:63], s43 offen offset:2048
    buffer_load_dwordx4 v[132:135], v15, s[60:63], s43 offen offset:3072
    s_add_u32 s43, s43, 114688
    s_barrier
    s_mov_b32 s45, 0
hv_75:
    s_waitcnt lgkmcnt(0)
    v_max3_i32 v2, v21, v23, v25
    v_max3_i32 v3, v27, v29, v31
    v_max3_i32 v2, v2, v33, v35
    v_max_i32 v2, v2, v3
    v_cmp_le_i32 vcc, s56, v2
    s_cbranch_vccnz hrp_77f
hok_76:
    s_add_u32 s47, s47, 262144
    s_cmp_ge_u32 s47, s41
    s_cselect_b32 s34, 3670016, 0
    s_sub_u32 s47, s47, s34
    s_add_u32 s43, s42, 1433600
    s_add_u32 s44, s46, 57344
    s_cmp_ge_u32 s43, s44
    s_cselect_b32 s34, 1605632, 0
    s_sub_u32 s43, s43, s34
    buffer_load_dwordx4 v[136:139], v12, s[60:63], s43 offen offset:0
    buffer_load_dwordx4 v[140:143], v13, s[60:63], s43 offen offset:1024
    buffer_load_dwordx4 v[144:147], v14, s[60:63], s43 offen offset:2048
    buffer_load_dwordx4 v[148:151], v15, s[60:63], s43 offen offset:3072
    s_add_u32 s43, s43, 114688
    s_barrier
    s_add_u32 s43, s42, 1548288
    s_add_u32 s44, s46, 57344
    s_cmp_ge_u32 s43, s44
    s_cselect_b32 s34, 1605632, 0
    s_sub_u32 s43, s43, s34
    buffer_load_dwordx4 v[152:155], v12, s[60:63], s43 offen offset:0
    buffer_load_dwordx4 v[156:159], v13, s[60:63], s43 offen offset:1024
    buffer_load_dwordx4 v[160:163], v14, s[60:63], s43 offen offset:2048
    buffer_load_dwordx4 v[164:167], v15, s[60:63], s43 offen offset:3072
    s_add_u32 s43, s43, 114688
    s_setprio 0
    v_mov_b32_e64 v2, 0
    s_barrier
    s_barrier
    s_barrier
    s_barrier
    s_cmp_lg_u32 s36, 0
    s_cbranch_scc1 cs2_78
    global_load_dword v3, v2, s[28:29] offset:128 sc1
cs2_78:
    s_barrier
    s_barrier
    s_barrier
    s_cmp_lg_u32 s36, 0
    s_cbranch_scc1 cs2_79
    s_mov_b32 s45, 0
cs2_79p:
    s_waitcnt vmcnt(0)
    v_cmp_gt_u32 vcc, 32, v3
    s_cbranch_vccz cs2_79
    s_sleep 16
    global_load_dword v3, v2, s[28:29] offset:128 sc1
    s_add_u32 s45, s45, 1
    s_cmp_lt_u32 s45, 262144
    s_cbranch_scc1 cs2_79p
cs2_79:
    s_barrier
    s_barrier
    s_barrier
    s_barrier
    s_barrier
    s_barrier
    s_barrier
    s_barrier
    s_barrier
    s_barrier
    s_barrier
    s_waitcnt vmcnt(0)
    ds_write_b128 v16, v[40:43] offset:0
    ds_write_b128 v16, v[44:47] offset:1024
    ds_write_b128 v16, v[48:51] offset:2048
    ds_write_b128 v16, v[52:55] offset:3072
    ds_write_b128 v16, v[56:59] offset:8192
    ds_write_b128 v16, v[60:63] offset:9216
    ds_write_b128 v16, v[64:67] offset:10240
    ds_write_b128 v16, v[68:71] offset:11264
    ds_write_b128 v16, v[72:75] offset:16384
    ds_write_b128 v16, v[76:79] offset:17408
    ds_write_b128 v16, v[80:83] offset:18432
    ds_write_b128 v16, v[84:87] offset:19456
    s_barrier
    s_nop 0
    ds_write_b128 v16, v[88:91] offset:24576
    ds_write_b128 v16, v[92:95] offset:25600
    ds_write_b128 v16, v[96:99] offset:26624
    ds_write_b128 v16, v[100:103] offset:27648
    ds_write_b128 v16, v[104:107] offset:32768
    ds_write_b128 v16, v[108:111] offset:33792
    ds_write_b128 v16, v[112:115] offset:34816
    ds_write_b128 v16, v[116:119] offset:35840
    ds_write_b128 v16, v[120:123] offset:40960
    ds_write_b128 v16, v[124:127] offset:41984
    ds_write_b128 v16, v[128:131] offset:43008
    ds_write_b128 v16, v[132:135] offset:44032
    ds_write_b128 v16, v[136:139] offset:49152
    ds_write_b128 v16, v[140:143] offset:50176
    ds_write_b128 v16, v[144:147] offset:51200
    ds_write_b128 v16, v[148:151] offset:52224
    ds_write_b128 v16, v[152:155] offset:57344
    ds_write_b128 v16, v[156:159] offset:58368
    ds_write_b128 v16, v[160:163] offset:59392
    ds_write_b128 v16, v[164:167] offset:60416
    s_waitcnt lgkmcnt(0)
end_1:
    s_endpgm
et_14c:
    s_mov_b32 s45, 0
poll_15:
    s_waitcnt lgkmcnt(0)
    s_cmp_ge_u32 s69, 14
    s_cbranch_scc1 ok_16
    s_mov_b32 s69, 0
    s_add_u32 s68, s59, 0
    s_atomic_add s69, s[30:31], s68 glc
    s_add_u32 s45, s45, 1
    s_cmp_lt_u32 s45, 262144
    s_cbranch_scc1 poll_15
    s_waitcnt lgkmcnt(0)
ok_16:
    buffer_load_dwordx4 v[96:99], v14, s[64:67], s4 offen offset:0 sc1
    buffer_load_dwordx4 v[100:103], v14, s[64:67], s5 offen offset:0 sc1
    buffer_load_dwordx4 v[104:107], v14, s[64:67], s6 offen offset:0 sc1
    buffer_load_dwordx4 v[108:111], v14, s[64:67], s7 offen offset:0 sc1
    buffer_load_dwordx4 v[112:115], v14, s[64:67], s8 offen offset:0 sc1
    s_branch et_14
xp_19c:
    s_add_u32 s45, s45, 1
    s_cmp_gt_u32 s45, 262144
    s_cbranch_scc1 xok_20
    v_cmp_ne_u32_e64 vcc, v101, v11
    v_cmp_ne_u32 s[50:51], v103, v11
    s_nop 0
    s_or_b64 exec, vcc, s[50:51]
    s_cbranch_execz xp_19m0
    buffer_load_dwordx4 v[100:103], v97, s[64:67], s44 offen offset:0 sc1
xp_19m0:
    s_mov_b64 exec, -1
    v_cmp_ne_u32_e64 vcc, v105, v11
    v_cmp_ne_u32 s[50:51], v107, v11
    s_nop 0
    s_or_b64 exec, vcc, s[50:51]
    s_cbranch_execz xp_19m1
    buffer_load_dwordx4 v[104:107], v97, s[64:67], s44 offen offset:1024 sc1
xp_19m1:
    s_mov_b64 exec, -1
    v_cmp_ne_u32_e64 vcc, v109, v11
    v_cmp_ne_u32 s[50:51], v111, v11
    s_nop 0
    s_or_b64 exec, vcc, s[50:51]
    s_cbranch_execz xp_19m2
    buffer_load_dwordx4 v[108:111], v97, s[64:67], s44 offen offset:2048 sc1
xp_19m2:
    s_mov_b64 exec, -1
    v_cmp_ne_u32_e64 vcc, v113, v11
    v_cmp_ne_u32 s[50:51], v115, v11
    s_nop 0
    s_or_b64 exec, vcc, s[50:51]
    s_cbranch_execz xp_19m3
    buffer_load_dwordx4 v[112:115], v97, s[64:67], s44 offen offset:3072 sc1
xp_19m3:
    s_mov_b64 exec, -1
    v_cmp_ne_u32_e64 vcc, v117, v11
    v_cmp_ne_u32 s[50:51], v119, v11
    s_nop 0
    s_or_b64 exec, vcc, s[50:51]
    s_cbranch_execz xp_19m4
    global_load_dwordx4 v[116:119], v97, s[30:31] offset:0 sc1
xp_19m4:
    s_mov_b64 exec, -1
    v_cmp_ne_u32_e64 vcc, v121, v11
    v_cmp_ne_u32 s[50:51], v123, v11
    s_nop 0
    s_or_b64 exec, vcc, s[50:51]
    s_cbranch_execz xp_19m5
    global_load_dwordx4 v[120:123], v97, s[30:31] offset:1024 sc1
xp_19m5:
    s_mov_b64 exec, -1
    v_cmp_ne_u32_e64 vcc, v125, v11
    v_cmp_ne_u32 s[50:51], v127, v11
    s_nop 0
    s_or_b64 exec, vcc, s[50:51]
    s_cbranch_execz xp_19m6
    global_load_dwordx4 v[124:127], v97, s[30:31] offset:2048 sc1
xp_19m6:
    s_mov_b64 exec, -1
    v_cmp_ne_u32_e64 vcc, v129, v11
    v_cmp_ne_u32 s[50:51], v131, v11
    s_nop 0
    s_or_b64 exec, vcc, s[50:51]
    s_cbranch_execz xp_19m7
    global_load_dwordx4 v[128:131], v97, s[30:31] offset:3072 sc1
xp_19m7:
    s_mov_b64 exec, -1
    s_waitcnt vmcnt(0)
    s_branch xp_19
gp_28c:
    s_add_u32 s45, s45, 1
    s_cmp_ge_u32 s45, 262144
    s_cbranch_scc1 gok_29
    global_load_dwordx2 v[96:97], v23, s[30:31] offset:-3072 sc1
    global_load_dwordx2 v[98:99], v23, s[30:31] offset:-2048 sc1
    global_load_dwordx2 v[100:101], v23, s[30:31] offset:-1024 sc1
    global_load_dwordx2 v[102:103], v23, s[30:31] offset:0 sc1
    global_load_dwordx2 v[104:105], v23, s[30:31] offset:1024 sc1
    global_load_dwordx2 v[106:107], v23, s[30:31] offset:2048 sc1
    global_load_dwordx2 v[108:109], v23, s[30:31] offset:3072 sc1
    s_branch gp_28
hrp_38f:
    s_sleep 4
    s_add_u32 s45, s45, 1
    s_cmp_ge_u32 s45, 262144
    s_cbranch_scc1 hok_37
    s_mov_b32 s43, s47
    s_add_u32 s44, s32, 0
    s_add_u32 s35, s32, 8192
hrp_38:
    s_add_u32 m0, s44, 0
    s_add_u32 s33, s43, 262144
    buffer_load_dwordx4 v8, s[48:51], s43 offen offset:0 sc1 lds
    s_cmp_ge_u32 s33, s41
    s_cselect_b32 s34, 3670016, 0
    buffer_load_dwordx4 v9, s[48:51], s43 offen offset:1024 sc1 lds
    buffer_load_dwordx4 v10, s[48:51], s43 offen offset:2048 sc1 lds
    buffer_load_dwordx4 v11, s[48:51], s43 offen offset:3072 sc1 lds
    s_sub_u32 s43, s33, s34
    s_add_u32 s44, s44, 8192
    s_cmp_lt_u32 s44, s35
    s_cbranch_scc1 hrp_38
    s_waitcnt vmcnt(0)
    ds_read_b128 v[20:23], v16 offset:0
    ds_read_b128 v[24:27], v16 offset:1024
    ds_read_b128 v[28:31], v16 offset:2048
    ds_read_b128 v[32:35], v16 offset:3072
    s_branch hv_36
hrp_41f:
    s_sleep 4
    s_add_u32 s45, s45, 1
    s_cmp_ge_u32 s45, 262144
    s_cbranch_scc1 hok_40
    s_mov_b32 s43, s47
    s_add_u32 s44, s32, 8192
    s_add_u32 s35, s32, 40960
hrp_41:
    s_add_u32 m0, s44, 0
    s_add_u32 s33, s43, 262144
    buffer_load_dwordx4 v8, s[48:51], s43 offen offset:0 sc1 lds
    s_cmp_ge_u32 s33, s41
    s_cselect_b32 s34, 3670016, 0
    buffer_load_dwordx4 v9, s[48:51], s43 offen offset:1024 sc1 lds
    buffer_load_dwordx4 v10, s[48:51], s43 offen offset:2048 sc1 lds
    buffer_load_dwordx4 v11, s[48:51], s43 offen offset:3072 sc1 lds
    s_sub_u32 s43, s33, s34
    s_add_u32 s44, s44, 8192
    s_cmp_lt_u32 s44, s35
    s_cbranch_scc1 hrp_41
    s_waitcnt vmcnt(12)
    ds_read_b128 v[20:23], v16 offset:8192
    ds_read_b128 v[24:27], v16 offset:9216
    ds_read_b128 v[28:31], v16 offset:10240
    ds_read_b128 v[32:35], v16 offset:11264
    s_branch hv_39
hrp_44f:
    s_sleep 4
    s_add_u32 s45, s45, 1
    s_cmp_ge_u32 s45, 262144
    s_cbranch_scc1 hok_43
    s_mov_b32 s43, s47
    s_add_u32 s44, s32, 16384
    s_add_u32 s35, s32, 40960
hrp_44:
    s_add_u32 m0, s44, 0
    s_add_u32 s33, s43, 262144
    buffer_load_dwordx4 v8, s[48:51], s43 offen offset:0 sc1 lds
    s_cmp_ge_u32 s33, s41
    s_cselect_b32 s34, 3670016, 0
    buffer_load_dwordx4 v9, s[48:51], s43 offen offset:1024 sc1 lds
    buffer_load_dwordx4 v10, s[48:51], s43 offen offset:2048 sc1 lds
    buffer_load_dwordx4 v11, s[48:51], s43 offen offset:3072 sc1 lds
    s_sub_u32 s43, s33, s34
    s_add_u32 s44, s44, 8192
    s_cmp_lt_u32 s44, s35
    s_cbranch_scc1 hrp_44
    s_waitcnt vmcnt(8)
    ds_read_b128 v[20:23], v16 offset:16384
    ds_read_b128 v[24:27], v16 offset:17408
    ds_read_b128 v[28:31], v16 offset:18432
    ds_read_b128 v[32:35], v16 offset:19456
    s_branch hv_42
hrp_47f:
    s_sleep 4
    s_add_u32 s45, s45, 1
    s_cmp_ge_u32 s45, 262144
    s_cbranch_scc1 hok_46
    s_mov_b32 s43, s47
    s_add_u32 s44, s32, 24576
    s_add_u32 s35, s32, 40960
hrp_47:
    s_add_u32 m0, s44, 0
    s_add_u32 s33, s43, 262144
    buffer_load_dwordx4 v8, s[48:51], s43 offen offset:0 sc1 lds
    s_cmp_ge_u32 s33, s41
    s_cselect_b32 s34, 3670016, 0
    buffer_load_dwordx4 v9, s[48:51], s43 offen offset:1024 sc1 lds
    buffer_load_dwordx4 v10, s[48:51], s43 offen offset:2048 sc1 lds
    buffer_load_dwordx4 v11, s[48:51], s43 offen offset:3072 sc1 lds
    s_sub_u32 s43, s33, s34
    s_add_u32 s44, s44, 8192
    s_cmp_lt_u32 s44, s35
    s_cbranch_scc1 hrp_47
    s_waitcnt vmcnt(4)
    ds_read_b128 v[20:23], v16 offset:24576
    ds_read_b128 v[24:27], v16 offset:25600
    ds_read_b128 v[28:31], v16 offset:26624
    s_branch Lpg7
.p2align 12
Lpw7:
    s_setpc_b64 s[96:97]
Lpg7:
    ds_read_b128 v[32:35], v16 offset:27648
    s_branch hv_45
hrp_50f:
    s_sleep 4
    s_add_u32 s45, s45, 1
    s_cmp_ge_u32 s45, 262144
    s_cbranch_scc1 hok_49
    s_mov_b32 s43, s47
    s_add_u32 s44, s32, 32768
    s_add_u32 s35, s32, 40960
hrp_50:
    s_add_u32 m0, s44, 0
    s_add_u32 s33, s43, 262144
    buffer_load_dwordx4 v8, s[48:51], s43 offen offset:0 sc1 lds
    s_cmp_ge_u32 s33, s41
    s_cselect_b32 s34, 3670016, 0
    buffer_load_dwordx4 v9, s[48:51], s43 offen offset:1024 sc1 lds
    buffer_load_dwordx4 v10, s[48:51], s43 offen offset:2048 sc1 lds
    buffer_load_dwordx4 v11, s[48:51], s43 offen offset:3072 sc1 lds
    s_sub_u32 s43, s33, s34
    s_add_u32 s44, s44, 8192
    s_cmp_lt_u32 s44, s35
    s_cbranch_scc1 hrp_50
    s_waitcnt vmcnt(0)
    ds_read_b128 v[20:23], v16 offset:32768
    ds_read_b128 v[24:27], v16 offset:33792
    ds_read_b128 v[28:31], v16 offset:34816
    ds_read_b128 v[32:35], v16 offset:35840
    s_branch hv_48
hrp_53f:
    s_sleep 4
    s_add_u32 s45, s45, 1
    s_cmp_ge_u32 s45, 262144
    s_cbranch_scc1 hok_52
    s_mov_b32 s43, s47
    s_add_u32 s44, s32, 40960
    s_add_u32 s35, s32, 49152
hrp_53:
    s_add_u32 m0, s44, 0
    s_add_u32 s33, s43, 262144
    buffer_load_dwordx4 v8, s[48:51], s43 offen offset:0 sc1 lds
    s_cmp_ge_u32 s33, s41
    s_cselect_b32 s34, 3670016, 0
    buffer_load_dwordx4 v9, s[48:51], s43 offen offset:1024 sc1 lds
    buffer_load_dwordx4 v10, s[48:51], s43 offen offset:2048 sc1 lds
    buffer_load_dwordx4 v11, s[48:51], s43 offen offset:3072 sc1 lds
    s_sub_u32 s43, s33, s34
    s_add_u32 s44, s44, 8192
    s_cmp_lt_u32 s44, s35
    s_cbranch_scc1 hrp_53
    s_waitcnt vmcnt(0)
    ds_read_b128 v[20:23], v16 offset:40960
    ds_read_b128 v[24:27], v16 offset:41984
    ds_read_b128 v[28:31], v16 offset:43008
    ds_read_b128 v[32:35], v16 offset:44032
    s_branch hv_51
hrp_56f:
    s_sleep 4
    s_add_u32 s45, s45, 1
    s_cmp_ge_u32 s45, 262144
    s_cbranch_scc1 hok_55
    s_mov_b32 s43, s47
    s_add_u32 s44, s32, 49152
    s_add_u32 s35, s32, 57344
hrp_56:
    s_add_u32 m0, s44, 0
    s_add_u32 s33, s43, 262144
    buffer_load_dwordx4 v8, s[48:51], s43 offen offset:0 sc1 lds
    s_cmp_ge_u32 s33, s41
    s_cselect_b32 s34, 3670016, 0
    buffer_load_dwordx4 v9, s[48:51], s43 offen offset:1024 sc1 lds
    buffer_load_dwordx4 v10, s[48:51], s43 offen offset:2048 sc1 lds
    buffer_load_dwordx4 v11, s[48:51], s43 offen offset:3072 sc1 lds
    s_sub_u32 s43, s33, s34
    s_add_u32 s44, s44, 8192
    s_cmp_lt_u32 s44, s35
    s_cbranch_scc1 hrp_56
    s_waitcnt vmcnt(0)
    ds_read_b128 v[20:23], v16 offset:49152
    ds_read_b128 v[24:27], v16 offset:50176
    ds_read_b128 v[28:31], v16 offset:51200
    ds_read_b128 v[32:35], v16 offset:52224
    s_branch hv_54
hrp_59f:
    s_sleep 4
    s_add_u32 s45, s45, 1
    s_cmp_ge_u32 s45, 262144
    s_cbranch_scc1 hok_58
    s_mov_b32 s43, s47
    s_add_u32 s44, s32, 57344
    s_add_u32 s35, s32, 65536
hrp_59:
    s_add_u32 m0, s44, 0
    s_add_u32 s33, s43, 262144
    buffer_load_dwordx4 v8, s[48:51], s43 offen offset:0 sc1 lds
    s_cmp_ge_u32 s33, s41
    s_cselect_b32 s34, 3670016, 0
    buffer_load_dwordx4 v9, s[48:51], s43 offen offset:1024 sc1 lds
    buffer_load_dwordx4 v10, s[48:51], s43 offen offset:2048 sc1 lds
    buffer_load_dwordx4 v11, s[48:51], s43 offen offset:3072 sc1 lds
    s_sub_u32 s43, s33, s34
    s_add_u32 s44, s44, 8192
    s_cmp_lt_u32 s44, s35
    s_cbranch_scc1 hrp_59
    s_waitcnt vmcnt(0)
    ds_read_b128 v[20:23], v16 offset:57344
    ds_read_b128 v[24:27], v16 offset:58368
    ds_read_b128 v[28:31], v16 offset:59392
    ds_read_b128 v[32:35], v16 offset:60416
    s_branch hv_57
hrp_62f:
    s_sleep 4
    s_add_u32 s45, s45, 1
    s_cmp_ge_u32 s45, 262144
    s_cbranch_scc1 hok_61
    s_mov_b32 s43, s47
    s_add_u32 s44, s32, 65536
    s_add_u32 s35, s32, 73728
hrp_62:
    s_add_u32 m0, s44, 0
    s_add_u32 s33, s43, 262144
    buffer_load_dwordx4 v8, s[48:51], s43 offen offset:0 sc1 lds
    s_cmp_ge_u32 s33, s41
    s_cselect_b32 s34, 3670016, 0
    buffer_load_dwordx4 v9, s[48:51], s43 offen offset:1024 sc1 lds
    buffer_load_dwordx4 v10, s[48:51], s43 offen offset:2048 sc1 lds
    buffer_load_dwordx4 v11, s[48:51], s43 offen offset:3072 sc1 lds
    s_sub_u32 s43, s33, s34
    s_add_u32 s44, s44, 8192
    s_cmp_lt_u32 s44, s35
    s_cbranch_scc1 hrp_62
    s_waitcnt vmcnt(0)
    ds_read_b128 v[20:23], v17 offset:0
    ds_read_b128 v[24:27], v17 offset:1024
    ds_read_b128 v[28:31], v17 offset:2048
    ds_read_b128 v[32:35], v17 offset:3072
    s_branch hv_60
hrp_65f:
    s_sleep 4
    s_add_u32 s45, s45, 1
    s_cmp_ge_u32 s45, 262144
    s_cbranch_scc1 hok_64
    s_mov_b32 s43, s47
    s_add_u32 s44, s32, 73728
    s_add_u32 s35, s32, 81920
hrp_65:
    s_add_u32 m0, s44, 0
    s_add_u32 s33, s43, 262144
    buffer_load_dwordx4 v8, s[48:51], s43 offen offset:0 sc1 lds
    s_cmp_ge_u32 s33, s41
    s_cselect_b32 s34, 3670016, 0
    buffer_load_dwordx4 v9, s[48:51], s43 offen offset:1024 sc1 lds
    buffer_load_dwordx4 v10, s[48:51], s43 offen offset:2048 sc1 lds
    buffer_load_dwordx4 v11, s[48:51], s43 offen offset:3072 sc1 lds
    s_sub_u32 s43, s33, s34
    s_add_u32 s44, s44, 8192
    s_cmp_lt_u32 s44, s35
    s_cbranch_scc1 hrp_65
    s_waitcnt vmcnt(0)
    ds_read_b128 v[20:23], v17 offset:8192
    ds_read_b128 v[24:27], v17 offset:9216
    ds_read_b128 v[28:31], v17 offset:10240
    ds_read_b128 v[32:35], v17 offset:11264
    s_branch hv_63
hrp_68f:
    s_sleep 4
    s_add_u32 s45, s45, 1
    s_cmp_ge_u32 s45, 262144
    s_cbranch_scc1 hok_67
    s_mov_b32 s43, s47
    s_add_u32 s44, s32, 81920
    s_add_u32 s35, s32, 90112
hrp_68:
    s_add_u32 m0, s44, 0
    s_add_u32 s33, s43, 262144
    buffer_load_dwordx4 v8, s[48:51], s43 offen offset:0 sc1 lds
    s_cmp_ge_u32 s33, s41
    s_cselect_b32 s34, 3670016, 0
    buffer_load_dwordx4 v9, s[48:51], s43 offen offset:1024 sc1 lds
    buffer_load_dwordx4 v10, s[48:51], s43 offen offset:2048 sc1 lds
    buffer_load_dwordx4 v11, s[48:51], s43 offen offset:3072 sc1 lds
    s_sub_u32 s43, s33, s34
    s_add_u32 s44, s44, 8192
    s_cmp_lt_u32 s44, s35
    s_cbranch_scc1 hrp_68
    s_waitcnt vmcnt(0)
    ds_read_b128 v[20:23], v17 offset:16384
    ds_read_b128 v[24:27], v17 offset:17408
    ds_read_b128 v[28:31], v17 offset:18432
    ds_read_b128 v[32:35], v17 offset:19456
    s_branch hv_66
hrp_71f:
    s_sleep 4
    s_add_u32 s45, s45, 1
    s_cmp_ge_u32 s45, 262144
    s_cbranch_scc1 hok_70
    s_mov_b32 s43, s47
    s_add_u32 s44, s32, 90112
    s_add_u32 s35, s32, 98304
hrp_71:
    s_add_u32 m0, s44, 0
    s_add_u32 s33, s43, 262144
    buffer_load_dwordx4 v8, s[48:51], s43 offen offset:0 sc1 lds
    s_cmp_ge_u32 s33, s41
    s_cselect_b32 s34, 3670016, 0
    buffer_load_dwordx4 v9, s[48:51], s43 offen offset:1024 sc1 lds
    buffer_load_dwordx4 v10, s[48:51], s43 offen offset:2048 sc1 lds
    buffer_load_dwordx4 v11, s[48:51], s43 offen offset:3072 sc1 lds
    s_sub_u32 s43, s33, s34
    s_add_u32 s44, s44, 8192
    s_cmp_lt_u32 s44, s35
    s_cbranch_scc1 hrp_71
    s_waitcnt vmcnt(0)
    ds_read_b128 v[20:23], v17 offset:24576
    ds_read_b128 v[24:27], v17 offset:25600
    ds_read_b128 v[28:31], v17 offset:26624
    ds_read_b128 v[32:35], v17 offset:27648
    s_branch hv_69
hrp_74f:
    s_sleep 4
    s_add_u32 s45, s45, 1
    s_cmp_ge_u32 s45, 262144
    s_cbranch_scc1 hok_73
    s_mov_b32 s43, s47
    s_add_u32 s44, s32, 98304
    s_add_u32 s35, s32, 106496
hrp_74:
    s_add_u32 m0, s44, 0
    s_add_u32 s33, s43, 262144
    buffer_load_dwordx4 v8, s[48:51], s43 offen offset:0 sc1 lds
    s_cmp_ge_u32 s33, s41
    s_cselect_b32 s34, 3670016, 0
    buffer_load_dwordx4 v9, s[48:51], s43 offen offset:1024 sc1 lds
    buffer_load_dwordx4 v10, s[48:51], s43 offen offset:2048 sc1 lds
    buffer_load_dwordx4 v11, s[48:51], s43 offen offset:3072 sc1 lds
    s_sub_u32 s43, s33, s34
    s_add_u32 s44, s44, 8192
    s_cmp_lt_u32 s44, s35
    s_cbranch_scc1 hrp_74
    s_waitcnt vmcnt(0)
    ds_read_b128 v[20:23], v17 offset:32768
    ds_read_b128 v[24:27], v17 offset:33792
    ds_read_b128 v[28:31], v17 offset:34816
    ds_read_b128 v[32:35], v17 offset:35840
    s_branch hv_72
hrp_77f:
    s_sleep 4
    s_add_u32 s45, s45, 1
    s_cmp_ge_u32 s45, 262144
    s_cbranch_scc1 hok_76
    s_mov_b32 s43, s47
    s_add_u32 s44, s32, 106496
    s_add_u32 s35, s32, 114688
hrp_77:
    s_add_u32 m0, s44, 0
    s_add_u32 s33, s43, 262144
    buffer_load_dwordx4 v8, s[48:51], s43 offen offset:0 sc1 lds
    s_cmp_ge_u32 s33, s41
    s_cselect_b32 s34, 3670016, 0
    buffer_load_dwordx4 v9, s[48:51], s43 offen offset:1024 sc1 lds
    buffer_load_dwordx4 v10, s[48:51], s43 offen offset:2048 sc1 lds
    buffer_load_dwordx4 v11, s[48:51], s43 offen offset:3072 sc1 lds
    s_sub_u32 s43, s33, s34
    s_add_u32 s44, s44, 8192
    s_cmp_lt_u32 s44, s35
    s_cbranch_scc1 hrp_77
    s_waitcnt vmcnt(0)
    ds_read_b128 v[20:23], v17 offset:40960
    ds_read_b128 v[24:27], v17 offset:41984
    ds_read_b128 v[28:31], v17 offset:43008
    ds_read_b128 v[32:35], v17 offset:44032
    s_branch hv_75
.p2align 3
hlp_2:
    s_cmp_eq_u32 s36, 9
    s_cbranch_scc1 Lhe
    s_sub_u32 s44, s2, 224
    s_lshr_b32 s45, s44, 3
    s_bfe_u32 s46, s44, 0x20001
    s_lshl_b32 s46, s46, 2
    s_add_u32 s46, s46, s45
    s_and_b32 s44, s44, 1
    s_cmp_ge_u32 s46, 14
    s_cselect_b32 s47, 2, 0
    s_sub_u32 s46, s46, s47
    v_and_b32 v1, 7, v0
    v_lshrrev_b32_e64 v2, 3, v0
    v_mul_u32_u24 v2, 3584, v2
    v_lshl_add_u32 v2, v1, 4, v2
    s_cmp_ge_u32 s46, 7
    s_cselect_b32 s47, 7, 0
    s_waitcnt lgkmcnt(0)
    s_cselect_b32 s48, s22, s20
    s_cselect_b32 s49, s23, s21
    s_sub_u32 s46, s46, s47
    s_mul_i32 s50, s44, 7
    s_add_u32 s46, s46, s50
    s_lshl_b32 s47, s47, 1
    s_add_u32 s52, s46, s47
    s_lshl_b32 s55, s46, 8
    s_mov_b32 s50, 1605632
    s_mov_b32 s51, 0x20000
    s_lshr_b32 s54, s52, 1
    s_mul_i32 s54, s54, 114688
    s_and_b32 s53, s52, 1
    s_lshl_b32 s53, s53, 3
    s_add_u32 s53, s53, s36
    s_mul_i32 s53, s53, 3584
    s_add_u32 s54, s54, s53
    s_add_u32 s54, s54, 57344
    v_and_b32 v3, 63, v0
    v_min_u32 v3, 27, v3
    v_lshl_add_u32 v3, v3, 7, s54
    v_lshrrev_b32 v12, 6, v0
    v_lshlrev_b32 v12, 8, v12
    v_lshl_add_u32 v12, v1, 5, v12
    v_and_b32 v14, 63, v0
    v_lshlrev_b32_e64 v13, 2, v14
    s_lshl_b32 s46, s52, 10
    s_add_u32 s46, s46, 32768
    v_lshl_add_u32 v14, v14, 3, s46
    s_mov_b32 s42, 0x00003f80
    s_mov_b32 s43, 0x3f800000
    s_mov_b32 s41, 0xffff0000
    s_mov_b32 s56, 0
    s_barrier
    s_cmp_eq_u32 s36, 8
    s_cbranch_scc1 Lhf
    s_mov_b32 s47, s55
    buffer_load_dwordx4 v[40:43], v2, s[48:51], s47 offen offset:0
    s_add_u32 s47, s47, 229376
    buffer_load_dwordx4 v[44:47], v2, s[48:51], s47 offen offset:0
    s_add_u32 s47, s47, 229376
    buffer_load_dwordx4 v[48:51], v2, s[48:51], s47 offen offset:0
    s_add_u32 s47, s47, 229376
    buffer_load_dwordx4 v[52:55], v2, s[48:51], s47 offen offset:0
    s_add_u32 s47, s47, 229376
    buffer_load_dwordx4 v[56:59], v2, s[48:51], s47 offen offset:0
    s_add_u32 s47, s47, 229376
    buffer_load_dwordx4 v[60:63], v2, s[48:51], s47 offen offset:0
    s_add_u32 s47, s47, 229376
    buffer_load_dwordx4 v[64:67], v2, s[48:51], s47 offen offset:0
    global_load_dword v100, v3, s[24:25]
    v_subrev_u32 v3, 57344, v3
    s_waitcnt vmcnt(3)
    s_mov_b32 s47, s55
    buffer_load_dwordx4 v[68:71], v2, s[48:51], s47 offen offset:128
    s_add_u32 s47, s47, 229376
    buffer_load_dwordx4 v[72:75], v2, s[48:51], s47 offen offset:128
    s_add_u32 s47, s47, 229376
    buffer_load_dwordx4 v[76:79], v2, s[48:51], s47 offen offset:128
    s_add_u32 s47, s47, 229376
    buffer_load_dwordx4 v[80:83], v2, s[48:51], s47 offen offset:128
    s_add_u32 s47, s47, 229376
    buffer_load_dwordx4 v[84:87], v2, s[48:51], s47 offen offset:128
    s_add_u32 s47, s47, 229376
    buffer_load_dwordx4 v[88:91], v2, s[48:51], s47 offen offset:128
    s_add_u32 s47, s47, 229376
    buffer_load_dwordx4 v[92:95], v2, s[48:51], s47 offen offset:128
    global_load_dword v101, v3, s[24:25]
    s_waitcnt vmcnt(9)
Lhl:
    s_nop 0
    v_dot2_f32_bf16 v4, v40, s42, 0
    v_dot2_f32_bf16 v5, v40, s43, 0
    v_dot2_f32_bf16 v6, v41, s42, 0
    v_dot2_f32_bf16 v7, v41, s43, 0
    v_dot2_f32_bf16 v8, v42, s42, 0
    v_dot2_f32_bf16 v9, v42, s43, 0
    v_dot2_f32_bf16 v10, v43, s42, 0
    v_dot2_f32_bf16 v11, v43, s43, 0
    v_dot2_f32_bf16 v4, v44, s42, v4
    v_dot2_f32_bf16 v5, v44, s43, v5
    v_dot2_f32_bf16 v6, v45, s42, v6
    v_dot2_f32_bf16 v7, v45, s43, v7
    v_dot2_f32_bf16 v8, v46, s42, v8
    v_dot2_f32_bf16 v9, v46, s43, v9
    v_dot2_f32_bf16 v10, v47, s42, v10
    v_dot2_f32_bf16 v11, v47, s43, v11
    v_dot2_f32_bf16 v4, v48, s42, v4
    v_dot2_f32_bf16 v5, v48, s43, v5
    v_dot2_f32_bf16 v6, v49, s42, v6
    v_dot2_f32_bf16 v7, v49, s43, v7
    v_dot2_f32_bf16 v8, v50, s42, v8
    v_dot2_f32_bf16 v9, v50, s43, v9
    v_dot2_f32_bf16 v10, v51, s42, v10
    v_dot2_f32_bf16 v11, v51, s43, v11
    v_dot2_f32_bf16 v4, v52, s42, v4
    v_dot2_f32_bf16 v5, v52, s43, v5
    v_dot2_f32_bf16 v6, v53, s42, v6
    v_dot2_f32_bf16 v7, v53, s43, v7
    v_dot2_f32_bf16 v8, v54, s42, v8
    v_dot2_f32_bf16 v9, v54, s43, v9
    v_dot2_f32_bf16 v10, v55, s42, v10
    v_dot2_f32_bf16 v11, v55, s43, v11
    v_dot2_f32_bf16 v4, v56, s42, v4
    v_dot2_f32_bf16 v5, v56, s43, v5
    v_dot2_f32_bf16 v6, v57, s42, v6
    v_dot2_f32_bf16 v7, v57, s43, v7
    v_dot2_f32_bf16 v8, v58, s42, v8
    v_dot2_f32_bf16 v9, v58, s43, v9
    v_dot2_f32_bf16 v10, v59, s42, v10
    v_dot2_f32_bf16 v11, v59, s43, v11
    v_dot2_f32_bf16 v4, v60, s42, v4
    v_dot2_f32_bf16 v5, v60, s43, v5
    v_dot2_f32_bf16 v6, v61, s42, v6
    v_dot2_f32_bf16 v7, v61, s43, v7
    v_dot2_f32_bf16 v8, v62, s42, v8
    v_dot2_f32_bf16 v9, v62, s43, v9
    v_dot2_f32_bf16 v10, v63, s42, v10
    v_dot2_f32_bf16 v11, v63, s43, v11
    v_dot2_f32_bf16 v4, v64, s42, v4
    v_dot2_f32_bf16 v5, v64, s43, v5
    v_dot2_f32_bf16 v6, v65, s42, v6
    v_dot2_f32_bf16 v7, v65, s43, v7
    v_dot2_f32_bf16 v8, v66, s42, v8
    v_dot2_f32_bf16 v9, v66, s43, v9
    v_dot2_f32_bf16 v10, v67, s42, v10
    v_dot2_f32_bf16 v11, v67, s43, v11
    v_add_f32_dpp v4, v4, v4 row_ror:8 row_mask:0xf bank_mask:0xf
    v_add_f32_dpp v5, v5, v5 row_ror:8 row_mask:0xf bank_mask:0xf
    v_add_f32_dpp v6, v6, v6 row_ror:8 row_mask:0xf bank_mask:0xf
    v_add_f32_dpp v7, v7, v7 row_ror:8 row_mask:0xf bank_mask:0xf
    v_add_f32_dpp v8, v8, v8 row_ror:8 row_mask:0xf bank_mask:0xf
    v_add_f32_dpp v9, v9, v9 row_ror:8 row_mask:0xf bank_mask:0xf
    v_add_f32_dpp v10, v10, v10 row_ror:8 row_mask:0xf bank_mask:0xf
    v_add_f32_dpp v11, v11, v11 row_ror:8 row_mask:0xf bank_mask:0xf
    v_mov_b32 v16, v4
    v_mov_b32 v17, v5
    v_mov_b32 v18, v6
    v_mov_b32 v19, v7
    v_mov_b32 v20, v8
    v_mov_b32 v21, v9
    v_mov_b32 v22, v10
    v_mov_b32 v23, v11
    v_permlane16_swap_b32 v4, v16
    v_permlane16_swap_b32 v5, v17
    v_permlane16_swap_b32 v6, v18
    v_permlane16_swap_b32 v7, v19
    v_permlane16_swap_b32 v8, v20
    v_permlane16_swap_b32 v9, v21
    v_permlane16_swap_b32 v10, v22
    v_permlane16_swap_b32 v11, v23
    v_add_f32 v4, v4, v16
    v_add_f32 v5, v5, v17
    v_add_f32 v6, v6, v18
    v_add_f32 v7, v7, v19
    v_add_f32 v8, v8, v20
    v_add_f32 v9, v9, v21
    v_add_f32 v10, v10, v22
    v_add_f32 v11, v11, v23
    v_mov_b32 v16, v4
    v_mov_b32 v17, v5
    v_mov_b32 v18, v6
    v_mov_b32 v19, v7
    v_mov_b32 v20, v8
    v_mov_b32 v21, v9
    v_mov_b32 v22, v10
    v_mov_b32 v23, v11
    v_permlane32_swap_b32 v4, v16
    v_permlane32_swap_b32 v5, v17
    v_permlane32_swap_b32 v6, v18
    v_permlane32_swap_b32 v7, v19
    v_permlane32_swap_b32 v8, v20
    v_permlane32_swap_b32 v9, v21
    v_permlane32_swap_b32 v10, v22
    v_permlane32_swap_b32 v11, v23
    v_add_f32 v4, v4, v16
    v_add_f32 v5, v5, v17
    v_add_f32 v6, v6, v18
    v_add_f32 v7, v7, v19
    v_add_f32 v8, v8, v20
    v_add_f32 v9, v9, v21
    v_add_f32 v10, v10, v22
    v_add_f32 v11, v11, v23
    s_mov_b64 exec, 0xff
    ds_write_b128 v12, v[4:7]
    ds_write_b128 v12, v[8:11] offset:16
    s_mov_b64 exec, -1
    s_waitcnt lgkmcnt(0)
    s_barrier
    s_cmp_lg_u32 s56, 0
    s_cbranch_scc1 Lhe
    s_mov_b32 s56, 1
    v_add_u32 v12, 2048, v12
    s_waitcnt vmcnt(1)
    v_mov_b32 v40, v68
    v_mov_b32 v41, v69
    v_mov_b32 v42, v70
    v_mov_b32 v43, v71
    v_mov_b32 v44, v72
    v_mov_b32 v45, v73
    v_mov_b32 v46, v74
    v_mov_b32 v47, v75
    v_mov_b32 v48, v76
    v_mov_b32 v49, v77
    v_mov_b32 v50, v78
    v_mov_b32 v51, v79
    v_mov_b32 v52, v80
    v_mov_b32 v53, v81
    v_mov_b32 v54, v82
    v_mov_b32 v55, v83
    v_mov_b32 v56, v84
    v_mov_b32 v57, v85
    v_mov_b32 v58, v86
    v_mov_b32 v59, v87
    v_mov_b32 v60, v88
    v_mov_b32 v61, v89
    v_mov_b32 v62, v90
    v_mov_b32 v63, v91
    v_mov_b32 v64, v92
    v_mov_b32 v65, v93
    v_mov_b32 v66, v94
    v_mov_b32_e64 v67, v95
    s_branch Lhl
Lhf:
    s_barrier
    ds_read2st64_b32 v[4:5], v13 offset0:0 offset1:1
    ds_read2st64_b32 v[6:7], v13 offset0:2 offset1:3
    ds_read2st64_b32 v[8:9], v13 offset0:4 offset1:5
    ds_read2st64_b32 v[10:11], v13 offset0:6 offset1:7
    s_waitcnt lgkmcnt(0)
    v_pk_add_f32 v[4:5], v[4:5], v[6:7]
    v_pk_add_f32 v[8:9], v[8:9], v[10:11]
    v_pk_add_f32 v[4:5], v[4:5], v[8:9]
    v_add_f32 v4, v4, v5
    v_cvt_pk_bf16_f32 v5, v4, v4
    v_and_b32 v5, s41, v5
    v_sub_f32 v6, v4, v5
    v_cvt_pk_bf16_f32 v8, v5, v6
    v_and_b32 v7, s41, v8
    v_sub_f32 v6, v6, v7
    v_cvt_pk_bf16_f32 v9, v6, 0
    global_store_dwordx2 v14, v[8:9], s[30:31] sc0 sc1
    s_mov_b32 s46, 1
    s_waitcnt vmcnt(0)
    s_atomic_add s46, s[28:29], s56
    v_add_u32 v14, 512, v14
    v_add_u32 v13, 2048, v13
    s_add_u32 s56, s56, 128
    s_waitcnt lgkmcnt(0)
    s_cmp_lt_u32 s56, 256
    s_cbranch_scc1 Lhf
Lhe:
    s_endpgm
.p2align 7
.type tab_5,@object
tab_5:
.long 0x00000000, 0x00000000, 0x08400420, 0x10800c60
.long 0x18c014a0, 0x00041ce0, 0x08440424, 0x10840c64
.long 0x18c414a4, 0x00081ce4, 0x08480428, 0x10880c68
.long 0x18c814a8, 0x000c1ce8, 0x084c042c, 0x108c0c6c
.long 0x18cc14ac, 0x00101cec, 0x08500430, 0x10900c70
.long 0x18d014b0, 0x00141cf0, 0x08540434, 0x10940c74
.long 0x18d414b4, 0x00181cf4, 0x08580438, 0x10980c78
.long 0x18d814b8, 0x001c1cf8, 0x085c043c, 0x109c0c7c
.long 0x18dc14bc, 0x00201cfc, 0x08600440, 0x10a00c80
.long 0x18e014c0, 0x00241d00, 0x08640444, 0x10a40c84
.long 0x18e414c4, 0x00281d04, 0x08680448, 0x10a80c88
.long 0x18e814c8, 0x002c1d08, 0x086c044c, 0x10ac0c8c
.long 0x18ec14cc, 0x00301d0c, 0x08700450, 0x10b00c90
.long 0x18f014d0, 0x00341d10, 0x08740454, 0x10b40c94
.long 0x18f414d4, 0x00381d14, 0x08780458, 0x10b80c98
.long 0x18f814d8, 0x003c1d18, 0x087c045c, 0x10bc0c9c
.long 0x18fc14dc, 0x00401d1c, 0x08800460, 0x10c00ca0
.long 0x190014e0, 0x00441d20, 0x08840464, 0x10c40ca4
.long 0x190414e4, 0x00481d24, 0x08880468, 0x10c80ca8
.long 0x190814e8, 0x004c1d28, 0x088c046c, 0x10cc0cac
.long 0x190c14ec, 0x00501d2c, 0x08900470, 0x10d00cb0
.long 0x191014f0, 0x00541d30, 0x08940474, 0x10d40cb4
.long 0x191414f4, 0x00581d34, 0x08980478, 0x10d80cb8
.long 0x191814f8, 0x005c1d38, 0x089c047c, 0x10dc0cbc
.long 0x191c14fc, 0x00601d3c, 0x08a00480, 0x10e00cc0
.long 0x19201500, 0x00641d40, 0x08a40484, 0x10e40cc4
.long 0x19241504, 0x00681d44, 0x08a80488, 0x10e80cc8
.long 0x19281508, 0x006c1d48, 0x08ac048c, 0x10ec0ccc
.long 0x192c150c, 0x00701d4c, 0x08b00490, 0x10f00cd0
.long 0x19301510, 0x00741d50, 0x08b40494, 0x10f40cd4
.long 0x19341514, 0x00781d54, 0x08b80498, 0x10f80cd8
.long 0x19381518, 0x007c1d58, 0x08bc049c, 0x10fc0cdc
.long 0x193c151c, 0x00801d5c, 0x08c00080, 0x11001100
.long 0x19401100, 0x00840084, 0x08c40084, 0x11041104
.long 0x19441104, 0x00880088, 0x08c80088, 0x11081108
.long 0x19481108, 0x008c008c, 0x08cc008c, 0x110c110c
.long 0x194c110c, 0x00900090, 0x08d00090, 0x11101110
.long 0x19501110, 0x00940094, 0x08d40094, 0x11141114
.long 0x19541114, 0x00980098, 0x08d80098, 0x11181118
.long 0x19581118, 0x009c009c, 0x08dc009c, 0x111c111c
.long 0x195c111c, 0x00a000a0, 0x08e000a0, 0x11201120
.long 0x19601120, 0x00a400a4, 0x08e400a4, 0x11241124
.long 0x19641124, 0x00a800a8, 0x08e800a8, 0x11281128
.long 0x19681128, 0x00ac00ac, 0x08ec00ac, 0x112c112c
.long 0x196c112c, 0x00b000b0, 0x08f000b0, 0x11301130
.long 0x19701130, 0x00b400b4, 0x08f400b4, 0x11341134
.long 0x19741134, 0x00b800b8, 0x08f800b8, 0x11381138
.long 0x19781138, 0x00bc00bc, 0x08fc00bc, 0x113c113c
.long 0x197c113c, 0x00c000c0, 0x090000c0, 0x11401140
.long 0x19801140, 0x00c400c4, 0x090400c4, 0x11441144
.long 0x19841144, 0x00c800c8, 0x090800c8, 0x11481148
.long 0x19881148, 0x00cc00cc, 0x090c00cc, 0x114c114c
.long 0x198c114c, 0x00d000d0, 0x091000d0, 0x11501150
.long 0x19901150, 0x00d400d4, 0x091400d4, 0x11541154
.long 0x19941154, 0x00d800d8, 0x091800d8, 0x11581158
.long 0x19981158, 0x00dc00dc, 0x091c00dc, 0x115c115c
.long 0x199c115c, 0x00e000e0, 0x092000e0, 0x11601160
.long 0x19a01160, 0x00e400e4, 0x092400e4, 0x11641164
.long 0x19a41164, 0x00e800e8, 0x092800e8, 0x11681168
.long 0x19a81168, 0x00ec00ec, 0x092c00ec, 0x116c116c
.long 0x19ac116c, 0x00f000f0, 0x093000f0, 0x11701170
.long 0x19b01170, 0x00f400f4, 0x093400f4, 0x11741174
.long 0x19b41174, 0x00f800f8, 0x093800f8, 0x11781178
.long 0x19b81178, 0x00fc00fc, 0x093c00fc, 0x117c117c
.long 0x19bc117c, 0x01000100, 0x01000100, 0x11801180
.long 0x01041180, 0x01040104, 0x01040104, 0x11841184
.long 0x01081184, 0x01080108, 0x01080108, 0x11881188
.long 0x010c1188, 0x010c010c, 0x010c010c, 0x118c118c
.long 0x0110118c, 0x01100110, 0x01100110, 0x11901190
.long 0x01141190, 0x01140114, 0x01140114, 0x11941194
.long 0x01181194, 0x01180118, 0x01180118, 0x11981198
.long 0x011c1198, 0x011c011c, 0x011c011c, 0x119c119c
.long 0x0120119c, 0x01200120, 0x01200120, 0x11a011a0
.long 0x012411a0, 0x01240124, 0x01240124, 0x11a411a4
.long 0x012811a4, 0x01280128, 0x01280128, 0x11a811a8
.long 0x012c11a8, 0x012c012c, 0x012c012c, 0x11ac11ac
.long 0x013011ac, 0x01300130, 0x01300130, 0x11b011b0
.long 0x013411b0, 0x01340134, 0x01340134, 0x11b411b4
.long 0x013811b4, 0x01380138, 0x01380138, 0x11b811b8
.long 0x013c11b8, 0x013c013c, 0x013c013c, 0x11bc11bc
.long 0x014011bc, 0x01400140, 0x01400140, 0x11c011c0
.long 0x014411c0, 0x01440144, 0x01440144, 0x11c411c4
.long 0x014811c4, 0x01480148, 0x01480148, 0x11c811c8
.long 0x014c11c8, 0x014c014c, 0x014c014c, 0x11cc11cc
.long 0x015011cc, 0x01500150, 0x01500150, 0x11d011d0
.long 0x015411d0, 0x01540154, 0x01540154, 0x11d411d4
.long 0x015811d4, 0x01580158, 0x01580158, 0x11d811d8
.long 0x015c11d8, 0x015c015c, 0x015c015c, 0x11dc11dc
.long 0x016011dc, 0x01600160, 0x01600160, 0x11e011e0
.long 0x016411e0, 0x01640164, 0x01640164, 0x11e411e4
.long 0x016811e4, 0x01680168, 0x01680168, 0x11e811e8
.long 0x016c11e8, 0x016c016c, 0x016c016c, 0x11ec11ec
.long 0x017011ec, 0x01700170, 0x01700170, 0x11f011f0
.long 0x017411f0, 0x01740174, 0x01740174, 0x11f411f4
.long 0x017811f4, 0x01780178, 0x01780178, 0x11f811f8
.long 0x017c11f8, 0x017c017c, 0x017c017c, 0x11fc11fc
.long 0x018011fc, 0x01800180, 0x01800180, 0x12001200
.long 0x01841200, 0x01840184, 0x01840184, 0x12041204
.long 0x01881204, 0x01880188, 0x01880188, 0x12081208
.long 0x018c1208, 0x018c018c, 0x018c018c, 0x120c120c
.long 0x0190120c, 0x01900190, 0x01900190, 0x12101210
.long 0x01941210, 0x01940194, 0x01940194, 0x12141214
.long 0x01981214, 0x01980198, 0x01980198, 0x12181218
.long 0x019c1218, 0x019c019c, 0x019c019c, 0x121c121c
.long 0x01a0121c, 0x01a001a0, 0x01a001a0, 0x12201220
.long 0x01a41220, 0x01a401a4, 0x01a401a4, 0x12241224
.long 0x01a81224, 0x01a801a8, 0x01a801a8, 0x12281228
.long 0x01ac1228, 0x01ac01ac, 0x01ac01ac, 0x122c122c
.long 0x01b0122c, 0x01b001b0, 0x01b001b0, 0x12301230
.long 0x01b41230, 0x01b401b4, 0x01b401b4, 0x12341234
.long 0x01b81234, 0x01b801b8, 0x01b801b8, 0x12381238
.long 0x01bc1238, 0x01bc01bc, 0x01bc01bc, 0x123c123c
.long 0x01c0123c, 0x01c001c0, 0x01c001c0, 0x12401240
.long 0x01c41240, 0x01c401c4, 0x01c401c4, 0x12441244
.long 0x01c81244, 0x01c801c8, 0x01c801c8, 0x12481248
.long 0x01cc1248, 0x01cc01cc, 0x01cc01cc, 0x124c124c
.long 0x01d0124c, 0x01d001d0, 0x01d001d0, 0x12501250
.long 0x01d41250, 0x01d401d4, 0x01d401d4, 0x12541254
.long 0x01d81254, 0x01d801d8, 0x01d801d8, 0x12581258
.long 0x01dc1258, 0x01dc01dc, 0x01dc01dc, 0x125c125c
.long 0x01e0125c, 0x01e001e0, 0x01e001e0, 0x12601260
.long 0x01e41260, 0x01e401e4, 0x01e401e4, 0x12641264
.long 0x01e81264, 0x01e801e8, 0x01e801e8, 0x12681268
.long 0x01ec1268, 0x01ec01ec, 0x01ec01ec, 0x126c126c
.long 0x01f0126c, 0x01f001f0, 0x01f001f0, 0x12701270
.long 0x01f41270, 0x01f401f4, 0x01f401f4, 0x12741274
.long 0x01f81274, 0x01f801f8, 0x01f801f8, 0x12781278
.long 0x01fc1278, 0x01fc01fc, 0x01fc01fc, 0x127c127c
.long 0x0200127c, 0x02000200, 0x02000200, 0x02000200
.long 0x02040204, 0x02040204, 0x02040204, 0x02080204
.long 0x02080208, 0x02080208, 0x02080208, 0x02080208
.long 0x020c020c, 0x020c020c, 0x020c020c, 0x0210020c
.long 0x02100210, 0x02100210, 0x02100210, 0x02100210
.long 0x02140214, 0x02140214, 0x02140214, 0x02180214
.long 0x02180218, 0x02180218, 0x02180218, 0x02180218
.long 0x021c021c, 0x021c021c, 0x021c021c, 0x0220021c
.long 0x02200220, 0x02200220, 0x02200220, 0x02200220
.long 0x02240224, 0x02240224, 0x02240224, 0x02280224
.long 0x02280228, 0x02280228, 0x02280228, 0x02280228
.long 0x022c022c, 0x022c022c, 0x022c022c, 0x0230022c
.long 0x02300230, 0x02300230, 0x02300230, 0x02300230
.long 0x02340234, 0x02340234, 0x02340234, 0x02380234
.long 0x02380238, 0x02380238, 0x02380238, 0x02380238
.long 0x023c023c, 0x023c023c, 0x023c023c, 0x0240023c
.long 0x02400240, 0x02400240, 0x02400240, 0x02400240
.long 0x02440244, 0x02440244, 0x02440244, 0x02480244
.long 0x02480248, 0x02480248, 0x02480248, 0x02480248
.long 0x024c024c, 0x024c024c, 0x024c024c, 0x0250024c
.long 0x02500250, 0x02500250, 0x02500250, 0x02500250
.long 0x02540254, 0x02540254, 0x02540254, 0x02580254
.long 0x02580258, 0x02580258, 0x02580258, 0x02580258
.long 0x025c025c, 0x025c025c, 0x025c025c, 0x0260025c
.long 0x02600260, 0x02600260, 0x02600260, 0x02600260
.long 0x02640264, 0x02640264, 0x02640264, 0x02680264
.long 0x02680268, 0x02680268, 0x02680268, 0x02680268
.long 0x026c026c, 0x026c026c, 0x026c026c, 0x0270026c
.long 0x02700270, 0x02700270, 0x02700270, 0x02700270
.long 0x02740274, 0x02740274, 0x02740274, 0x02780274
.long 0x02780278, 0x02780278, 0x02780278, 0x02780278
.long 0x027c027c, 0x027c027c, 0x027c027c, 0x0280027c
.long 0x02800280, 0x02800280, 0x02800280, 0x02800280
.long 0x02840284, 0x02840284, 0x02840284, 0x02880284
.long 0x02880288, 0x02880288, 0x02880288, 0x02880288
.long 0x028c028c, 0x028c028c, 0x028c028c, 0x0290028c
.long 0x02900290, 0x02900290, 0x02900290, 0x02900290
.long 0x02940294, 0x02940294, 0x02940294, 0x02980294
.long 0x02980298, 0x02980298, 0x02980298, 0x02980298
.long 0x029c029c, 0x029c029c, 0x029c029c, 0x02a0029c
.long 0x02a002a0, 0x02a002a0, 0x02a002a0, 0x02a002a0
.long 0x02a402a4, 0x02a402a4, 0x02a402a4, 0x02a802a4
.long 0x02a802a8, 0x02a802a8, 0x02a802a8, 0x02a802a8
.long 0x02ac02ac, 0x02ac02ac, 0x02ac02ac, 0x02b002ac
.long 0x02b002b0, 0x02b002b0, 0x02b002b0, 0x02b002b0
.long 0x02b402b4, 0x02b402b4, 0x02b402b4, 0x02b802b4
.long 0x02b802b8, 0x02b802b8, 0x02b802b8, 0x02b802b8
.long 0x02bc02bc, 0x02bc02bc, 0x02bc02bc, 0x02c002bc
.long 0x02c002c0, 0x02c002c0, 0x02c002c0, 0x02c002c0
.long 0x02c402c4, 0x02c402c4, 0x02c402c4, 0x02c802c4
.long 0x02c802c8, 0x02c802c8, 0x02c802c8, 0x02c802c8
.long 0x02cc02cc, 0x02cc02cc, 0x02cc02cc, 0x02d002cc
.long 0x02d002d0, 0x02d002d0, 0x02d002d0, 0x02d002d0
.long 0x02d402d4, 0x02d402d4, 0x02d402d4, 0x02d802d4
.long 0x02d802d8, 0x02d802d8, 0x02d802d8, 0x02d802d8
.long 0x02dc02dc, 0x02dc02dc, 0x02dc02dc, 0x02e002dc
.long 0x02e002e0, 0x02e002e0, 0x02e002e0, 0x02e002e0
.long 0x02e402e4, 0x02e402e4, 0x02e402e4, 0x02e802e4
.long 0x02e802e8, 0x02e802e8, 0x02e802e8, 0x02e802e8
.long 0x02ec02ec, 0x02ec02ec, 0x02ec02ec, 0x02f002ec
.long 0x02f002f0, 0x02f002f0, 0x02f002f0, 0x02f002f0
.long 0x02f402f4, 0x02f402f4, 0x02f402f4, 0x02f802f4
.long 0x02f802f8, 0x02f802f8, 0x02f802f8, 0x02f802f8
.long 0x02fc02fc, 0x02fc02fc, 0x02fc02fc, 0x030002fc
.long 0x03000300, 0x03000300, 0x03000300, 0x03000300
.long 0x03040304, 0x03040304, 0x03040304, 0x03080304
.long 0x03080308, 0x03080308, 0x03080308, 0x03080308
.long 0x030c030c, 0x030c030c, 0x030c030c, 0x0310030c
.long 0x03100310, 0x03100310, 0x03100310, 0x03100310
.long 0x03140314, 0x03140314, 0x03140314, 0x03180314
.long 0x03180318, 0x03180318, 0x03180318, 0x03180318
.long 0x031c031c, 0x031c031c, 0x031c031c, 0x0320031c
.long 0x03200320, 0x03200320, 0x03200320, 0x03200320
.long 0x03240324, 0x03240324, 0x03240324, 0x03280324
.long 0x03280328, 0x03280328, 0x03280328, 0x03280328
.long 0x032c032c, 0x032c032c, 0x032c032c, 0x0330032c
.long 0x03300330, 0x03300330, 0x03300330, 0x03300330
.long 0x03340334, 0x03340334, 0x03340334, 0x03380334
.long 0x03380338, 0x03380338, 0x03380338, 0x03380338
.long 0x033c033c, 0x033c033c, 0x033c033c, 0x0340033c
.long 0x03400340, 0x03400340, 0x03400340, 0x03400340
.long 0x03440344, 0x03440344, 0x03440344, 0x03480344
.long 0x03480348, 0x03480348, 0x03480348, 0x03480348
.long 0x034c034c, 0x034c034c, 0x034c034c, 0x0350034c
.long 0x03500350, 0x03500350, 0x03500350, 0x03500350
.long 0x03540354, 0x03540354, 0x03540354, 0x03580354
.long 0x03580358, 0x03580358, 0x03580358, 0x03580358
.long 0x035c035c, 0x035c035c, 0x035c035c, 0x0360035c
.long 0x03600360, 0x03600360, 0x03600360, 0x03600360
.long 0x03640364, 0x03640364, 0x03640364, 0x03680364
.long 0x03680368, 0x03680368, 0x03680368, 0x03680368
.long 0x036c036c, 0x036c036c, 0x036c036c, 0x0370036c
.long 0x03700370, 0x03700370, 0x03700370, 0x03700370
.long 0x03740374, 0x03740374, 0x03740374, 0x03780374
.long 0x03780378, 0x03780378, 0x03780378, 0x03780378
.long 0x037c037c, 0x037c037c, 0x037c037c, 0x0380037c
.long 0x03800380, 0x03800380, 0x03800380, 0x03800380
.long 0x03840384, 0x03840384, 0x03840384, 0x03880384
.long 0x03880388, 0x03880388, 0x03880388, 0x03880388
.long 0x038c038c, 0x038c038c, 0x038c038c, 0x0390038c
.long 0x03900390, 0x03900390, 0x03900390, 0x03900390
.long 0x03940394, 0x03940394, 0x03940394, 0x03980394
.long 0x03980398, 0x03980398, 0x03980398, 0x03980398
.long 0x039c039c, 0x039c039c, 0x039c039c, 0x03a0039c
.long 0x03a003a0, 0x03a003a0, 0x03a003a0, 0x03a003a0
.long 0x03a403a4, 0x03a403a4, 0x03a403a4, 0x03a803a4
.long 0x03a803a8, 0x03a803a8, 0x03a803a8, 0x03a803a8
.long 0x03ac03ac, 0x03ac03ac, 0x03ac03ac, 0x03b003ac
.long 0x03b003b0, 0x03b003b0, 0x03b003b0, 0x03b003b0
.long 0x03b403b4, 0x03b403b4, 0x03b403b4, 0x03b803b4
.long 0x03b803b8, 0x03b803b8, 0x03b803b8, 0x03b803b8
.long 0x03bc03bc, 0x03bc03bc, 0x03bc03bc, 0x03c003bc
.long 0x03c003c0, 0x03c003c0, 0x03c003c0, 0x03c003c0
.long 0x03c403c4, 0x03c403c4, 0x03c403c4, 0x03c803c4
.long 0x03c803c8, 0x03c803c8, 0x03c803c8, 0x03c803c8
.long 0x03cc03cc, 0x03cc03cc, 0x03cc03cc, 0x03d003cc
.long 0x03d003d0, 0x03d003d0, 0x03d003d0, 0x03d003d0
.long 0x03d403d4, 0x03d403d4, 0x03d403d4, 0x03d803d4
.long 0x03d803d8, 0x03d803d8, 0x03d803d8, 0x03d803d8
.long 0x03dc03dc, 0x03dc03dc, 0x03dc03dc, 0x03e003dc
.long 0x03e003e0, 0x03e003e0, 0x03e003e0, 0x03e003e0
.long 0x03e403e4, 0x03e403e4, 0x03e403e4, 0x03e803e4
.long 0x03e803e8, 0x03e803e8, 0x03e803e8, 0x03e803e8
.long 0x03ec03ec, 0x03ec03ec, 0x03ec03ec, 0x03f003ec
.long 0x03f003f0, 0x03f003f0, 0x03f003f0, 0x03f003f0
.long 0x03f403f4, 0x03f403f4, 0x03f403f4, 0x03f803f4
.long 0x03f803f8, 0x03f803f8, 0x03f803f8, 0x03f803f8
.long 0x03fc03fc, 0x03fc03fc, 0x03fc03fc, 0x040003fc
.long 0x18c014a0, 0x00041ce0
.long 0x18c414a4, 0x00081ce4
.long 0x18c814a8, 0x000c1ce8
.long 0x18cc14ac, 0x00101cec
.long 0x18d014b0, 0x00141cf0
.long 0x18d414b4, 0x00181cf4
.long 0x18d814b8, 0x001c1cf8
.long 0x18dc14bc, 0x00201cfc
.long 0x18e014c0, 0x00241d00
.long 0x18e414c4, 0x00281d04
.long 0x18e814c8, 0x002c1d08
.long 0x18ec14cc, 0x00301d0c
.long 0x18f014d0, 0x00341d10
.long 0x18f414d4, 0x00381d14
.long 0x18f814d8, 0x003c1d18
.long 0x18fc14dc, 0x00401d1c
.long 0x190014e0, 0x00441d20
.long 0x190414e4, 0x00481d24
.long 0x190814e8, 0x004c1d28
.long 0x190c14ec, 0x00501d2c
.long 0x191014f0, 0x00541d30
.long 0x191414f4, 0x00581d34
.long 0x191814f8, 0x005c1d38
.long 0x191c14fc, 0x00601d3c
.long 0x19201500, 0x00641d40
.long 0x19241504, 0x00681d44
.long 0x19281508, 0x006c1d48
.long 0x192c150c, 0x00701d4c
.long 0x19301510, 0x00741d50
.long 0x19341514, 0x00781d54
.long 0x19381518, 0x007c1d58
.long 0x193c151c, 0x00801d5c
.long 0x19401100, 0x00840084
.long 0x19441104, 0x00880088
.long 0x19481108, 0x008c008c
.long 0x194c110c, 0x00900090
.long 0x19501110, 0x00940094
.long 0x19541114, 0x00980098
.long 0x19581118, 0x009c009c
.long 0x195c111c, 0x00a000a0
.long 0x19601120, 0x00a400a4
.long 0x19641124, 0x00a800a8
.long 0x19681128, 0x00ac00ac
.long 0x196c112c, 0x00b000b0
.long 0x19701130, 0x00b400b4
.long 0x19741134, 0x00b800b8
.long 0x19781138, 0x00bc00bc
.long 0x197c113c, 0x00c000c0
.long 0x19801140, 0x00c400c4
.long 0x19841144, 0x00c800c8
.long 0x19881148, 0x00cc00cc
.long 0x198c114c, 0x00d000d0
.long 0x19901150, 0x00d400d4
.long 0x19941154, 0x00d800d8
.long 0x19981158, 0x00dc00dc
.long 0x199c115c, 0x00e000e0
.long 0x19a01160, 0x00e400e4
.long 0x19a41164, 0x00e800e8
.long 0x19a81168, 0x00ec00ec
.long 0x19ac116c, 0x00f000f0
.long 0x19b01170, 0x00f400f4
.long 0x19b41174, 0x00f800f8
.long 0x19b81178, 0x00fc00fc
.long 0x19bc117c, 0x01000100
.long 0x01041180, 0x01040104
.long 0x01081184, 0x01080108
.long 0x010c1188, 0x010c010c
.long 0x0110118c, 0x01100110
.long 0x01141190, 0x01140114
.long 0x01181194, 0x01180118
.long 0x011c1198, 0x011c011c
.long 0x0120119c, 0x01200120
.long 0x012411a0, 0x01240124
.long 0x012811a4, 0x01280128
.long 0x012c11a8, 0x012c012c
.long 0x013011ac, 0x01300130
.long 0x013411b0, 0x01340134
.long 0x013811b4, 0x01380138
.long 0x013c11b8, 0x013c013c
.long 0x014011bc, 0x01400140
.long 0x014411c0, 0x01440144
.long 0x014811c4, 0x01480148
.long 0x014c11c8, 0x014c014c
.long 0x015011cc, 0x01500150
.long 0x015411d0, 0x01540154
.long 0x015811d4, 0x01580158
.long 0x015c11d8, 0x015c015c
.long 0x016011dc, 0x01600160
.long 0x016411e0, 0x01640164
.long 0x016811e4, 0x01680168
.long 0x016c11e8, 0x016c016c
.long 0x017011ec, 0x01700170
.long 0x017411f0, 0x01740174
.long 0x017811f4, 0x01780178
.long 0x017c11f8, 0x017c017c
.long 0x018011fc, 0x01800180
.long 0x01841200, 0x01840184
.long 0x01881204, 0x01880188
.long 0x018c1208, 0x018c018c
.long 0x0190120c, 0x01900190
.long 0x01941210, 0x01940194
.long 0x01981214, 0x01980198
.long 0x019c1218, 0x019c019c
.long 0x01a0121c, 0x01a001a0
.long 0x01a41220, 0x01a401a4
.long 0x01a81224, 0x01a801a8
.long 0x01ac1228, 0x01ac01ac
.long 0x01b0122c, 0x01b001b0
.long 0x01b41230, 0x01b401b4
.long 0x01b81234, 0x01b801b8
.long 0x01bc1238, 0x01bc01bc
.long 0x01c0123c, 0x01c001c0
.long 0x01c41240, 0x01c401c4
.long 0x01c81244, 0x01c801c8
.long 0x01cc1248, 0x01cc01cc
.long 0x01d0124c, 0x01d001d0
.long 0x01d41250, 0x01d401d4
.long 0x01d81254, 0x01d801d8
.long 0x01dc1258, 0x01dc01dc
.long 0x01e0125c, 0x01e001e0
.long 0x01e41260, 0x01e401e4
.long 0x01e81264, 0x01e801e8
.long 0x01ec1268, 0x01ec01ec
.long 0x01f0126c, 0x01f001f0
.long 0x01f41270, 0x01f401f4
.long 0x01f81274, 0x01f801f8
.long 0x01fc1278, 0x01fc01fc
.long 0x0200127c, 0x02000200
.long 0x02040204, 0x02040204
.long 0x02080208, 0x02080208
.long 0x020c020c, 0x020c020c
.long 0x02100210, 0x02100210
.long 0x02140214, 0x02140214
.long 0x02180218, 0x02180218
.long 0x021c021c, 0x021c021c
.long 0x02200220, 0x02200220
.long 0x02240224, 0x02240224
.long 0x02280228, 0x02280228
.long 0x022c022c, 0x022c022c
.long 0x02300230, 0x02300230
.long 0x02340234, 0x02340234
.long 0x02380238, 0x02380238
.long 0x023c023c, 0x023c023c
.long 0x02400240, 0x02400240
.long 0x02440244, 0x02440244
.long 0x02480248, 0x02480248
.long 0x024c024c, 0x024c024c
.long 0x02500250, 0x02500250
.long 0x02540254, 0x02540254
.long 0x02580258, 0x02580258
.long 0x025c025c, 0x025c025c
.long 0x02600260, 0x02600260
.long 0x02640264, 0x02640264
.long 0x02680268, 0x02680268
.long 0x026c026c, 0x026c026c
.long 0x02700270, 0x02700270
.long 0x02740274, 0x02740274
.long 0x02780278, 0x02780278
.long 0x027c027c, 0x027c027c
.long 0x02800280, 0x02800280
.long 0x02840284, 0x02840284
.long 0x02880288, 0x02880288
.long 0x028c028c, 0x028c028c
.long 0x02900290, 0x02900290
.long 0x02940294, 0x02940294
.long 0x02980298, 0x02980298
.long 0x029c029c, 0x029c029c
.long 0x02a002a0, 0x02a002a0
.long 0x02a402a4, 0x02a402a4
.long 0x02a802a8, 0x02a802a8
.long 0x02ac02ac, 0x02ac02ac
.long 0x02b002b0, 0x02b002b0
.long 0x02b402b4, 0x02b402b4
.long 0x02b802b8, 0x02b802b8
.long 0x02bc02bc, 0x02bc02bc
.long 0x02c002c0, 0x02c002c0
.long 0x02c402c4, 0x02c402c4
.long 0x02c802c8, 0x02c802c8
.long 0x02cc02cc, 0x02cc02cc
.long 0x02d002d0, 0x02d002d0
.long 0x02d402d4, 0x02d402d4
.long 0x02d802d8, 0x02d802d8
.long 0x02dc02dc, 0x02dc02dc
.long 0x02e002e0, 0x02e002e0
.long 0x02e402e4, 0x02e402e4
.long 0x02e802e8, 0x02e802e8
.long 0x02ec02ec, 0x02ec02ec
.long 0x02f002f0, 0x02f002f0
.long 0x02f402f4, 0x02f402f4
.long 0x02f802f8, 0x02f802f8
.long 0x02fc02fc, 0x02fc02fc
.long 0x03000300, 0x03000300
.long 0x03040304, 0x03040304
.long 0x03080308, 0x03080308
.long 0x030c030c, 0x030c030c
.long 0x03100310, 0x03100310
.long 0x03140314, 0x03140314
.long 0x03180318, 0x03180318
.long 0x031c031c, 0x031c031c
.long 0x03200320, 0x03200320
.long 0x03240324, 0x03240324
.long 0x03280328, 0x03280328
.long 0x032c032c, 0x032c032c
.long 0x03300330, 0x03300330
.long 0x03340334, 0x03340334
.long 0x03380338, 0x03380338
.long 0x033c033c, 0x033c033c
.long 0x03400340, 0x03400340
.long 0x03440344, 0x03440344
.long 0x03480348, 0x03480348
.long 0x034c034c, 0x034c034c
.long 0x03500350, 0x03500350
.long 0x03540354, 0x03540354
.long 0x03580358, 0x03580358
.long 0x035c035c, 0x035c035c
.long 0x03600360, 0x03600360
.long 0x03640364, 0x03640364
.long 0x03680368, 0x03680368
.long 0x036c036c, 0x036c036c
.long 0x03700370, 0x03700370
.long 0x03740374, 0x03740374
.long 0x03780378, 0x03780378
.long 0x037c037c, 0x037c037c
.long 0x03800380, 0x03800380
.long 0x03840384, 0x03840384
.long 0x03880388, 0x03880388
.long 0x038c038c, 0x038c038c
.long 0x03900390, 0x03900390
.long 0x03940394, 0x03940394
.long 0x03980398, 0x03980398
.long 0x039c039c, 0x039c039c
.long 0x03a003a0, 0x03a003a0
.long 0x03a403a4, 0x03a403a4
.long 0x03a803a8, 0x03a803a8
.long 0x03ac03ac, 0x03ac03ac
.long 0x03b003b0, 0x03b003b0
.long 0x03b403b4, 0x03b403b4
.long 0x03b803b8, 0x03b803b8
.long 0x03bc03bc, 0x03bc03bc
.long 0x03c003c0, 0x03c003c0
.long 0x03c403c4, 0x03c403c4
.long 0x03c803c8, 0x03c803c8
.long 0x03cc03cc, 0x03cc03cc
.long 0x03d003d0, 0x03d003d0
.long 0x03d403d4, 0x03d403d4
.long 0x03d803d8, 0x03d803d8
.long 0x03dc03dc, 0x03dc03dc
.long 0x03e003e0, 0x03e003e0
.long 0x03e403e4, 0x03e403e4
.long 0x03e803e8, 0x03e803e8
.long 0x03ec03ec, 0x03ec03ec
.long 0x03f003f0, 0x03f003f0
.long 0x03f403f4, 0x03f403f4
.long 0x03f803f8, 0x03f803f8
.long 0x03fc03fc, 0x03fc03fc
.long 0x04000400, 0x04000400
.size tab_5, 6144
Lcode_end:
.section .rodata,"a"
.p2align 6
.amdhsa_kernel sequential_preLN__ssm_conv_s4d__geglu_ffn__prompt_kernel
  .amdhsa_next_free_vgpr 168
  .amdhsa_next_free_sgpr 102
  .amdhsa_accum_offset 168
  .amdhsa_group_segment_fixed_size 0
  .amdhsa_kernarg_size 112
  .amdhsa_user_sgpr_count 2
  .amdhsa_user_sgpr_kernarg_segment_ptr 1
  .amdhsa_system_sgpr_workgroup_id_x 1
.end_amdhsa_kernel
```
